```python
import torch

def _softmax(x, axis=-1):
    return torch.softmax(x, dim=axis)
def _gelu(x):
    return torch.nn.functional.gelu(x, approximate="tanh")
def _silu(x):
    return torch.nn.functional.silu(x)
def _sigmoid(x):
    return torch.sigmoid(x)
def _layernorm(x, axis=-1, eps=1e-5):
    m = x.mean(dim=axis, keepdim=True)
    v = x.var(dim=axis, keepdim=True, unbiased=False)
    return (x - m) / torch.sqrt(v + eps)
def _scatter_add(tgt, idx, src, axis=0):
    return tgt.clone().index_add_(axis, idx, src)
def _segment_sum(src, seg, n):
    out = torch.zeros((n,) + src.shape[1:], dtype=src.dtype)
    return out.index_add_(0, seg, src)
def _pad(x, pw):
    flat = tuple(v for pair in reversed(pw) for v in pair)
    return torch.nn.functional.pad(x, flat)

kernel_name = 'interleave_layers__softmax_full_mha__dense_activation_relu__prompt'

def setup_inputs():

    _w = (lambda a: (lambda t: t.to(torch.bfloat16) if t.is_floating_point() else t)(torch.as_tensor(a)))
    def _A_setup():
        B, S, D = 1, 2048, 1024
        return {
            "x": _w((lambda *s: torch.randn(*s, dtype=torch.bfloat16) * 0.05)(B, S, D)),
            "wqkv": _w((lambda *s: torch.randn(*s, dtype=torch.bfloat16) * 0.05)(D, 3 * D)),
            "wo": _w((lambda *s: torch.randn(*s, dtype=torch.bfloat16) * 0.05)(D, D)),
        }
    _A_in = _A_setup()

    def _B_setup():
        B, S, D, Dff = 1, 2048, 1024, 3584
        return {
            "x": _w((lambda *s: torch.randn(*s, dtype=torch.bfloat16) * 0.05)(B, S, D)),
            "w1": _w((lambda *s: torch.randn(*s, dtype=torch.bfloat16) * 0.05)(D, Dff)),
            "w2": _w((lambda *s: torch.randn(*s, dtype=torch.bfloat16) * 0.05)(Dff, D)),
        }
    _B_in = _B_setup()

    return {
        "A_x": _A_in["x"],
        "A_wqkv": _A_in["wqkv"],
        "A_wo": _A_in["wo"],
        "B_x": _B_in["x"],
        "B_w1": _B_in["w1"],
        "B_w2": _B_in["w2"],
    }

def reference(A_x, A_wqkv, A_wo, B_x, B_w1, B_w2):
    def _A_ref(x, wqkv, wo):
        B, S, D = x.shape
        H = 32; Dh = D // H
        qkv = (lambda x, *d: x.permute(*d))((x @ wqkv).reshape(B, S, 3, H, Dh), 2, 0, 3, 1, 4)
        q, k, v = qkv[0], qkv[1], qkv[2]
        scale = Dh ** -0.5
        scores = torch.einsum("bhqd,bhkd->bhqk", q, k) * scale
        p = _softmax(scores, axis=-1)
        o = torch.einsum("bhqk,bhkd->bhqd", p, v)
        return (lambda x, *d: x.permute(*d))(o, 0, 2, 1, 3).reshape(B, S, D) @ wo

    def _B_ref(x, w1, w2):
        h = torch.einsum("bsd,df->bsf", x, w1)
        zero = torch.zeros_like(h)
        h = torch.maximum(h, zero)
        return torch.einsum("bsf,fd->bsd", h, w2)

    x = A_x
    x = x + _A_ref(_layernorm(x, axis=-1), A_wqkv, A_wo)
    x = x + _B_ref(_layernorm(x, axis=-1), B_w1, B_w2)
    x = x + _A_ref(_layernorm(x, axis=-1), A_wqkv, A_wo)
    x = x + _B_ref(_layernorm(x, axis=-1), B_w1, B_w2)
    return x
```

```asm
; @launch kernel=main_kernel grid=(256,1,1) block=(512,1,1) lds=163840
.amdgcn_target "amdgcn-amd-amdhsa--gfx950"
.text
.p2align 8
.globl main_kernel
.type main_kernel,@function
main_kernel:
  s_load_dwordx2 s[4:5], s[0:1], 64
  s_load_dwordx2 s[8:9], s[0:1], 48
  s_load_dwordx4 s[84:87], s[0:1], 0
  s_load_dwordx2 s[56:57], s[0:1], 16
  s_load_dwordx4 s[60:63], s[0:1], 32
  s_cmp_ge_u32 s2, 256
  s_cbranch_scc1 main_exit
  v_lshrrev_b32 v1, 6, v0
  v_and_b32 v0, 63, v0
  v_readfirstlane_b32 s3, v1
  s_and_b32 s24, s2, 7
  s_lshr_b32 s25, s2, 3
  s_lshr_b32 s26, s24, 2
  s_and_b32 s27, s24, 3
  s_lshl_b32 s26, s26, 3
  s_lshl_b32 s27, s27, 2
  s_and_b32 s28, s25, 7
  s_lshr_b32 s29, s25, 3
  s_add_u32 s26, s26, s28
  s_add_u32 s27, s27, s29
  s_mov_b32 s18, 155189248
  s_mov_b32 s19, 0x20000
  s_mov_b32 s10, 0
  s_mul_i32 s6, s26, 20480
  s_mov_b32 s11, 97583104
  s_waitcnt lgkmcnt(0)
  s_mov_b32 s16, s4
  s_mov_b32 s17, s5
  s_cmp_ge_u32 s3, 4
  s_cbranch_scc1 main_c0
  s_getpc_b64 s[80:81]
main_pc:
  s_add_u32 s80, s80, main_kernel-main_pc
  s_addc_u32 s81, s81, -1
  s_mov_b32 s82, main_end-main_kernel
  s_mov_b32 s83, 0x20000
  v_lshrrev_b32 v1, 3, v0
  s_lshl_b32 s46, s3, 3
  v_add_u32 v1, s46, v1
  s_movk_i32 s47, 6144
  v_mul_lo_u32 v1, s47, v1
  v_bfe_u32 v2, v0, 4, 1
  s_and_b32 s46, s3, 1
  s_lshl_b32 s46, s46, 2
  v_lshl_or_b32 v2, v2, 1, s46
  v_and_b32 v3, 7, v0
  v_xor_b32 v2, v2, v3
  v_lshl_add_u32 v5, v2, 4, v1
  v_lshrrev_b32 v1, 3, v0
  v_lshrrev_b32 v2, 4, v0
  v_xor_b32 v2, v2, v3
  v_lshlrev_b32 v2, 4, v2
  v_lshl_add_u32 v6, v1, 11, v2
  s_lshl_b32 s46, s3, 16
  v_add_u32 v6, s46, v6
  v_xor_b32 v7, 64, v6
  v_add_u32 v7, 16384, v7
  v_add_u32 v14, 32768, v6
  v_add_u32 v15, 32768, v7
  s_mov_b32 s28, s84
  s_mov_b32 s29, s85
  s_mov_b32 s30, 4194304
  s_mov_b32 s31, 0x20000
  s_mov_b32 s12, s86
  s_mov_b32 s13, s87
  s_mov_b32 s14, 6291456
  s_mov_b32 s15, 0x20000
  s_lshl_b32 s23, s26, 18
  s_lshl_b32 s21, s26, 7
  s_add_u32 s21, s21, s23
  s_lshl_b32 s24, s27, 7
  s_mul_i32 s22, s26, 393216
  s_add_u32 s22, s22, s24
  s_mov_b32 s48, s21
  s_mov_b32 s49, s22
  s_lshr_b32 s20, s3, 1
  s_mul_i32 s20, s20, 20480
  s_and_b32 s25, s3, 1
  s_lshl_b32 s25, s25, 12
  s_add_u32 s20, s20, s25
  s_lshl_b32 s25, s3, 10
  s_add_u32 s25, s25, 8192
  s_mov_b32 s51, 0
  s_mov_b32 s48, s23
  s_mov_b32 s49, s24
  s_cmp_eq_u32 s48, s21
  s_cselect_b32 s46, 128, 0
  s_cselect_b32 s47, 393216, 0
  s_add_u32 s48, s48, s46
  s_add_u32 s49, s49, s47
  s_add_u32 m0, s51, s20
  s_nop 0
  buffer_load_dwordx4 v6, s[28:31], s48 offen lds
  s_add_u32 m0, m0, 1024
  s_nop 0
  buffer_load_dwordx4 v7, s[28:31], s48 offen lds
  s_add_u32 m0, m0, 1024
  s_nop 0
  buffer_load_dwordx4 v14, s[28:31], s48 offen lds
  s_add_u32 m0, m0, 1024
  s_nop 0
  buffer_load_dwordx4 v15, s[28:31], s48 offen lds
  s_add_u32 s48, s48, 128
  s_add_u32 m0, s51, s25
  s_add_u32 s51, s51, 20480
  buffer_load_dwordx4 v5, s[12:15], s49 offen lds
  s_add_u32 m0, m0, 4096
  s_add_u32 s47, s49, 2048
  buffer_load_dwordx4 v5, s[12:15], s47 offen lds
  s_add_u32 m0, m0, 4096
  s_add_u32 s47, s49, 4096
  buffer_load_dwordx4 v5, s[12:15], s47 offen lds
  s_add_u32 s49, s49, 196608
  s_add_u32 m0, s51, s25
  s_add_u32 s51, s51, 20480
  buffer_load_dwordx4 v5, s[12:15], s49 offen lds
  s_add_u32 m0, m0, 4096
  s_add_u32 s47, s49, 2048
  buffer_load_dwordx4 v5, s[12:15], s47 offen lds
  s_add_u32 m0, m0, 4096
  s_add_u32 s47, s49, 4096
  buffer_load_dwordx4 v5, s[12:15], s47 offen lds
  s_add_u32 s49, s49, 196608
  s_cmp_eq_u32 s51, 122880
  s_cselect_b32 s51, 0, s51
  s_cmp_eq_u32 s48, s21
  s_cselect_b32 s46, 128, 0
  s_cselect_b32 s47, 393216, 0
  s_add_u32 s48, s48, s46
  s_add_u32 s49, s49, s47
  s_mov_b32 s23, s48
  s_mov_b32 s24, s49
  s_mov_b32 s48, s21
  s_mov_b32 s49, s22
  s_add_u32 m0, s51, s20
  s_nop 0
  buffer_load_dwordx4 v6, s[28:31], s48 offen lds
  s_add_u32 m0, m0, 1024
  s_nop 0
  buffer_load_dwordx4 v7, s[28:31], s48 offen lds
  s_add_u32 m0, m0, 1024
  s_nop 0
  buffer_load_dwordx4 v14, s[28:31], s48 offen lds
  s_add_u32 m0, m0, 1024
  s_nop 0
  buffer_load_dwordx4 v15, s[28:31], s48 offen lds
  s_add_u32 s48, s48, 128
  s_add_u32 m0, s51, s25
  s_add_u32 s51, s51, 20480
  buffer_load_dwordx4 v5, s[12:15], s49 offen lds
  s_add_u32 m0, m0, 4096
  s_add_u32 s47, s49, 2048
  buffer_load_dwordx4 v5, s[12:15], s47 offen lds
  s_add_u32 m0, m0, 4096
  s_add_u32 s47, s49, 4096
  buffer_load_dwordx4 v5, s[12:15], s47 offen lds
  s_add_u32 s49, s49, 196608
  s_add_u32 m0, s51, s25
  s_add_u32 s51, s51, 20480
  buffer_load_dwordx4 v5, s[12:15], s49 offen lds
  s_add_u32 m0, m0, 4096
  s_add_u32 s47, s49, 2048
  buffer_load_dwordx4 v5, s[12:15], s47 offen lds
  s_add_u32 m0, m0, 4096
  s_add_u32 s47, s49, 4096
  buffer_load_dwordx4 v5, s[12:15], s47 offen lds
  s_add_u32 s49, s49, 196608
  s_cmp_eq_u32 s51, 122880
  s_cselect_b32 s51, 0, s51
  s_mov_b32 s48, s23
  s_mov_b32 s49, s24
  s_mov_b32 s58, 0
  v_mov_b32 v11, 161728
  v_mov_b32 v10, 0
  ds_write_b32 v11, v10
  s_min_u32 s45, s3, 2
  s_lshl_b32 s46, s45, 4
  s_add_u32 s46, s46, s27
  s_mov_b32 s32, s86
  s_mov_b32 s33, s87
  s_mov_b32 s34, 6291456
  s_mov_b32 s36, 6144
  s_mul_i32 s42, 0, 8
  s_add_u32 s42, s42, s26
  s_mul_i32 s37, s42, 393216
  s_lshl_b32 s43, s46, 7
  s_add_u32 s37, s37, s43
  s_mov_b32 s40, 12288
  s_mul_i32 s41, s42, 12288
  s_lshl_b32 s43, s46, 8
  s_add_u32 s41, s41, s43
  s_add_u32 s41, s41, 96468992
  s_mul_i32 s42, s42, 24576
  s_add_u32 s42, s42, 98566144
  s_and_b32 s43, s46, 15
  s_mul_i32 s38, s43, 413696
  s_lshr_b32 s43, s46, 4
  s_lshl_b32 s43, s43, 12
  s_add_u32 s38, s38, s43
  s_add_u32 s38, s38, s42
  s_add_u32 s39, s38, 2048
  v_lshrrev_b32 v17, 2, v0
  v_and_b32 v18, 3, v0
  v_lshlrev_b32 v18, 3, v18
  v_lshl_add_u32 v17, v17, 7, v18
  v_bfe_u32 v18, v0, 3, 1
  v_lshrrev_b32 v19, 5, v0
  v_lshl_or_b32 v18, v19, 1, v18
  v_lshl_add_u32 v16, v18, 5, v17
  s_lshl_b32 s45, s45, 12
  s_add_u32 s45, s45, 8192
  v_add_u32 v16, s45, v16
  v_xor_b32 v17, 32, v16
  v_xor_b32 v18, 64, v16
  v_xor_b32 v19, 96, v16
  v_mov_b32 v20, 0x3f803f80
  v_mov_b32 v21, 0x3f803f80
  v_mov_b32 v22, 0x3f803f80
  v_mov_b32 v23, 0x3f803f80
  v_lshlrev_b32 v8, 4, v0
  v_and_b32 v4, 15, v0
  v_lshlrev_b32 v4, 2, v4
  s_waitcnt vmcnt(10)
  s_barrier
  s_cmp_eq_u32 s3, 3
  s_cselect_b32 s88, 155189248, s38
  s_add_u32 m0, s51, s20
  s_nop 0
  buffer_load_dwordx4 v6, s[28:31], s48 offen lds
  s_add_u32 m0, m0, 1024
  s_nop 0
  buffer_load_dwordx4 v7, s[28:31], s48 offen lds
  s_add_u32 m0, m0, 1024
  s_nop 0
  buffer_load_dwordx4 v14, s[28:31], s48 offen lds
  s_add_u32 m0, m0, 1024
  s_nop 0
  buffer_load_dwordx4 v15, s[28:31], s48 offen lds
  s_add_u32 s48, s48, 128
  s_add_u32 m0, s51, s25
  s_add_u32 s51, s51, 20480
  buffer_load_dwordx4 v5, s[12:15], s49 offen lds
  s_add_u32 m0, m0, 4096
  s_add_u32 s47, s49, 2048
  buffer_load_dwordx4 v5, s[12:15], s47 offen lds
  s_add_u32 m0, m0, 4096
  s_add_u32 s47, s49, 4096
  buffer_load_dwordx4 v5, s[12:15], s47 offen lds
  s_add_u32 s49, s49, 196608
  s_add_u32 m0, s51, s25
  s_add_u32 s51, s51, 20480
  buffer_load_dwordx4 v5, s[12:15], s49 offen lds
  s_add_u32 m0, m0, 4096
  s_add_u32 s47, s49, 2048
  buffer_load_dwordx4 v5, s[12:15], s47 offen lds
  s_add_u32 m0, m0, 4096
  s_add_u32 s47, s49, 4096
  buffer_load_dwordx4 v5, s[12:15], s47 offen lds
  s_add_u32 s49, s49, 196608
  s_cmp_eq_u32 s51, 122880
  s_cselect_b32 s51, 0, s51
  s_cmp_eq_u32 s48, s21
  s_cselect_b32 s46, 128, 0
  s_cselect_b32 s47, 393216, 0
  s_add_u32 s48, s48, s46
  s_add_u32 s49, s49, s47
  s_waitcnt vmcnt(10) lgkmcnt(0)
  s_barrier
  ds_read_b64_tr_b16 v[72:73], v16 offset:40960
  ds_read_b64_tr_b16 v[74:75], v16 offset:43008
  ds_read_b64_tr_b16 v[76:77], v17 offset:40960
  ds_read_b64_tr_b16 v[78:79], v17 offset:43008
  ds_read_b64_tr_b16 v[80:81], v18 offset:40960
  ds_read_b64_tr_b16 v[82:83], v18 offset:43008
  ds_read_b64_tr_b16 v[84:85], v19 offset:40960
  ds_read_b64_tr_b16 v[86:87], v19 offset:43008
  ds_read_b64_tr_b16 v[88:89], v16 offset:61440
  ds_read_b64_tr_b16 v[90:91], v16 offset:63488
  ds_read_b64_tr_b16 v[92:93], v17 offset:61440
  ds_read_b64_tr_b16 v[94:95], v17 offset:63488
  ds_read_b64_tr_b16 v[96:97], v18 offset:61440
  ds_read_b64_tr_b16 v[98:99], v18 offset:63488
  ds_read_b64_tr_b16 v[100:101], v19 offset:61440
  ds_read_b64_tr_b16 v[102:103], v19 offset:63488
  s_add_u32 m0, s51, s20
  s_nop 0
  buffer_load_dwordx4 v6, s[28:31], s48 offen lds
  s_add_u32 m0, m0, 1024
  s_nop 0
  buffer_load_dwordx4 v7, s[28:31], s48 offen lds
  s_add_u32 m0, m0, 1024
  s_nop 0
  buffer_load_dwordx4 v14, s[28:31], s48 offen lds
  s_add_u32 m0, m0, 1024
  s_nop 0
  buffer_load_dwordx4 v15, s[28:31], s48 offen lds
  s_add_u32 s48, s48, 128
  s_add_u32 m0, s51, s25
  s_add_u32 s51, s51, 20480
  buffer_load_dwordx4 v5, s[12:15], s49 offen lds
  s_add_u32 m0, m0, 4096
  s_add_u32 s47, s49, 2048
  buffer_load_dwordx4 v5, s[12:15], s47 offen lds
  s_add_u32 m0, m0, 4096
  s_add_u32 s47, s49, 4096
  buffer_load_dwordx4 v5, s[12:15], s47 offen lds
  s_add_u32 s49, s49, 196608
  s_add_u32 m0, s51, s25
  s_add_u32 s51, s51, 20480
  buffer_load_dwordx4 v5, s[12:15], s49 offen lds
  s_add_u32 m0, m0, 4096
  s_add_u32 s47, s49, 2048
  buffer_load_dwordx4 v5, s[12:15], s47 offen lds
  s_add_u32 m0, m0, 4096
  s_add_u32 s47, s49, 4096
  buffer_load_dwordx4 v5, s[12:15], s47 offen lds
  s_add_u32 s49, s49, 196608
  s_cmp_eq_u32 s51, 122880
  s_cselect_b32 s51, 0, s51
  s_cmp_eq_u32 s48, s21
  s_cselect_b32 s46, 128, 0
  s_cselect_b32 s47, 393216, 0
  s_add_u32 s48, s48, s46
  s_add_u32 s49, s49, s47
  s_mov_b32 s54, 97525760
  v_mov_b32 v9, 0
  buffer_load_dword v70, v9, s[16:19], s54 offen sc1
  v_and_b32 v12, 15, v0
  v_lshlrev_b32 v12, 7, v12
  s_lshr_b32 s55, s2, 3
  s_lshl_b32 s55, s55, 11
  buffer_load_dword v71, v12, s[80:83], s55 offen
  s_waitcnt vmcnt(12) lgkmcnt(0)
  s_barrier
  s_add_u32 m0, s51, s20
  s_nop 0
  buffer_load_dwordx4 v6, s[28:31], s48 offen lds
  s_add_u32 m0, m0, 1024
  s_nop 0
  buffer_load_dwordx4 v7, s[28:31], s48 offen lds
  s_add_u32 m0, m0, 1024
  s_nop 0
  buffer_load_dwordx4 v14, s[28:31], s48 offen lds
  s_add_u32 m0, m0, 1024
  s_nop 0
  buffer_load_dwordx4 v15, s[28:31], s48 offen lds
  s_add_u32 s48, s48, 128
  s_add_u32 m0, s51, s25
  s_add_u32 s51, s51, 20480
  buffer_load_dwordx4 v5, s[12:15], s49 offen lds
  s_add_u32 m0, m0, 4096
  s_add_u32 s47, s49, 2048
  buffer_load_dwordx4 v5, s[12:15], s47 offen lds
  s_add_u32 m0, m0, 4096
  s_add_u32 s47, s49, 4096
  buffer_load_dwordx4 v5, s[12:15], s47 offen lds
  s_add_u32 s49, s49, 196608
  s_add_u32 m0, s51, s25
  s_add_u32 s51, s51, 20480
  buffer_load_dwordx4 v5, s[12:15], s49 offen lds
  s_add_u32 m0, m0, 4096
  s_add_u32 s47, s49, 2048
  buffer_load_dwordx4 v5, s[12:15], s47 offen lds
  s_add_u32 m0, m0, 4096
  s_add_u32 s47, s49, 4096
  buffer_load_dwordx4 v5, s[12:15], s47 offen lds
  s_add_u32 s49, s49, 196608
  s_cmp_eq_u32 s51, 122880
  s_cselect_b32 s51, 0, s51
  s_cmp_eq_u32 s48, s21
  s_cselect_b32 s46, 128, 0
  s_cselect_b32 s47, 393216, 0
  s_add_u32 s48, s48, s46
  s_add_u32 s49, s49, s47
  v_mfma_f32_16x16x32_bf16 v[24:27], v[20:23], v[72:75], 0
  v_mfma_f32_16x16x32_bf16 v[28:31], v[20:23], v[76:79], 0
  v_mfma_f32_16x16x32_bf16 v[32:35], v[20:23], v[80:83], 0
  v_mfma_f32_16x16x32_bf16 v[36:39], v[20:23], v[84:87], 0
  v_mfma_f32_16x16x32_bf16 v[24:27], v[20:23], v[88:91], v[24:27]
  v_mfma_f32_16x16x32_bf16 v[28:31], v[20:23], v[92:95], v[28:31]
  v_mfma_f32_16x16x32_bf16 v[32:35], v[20:23], v[96:99], v[32:35]
  v_mfma_f32_16x16x32_bf16 v[36:39], v[20:23], v[100:103], v[36:39]
  s_mov_b64 exec, 0xffff
  s_nop 3
  buffer_store_dword v24, v4, s[16:19], s41 offen offset:0 sc1
  buffer_store_dword v28, v4, s[16:19], s41 offen offset:64 sc1
  buffer_store_dword v32, v4, s[16:19], s41 offen offset:128 sc1
  buffer_store_dword v36, v4, s[16:19], s41 offen offset:192 sc1
  s_mov_b64 exec, -1
  s_waitcnt vmcnt(16) lgkmcnt(0)
  s_barrier
  s_add_u32 m0, s51, s20
  s_nop 0
  buffer_load_dwordx4 v6, s[28:31], s48 offen lds
  s_add_u32 m0, m0, 1024
  s_nop 0
  buffer_load_dwordx4 v7, s[28:31], s48 offen lds
  s_add_u32 m0, m0, 1024
  s_nop 0
  buffer_load_dwordx4 v14, s[28:31], s48 offen lds
  s_add_u32 m0, m0, 1024
  s_nop 0
  buffer_load_dwordx4 v15, s[28:31], s48 offen lds
  s_add_u32 s48, s48, 128
  s_add_u32 m0, s51, s25
  s_add_u32 s51, s51, 20480
  buffer_load_dwordx4 v5, s[12:15], s49 offen lds
  s_add_u32 m0, m0, 4096
  s_add_u32 s47, s49, 2048
  buffer_load_dwordx4 v5, s[12:15], s47 offen lds
  s_add_u32 m0, m0, 4096
  s_add_u32 s47, s49, 4096
  buffer_load_dwordx4 v5, s[12:15], s47 offen lds
  s_add_u32 s49, s49, 196608
  s_add_u32 m0, s51, s25
  s_add_u32 s51, s51, 20480
  buffer_load_dwordx4 v5, s[12:15], s49 offen lds
  s_add_u32 m0, m0, 4096
  s_add_u32 s47, s49, 2048
  buffer_load_dwordx4 v5, s[12:15], s47 offen lds
  s_add_u32 m0, m0, 4096
  s_add_u32 s47, s49, 4096
  buffer_load_dwordx4 v5, s[12:15], s47 offen lds
  s_add_u32 s49, s49, 196608
  s_cmp_eq_u32 s51, 122880
  s_cselect_b32 s51, 0, s51
  s_cmp_eq_u32 s48, s21
  s_cselect_b32 s46, 128, 0
  s_cselect_b32 s47, 393216, 0
  s_add_u32 s48, s48, s46
  s_add_u32 s49, s49, s47
  s_waitcnt vmcnt(14) lgkmcnt(0)
  s_barrier
  s_add_u32 m0, s51, s20
  s_nop 0
  buffer_load_dwordx4 v6, s[28:31], s48 offen lds
  s_add_u32 m0, m0, 1024
  s_nop 0
  buffer_load_dwordx4 v7, s[28:31], s48 offen lds
  s_add_u32 m0, m0, 1024
  s_nop 0
  buffer_load_dwordx4 v14, s[28:31], s48 offen lds
  s_add_u32 m0, m0, 1024
  s_nop 0
  buffer_load_dwordx4 v15, s[28:31], s48 offen lds
  s_add_u32 s48, s48, 128
  s_add_u32 m0, s51, s25
  s_add_u32 s51, s51, 20480
  buffer_load_dwordx4 v5, s[12:15], s49 offen lds
  s_add_u32 m0, m0, 4096
  s_add_u32 s47, s49, 2048
  buffer_load_dwordx4 v5, s[12:15], s47 offen lds
  s_add_u32 m0, m0, 4096
  s_add_u32 s47, s49, 4096
  buffer_load_dwordx4 v5, s[12:15], s47 offen lds
  s_add_u32 s49, s49, 196608
  s_add_u32 m0, s51, s25
  s_add_u32 s51, s51, 20480
  buffer_load_dwordx4 v5, s[12:15], s49 offen lds
  s_add_u32 m0, m0, 4096
  s_add_u32 s47, s49, 2048
  buffer_load_dwordx4 v5, s[12:15], s47 offen lds
  s_add_u32 m0, m0, 4096
  s_add_u32 s47, s49, 4096
  buffer_load_dwordx4 v5, s[12:15], s47 offen lds
  s_add_u32 s49, s49, 196608
  s_cmp_eq_u32 s51, 122880
  s_cselect_b32 s51, 0, s51
  s_cmp_eq_u32 s48, s21
  s_cselect_b32 s46, 128, 0
  s_cselect_b32 s47, 393216, 0
  s_add_u32 s48, s48, s46
  s_add_u32 s49, s49, s47
  s_waitcnt vmcnt(10) lgkmcnt(0)
  s_barrier
  s_add_u32 m0, s51, s20
  s_nop 0
  buffer_load_dwordx4 v6, s[28:31], s48 offen lds
  s_add_u32 m0, m0, 1024
  s_nop 0
  buffer_load_dwordx4 v7, s[28:31], s48 offen lds
  s_add_u32 m0, m0, 1024
  s_nop 0
  buffer_load_dwordx4 v14, s[28:31], s48 offen lds
  s_add_u32 m0, m0, 1024
  s_nop 0
  buffer_load_dwordx4 v15, s[28:31], s48 offen lds
  s_add_u32 s48, s48, 128
  s_add_u32 m0, s51, s25
  s_add_u32 s51, s51, 20480
  buffer_load_dwordx4 v5, s[12:15], s49 offen lds
  s_add_u32 m0, m0, 4096
  s_add_u32 s47, s49, 2048
  buffer_load_dwordx4 v5, s[12:15], s47 offen lds
  s_add_u32 m0, m0, 4096
  s_add_u32 s47, s49, 4096
  buffer_load_dwordx4 v5, s[12:15], s47 offen lds
  s_add_u32 s49, s49, 196608
  s_add_u32 m0, s51, s25
  s_add_u32 s51, s51, 20480
  buffer_load_dwordx4 v5, s[12:15], s49 offen lds
  s_add_u32 m0, m0, 4096
  s_add_u32 s47, s49, 2048
  buffer_load_dwordx4 v5, s[12:15], s47 offen lds
  s_add_u32 m0, m0, 4096
  s_add_u32 s47, s49, 4096
  buffer_load_dwordx4 v5, s[12:15], s47 offen lds
  s_add_u32 s49, s49, 196608
  s_cmp_eq_u32 s51, 122880
  s_cselect_b32 s51, 0, s51
  s_cmp_eq_u32 s48, s21
  s_cselect_b32 s46, 128, 0
  s_cselect_b32 s47, 393216, 0
  s_add_u32 s48, s48, s46
  s_add_u32 s49, s49, s47
  s_waitcnt vmcnt(10) lgkmcnt(0)
  s_barrier
  s_add_u32 m0, s51, s20
  s_nop 0
  buffer_load_dwordx4 v6, s[28:31], s48 offen lds
  s_add_u32 m0, m0, 1024
  s_nop 0
  buffer_load_dwordx4 v7, s[28:31], s48 offen lds
  s_add_u32 m0, m0, 1024
  s_nop 0
  buffer_load_dwordx4 v14, s[28:31], s48 offen lds
  s_add_u32 m0, m0, 1024
  s_nop 0
  buffer_load_dwordx4 v15, s[28:31], s48 offen lds
  s_add_u32 s48, s48, 128
  s_add_u32 m0, s51, s25
  s_add_u32 s51, s51, 20480
  buffer_load_dwordx4 v5, s[12:15], s49 offen lds
  s_add_u32 m0, m0, 4096
  s_add_u32 s47, s49, 2048
  buffer_load_dwordx4 v5, s[12:15], s47 offen lds
  s_add_u32 m0, m0, 4096
  s_add_u32 s47, s49, 4096
  buffer_load_dwordx4 v5, s[12:15], s47 offen lds
  s_add_u32 s49, s49, 196608
  s_add_u32 m0, s51, s25
  s_add_u32 s51, s51, 20480
  buffer_load_dwordx4 v5, s[12:15], s49 offen lds
  s_add_u32 m0, m0, 4096
  s_add_u32 s47, s49, 2048
  buffer_load_dwordx4 v5, s[12:15], s47 offen lds
  s_add_u32 m0, m0, 4096
  s_add_u32 s47, s49, 4096
  buffer_load_dwordx4 v5, s[12:15], s47 offen lds
  s_add_u32 s49, s49, 196608
  s_cmp_eq_u32 s51, 122880
  s_cselect_b32 s51, 0, s51
  s_cmp_eq_u32 s48, s21
  s_cselect_b32 s46, 128, 0
  s_cselect_b32 s47, 393216, 0
  s_add_u32 s48, s48, s46
  s_add_u32 s49, s49, s47
  s_waitcnt vmcnt(10) lgkmcnt(0)
  s_barrier
  v_readfirstlane_b32 s52, v70
  s_nop 3
  s_add_u32 s52, s52, 1
  s_not_b32 s53, s52
  s_cmp_lg_u32 s3, 0
  s_cbranch_scc1 raw_nf
  s_mul_i32 s54, s26, 2048
  s_mul_i32 s55, s27, 8
  s_add_u32 s54, s54, s55
  s_add_u32 s54, s54, 97550336
  v_lshlrev_b32 v9, 7, v0
  v_mov_b32 v12, s52
  v_mov_b32 v13, s53
  s_mov_b64 exec, 65535
  buffer_store_dwordx2 v[12:13], v9, s[16:19], s54 offen sc1
  s_mov_b64 exec, -1
  s_mul_i32 s54, s27, 2048
  s_mul_i32 s55, s26, 8
  s_add_u32 s54, s54, s55
  s_add_u32 s54, s54, 97976320
  v_lshlrev_b32 v9, 7, v0
  v_mov_b32 v12, s52
  v_mov_b32 v13, s53
  s_mov_b64 exec, 65535
  buffer_store_dwordx2 v[12:13], v9, s[16:19], s54 offen sc1
  s_mov_b64 exec, -1
raw_nf:
  s_mov_b32 s50, 4
raw_lh:
  s_add_u32 m0, s51, s20
  s_nop 0
  buffer_load_dwordx4 v6, s[28:31], s48 offen lds
  s_add_u32 m0, m0, 1024
  s_nop 0
  buffer_load_dwordx4 v7, s[28:31], s48 offen lds
  s_add_u32 m0, m0, 1024
  s_nop 0
  buffer_load_dwordx4 v14, s[28:31], s48 offen lds
  s_add_u32 m0, m0, 1024
  s_nop 0
  buffer_load_dwordx4 v15, s[28:31], s48 offen lds
  s_add_u32 s48, s48, 128
  s_add_u32 m0, s51, s25
  s_add_u32 s51, s51, 20480
  buffer_load_dwordx4 v5, s[12:15], s49 offen lds
  s_add_u32 m0, m0, 4096
  s_add_u32 s47, s49, 2048
  buffer_load_dwordx4 v5, s[12:15], s47 offen lds
  s_add_u32 m0, m0, 4096
  s_add_u32 s47, s49, 4096
  buffer_load_dwordx4 v5, s[12:15], s47 offen lds
  s_add_u32 s49, s49, 196608
  s_add_u32 m0, s51, s25
  s_add_u32 s51, s51, 20480
  buffer_load_dwordx4 v5, s[12:15], s49 offen lds
  s_add_u32 m0, m0, 4096
  s_add_u32 s47, s49, 2048
  buffer_load_dwordx4 v5, s[12:15], s47 offen lds
  s_add_u32 m0, m0, 4096
  s_add_u32 s47, s49, 4096
  buffer_load_dwordx4 v5, s[12:15], s47 offen lds
  s_add_u32 s49, s49, 196608
  s_cmp_eq_u32 s51, 122880
  s_cselect_b32 s51, 0, s51
  s_cmp_eq_u32 s48, s21
  s_cselect_b32 s46, 128, 0
  s_cselect_b32 s47, 393216, 0
  s_add_u32 s48, s48, s46
  s_add_u32 s49, s49, s47
  s_waitcnt vmcnt(10)
  s_barrier
  s_sub_u32 s50, s50, 1
  s_cmp_lg_u32 s50, 0
  s_cbranch_scc1 raw_lh
  s_mul_i32 s44, s26, 2048
  s_mul_i32 s55, s27, 128
  s_add_u32 s44, s44, s55
  s_add_u32 s44, s44, 97550336
  s_mul_i32 s45, s27, 2048
  s_mul_i32 s55, s26, 128
  s_add_u32 s45, s45, s55
  s_add_u32 s45, s45, 97976320
  s_add_u32 m0, s51, s20
  s_nop 0
  buffer_load_dwordx4 v6, s[28:31], s48 offen lds
  s_add_u32 m0, m0, 1024
  s_nop 0
  buffer_load_dwordx4 v7, s[28:31], s48 offen lds
  s_add_u32 m0, m0, 1024
  s_nop 0
  buffer_load_dwordx4 v14, s[28:31], s48 offen lds
  s_add_u32 m0, m0, 1024
  s_nop 0
  buffer_load_dwordx4 v15, s[28:31], s48 offen lds
  s_add_u32 s48, s48, 128
  s_add_u32 m0, s51, s25
  s_add_u32 s51, s51, 20480
  buffer_load_dwordx4 v5, s[12:15], s49 offen lds
  s_add_u32 m0, m0, 4096
  s_add_u32 s47, s49, 2048
  buffer_load_dwordx4 v5, s[12:15], s47 offen lds
  s_add_u32 m0, m0, 4096
  s_add_u32 s47, s49, 4096
  buffer_load_dwordx4 v5, s[12:15], s47 offen lds
  s_add_u32 s49, s49, 196608
  s_add_u32 m0, s51, s25
  s_add_u32 s51, s51, 20480
  buffer_load_dwordx4 v5, s[12:15], s49 offen lds
  s_add_u32 m0, m0, 4096
  s_add_u32 s47, s49, 2048
  buffer_load_dwordx4 v5, s[12:15], s47 offen lds
  s_add_u32 m0, m0, 4096
  s_add_u32 s47, s49, 4096
  buffer_load_dwordx4 v5, s[12:15], s47 offen lds
  s_add_u32 s49, s49, 196608
  s_cmp_eq_u32 s51, 122880
  s_cselect_b32 s51, 0, s51
  s_cmp_eq_u32 s48, s21
  s_cselect_b32 s46, 128, 0
  s_cselect_b32 s47, 393216, 0
  s_add_u32 s48, s48, s46
  s_add_u32 s49, s49, s47
  s_waitcnt vmcnt(10) lgkmcnt(0)
  s_barrier
  s_add_u32 m0, s51, s20
  s_nop 0
  buffer_load_dwordx4 v6, s[28:31], s48 offen lds
  s_add_u32 m0, m0, 1024
  s_nop 0
  buffer_load_dwordx4 v7, s[28:31], s48 offen lds
  s_add_u32 m0, m0, 1024
  s_nop 0
  buffer_load_dwordx4 v14, s[28:31], s48 offen lds
  s_add_u32 m0, m0, 1024
  s_nop 0
  buffer_load_dwordx4 v15, s[28:31], s48 offen lds
  s_add_u32 s48, s48, 128
  s_add_u32 m0, s51, s25
  s_add_u32 s51, s51, 20480
  buffer_load_dwordx4 v5, s[12:15], s49 offen lds
  s_add_u32 m0, m0, 4096
  s_add_u32 s47, s49, 2048
  buffer_load_dwordx4 v5, s[12:15], s47 offen lds
  s_add_u32 m0, m0, 4096
  s_add_u32 s47, s49, 4096
  buffer_load_dwordx4 v5, s[12:15], s47 offen lds
  s_add_u32 s49, s49, 196608
  s_add_u32 m0, s51, s25
  s_add_u32 s51, s51, 20480
  buffer_load_dwordx4 v5, s[12:15], s49 offen lds
  s_add_u32 m0, m0, 4096
  s_add_u32 s47, s49, 2048
  buffer_load_dwordx4 v5, s[12:15], s47 offen lds
  s_add_u32 m0, m0, 4096
  s_add_u32 s47, s49, 4096
  buffer_load_dwordx4 v5, s[12:15], s47 offen lds
  s_add_u32 s49, s49, 196608
  s_cmp_eq_u32 s51, 122880
  s_cselect_b32 s51, 0, s51
  s_cmp_eq_u32 s48, s21
  s_cselect_b32 s46, 128, 0
  s_cselect_b32 s47, 393216, 0
  s_add_u32 s48, s48, s46
  s_add_u32 s49, s49, s47
  v_and_b32 v9, 15, v0
  v_lshlrev_b32 v9, 3, v9
  buffer_load_dwordx2 v[104:105], v9, s[16:19], s44 offen sc1
  buffer_load_dwordx2 v[106:107], v9, s[16:19], s45 offen sc1
  s_waitcnt vmcnt(12) lgkmcnt(0)
  s_barrier
  s_add_u32 m0, s51, s20
  s_nop 0
  buffer_load_dwordx4 v6, s[28:31], s48 offen lds
  s_add_u32 m0, m0, 1024
  s_nop 0
  buffer_load_dwordx4 v7, s[28:31], s48 offen lds
  s_add_u32 m0, m0, 1024
  s_nop 0
  buffer_load_dwordx4 v14, s[28:31], s48 offen lds
  s_add_u32 m0, m0, 1024
  s_nop 0
  buffer_load_dwordx4 v15, s[28:31], s48 offen lds
  s_add_u32 s48, s48, 128
  s_add_u32 m0, s51, s25
  s_add_u32 s51, s51, 20480
  buffer_load_dwordx4 v5, s[12:15], s49 offen lds
  s_add_u32 m0, m0, 4096
  s_add_u32 s47, s49, 2048
  buffer_load_dwordx4 v5, s[12:15], s47 offen lds
  s_add_u32 m0, m0, 4096
  s_add_u32 s47, s49, 4096
  buffer_load_dwordx4 v5, s[12:15], s47 offen lds
  s_add_u32 s49, s49, 196608
  s_add_u32 m0, s51, s25
  s_add_u32 s51, s51, 20480
  buffer_load_dwordx4 v5, s[12:15], s49 offen lds
  s_add_u32 m0, m0, 4096
  s_add_u32 s47, s49, 2048
  buffer_load_dwordx4 v5, s[12:15], s47 offen lds
  s_add_u32 m0, m0, 4096
  s_add_u32 s47, s49, 4096
  buffer_load_dwordx4 v5, s[12:15], s47 offen lds
  s_add_u32 s49, s49, 196608
  s_cmp_eq_u32 s51, 122880
  s_cselect_b32 s51, 0, s51
  s_cmp_eq_u32 s48, s21
  s_cselect_b32 s46, 128, 0
  s_cselect_b32 s47, 393216, 0
  s_add_u32 s48, s48, s46
  s_add_u32 s49, s49, s47
  s_waitcnt vmcnt(10)
  v_xor_b32 v104, s52, v104
  v_xor_b32 v105, s53, v105
  v_xor_b32 v106, s52, v106
  v_xor_b32 v107, s53, v107
  v_or_b32 v104, v104, v105
  v_or3_b32 v104, v104, v106, v107
  v_cmp_ne_u32 vcc, 0, v104
  s_cbranch_vccz raw_b_ok
  s_mov_b32 s55, 200000
  v_lshlrev_b32 v9, 3, v0
  s_mov_b64 exec, 65535
raw_a_poll:
  buffer_load_dwordx2 v[12:13], v9, s[16:19], s44 offen sc1
  s_waitcnt vmcnt(0)
  v_xor_b32 v12, s52, v12
  v_xor_b32 v13, s53, v13
  v_or_b32 v10, v12, v13
  v_cmp_ne_u32 vcc, 0, v10
  s_cbranch_vccz raw_a_ok
  s_sleep 2
  s_sub_u32 s55, s55, 1
  s_cmp_lg_u32 s55, 0
  s_cbranch_scc1 raw_a_poll
raw_a_ok:
  s_mov_b64 exec, -1
  s_mov_b32 s55, 200000
  v_lshlrev_b32 v9, 3, v0
  s_mov_b64 exec, 65535
raw_b_poll:
  buffer_load_dwordx2 v[12:13], v9, s[16:19], s45 offen sc1
  s_waitcnt vmcnt(0)
  v_xor_b32 v12, s52, v12
  v_xor_b32 v13, s53, v13
  v_or_b32 v10, v12, v13
  v_cmp_ne_u32 vcc, 0, v10
  s_cbranch_vccz raw_b_ok
  s_sleep 2
  s_sub_u32 s55, s55, 1
  s_cmp_lg_u32 s55, 0
  s_cbranch_scc1 raw_b_poll
raw_b_ok:
  s_mov_b64 exec, -1
  s_barrier
  v_and_b32 v1, 15, v0
  v_lshrrev_b32 v2, 4, v0
  v_lshlrev_b32 v3, 4, v1
  v_lshl_add_u32 v3, v2, 10, v3
  s_lshl_b32 s36, s26, 15
  s_lshl_b32 s37, s3, 8
  s_add_u32 s36, s36, s37
  s_add_u32 s36, s36, s10
  s_add_u32 s36, s36, 47185920
  buffer_load_dwordx4 v[16:19], v3, s[16:19], s36 offen sc1
  s_add_u32 s36, s36, 4096
  buffer_load_dwordx4 v[20:23], v3, s[16:19], s36 offen sc1
  s_add_u32 s36, s36, 4096
  buffer_load_dwordx4 v[24:27], v3, s[16:19], s36 offen sc1
  s_add_u32 s36, s36, 4096
  buffer_load_dwordx4 v[28:31], v3, s[16:19], s36 offen sc1
  s_add_u32 s36, s36, 4096
  buffer_load_dwordx4 v[32:35], v3, s[16:19], s36 offen sc1
  s_add_u32 s36, s36, 4096
  buffer_load_dwordx4 v[36:39], v3, s[16:19], s36 offen sc1
  s_add_u32 s36, s36, 4096
  buffer_load_dwordx4 v[40:43], v3, s[16:19], s36 offen sc1
  s_add_u32 s36, s36, 4096
  buffer_load_dwordx4 v[44:47], v3, s[16:19], s36 offen sc1
  s_min_u32 s37, s3, 2
  s_lshl_b32 s37, s37, 12
  s_lshl_b32 s38, s27, 8
  s_add_u32 s37, s37, s38
  s_add_u32 s37, s37, 96468992
  v_lshlrev_b32 v13, 2, v0
  buffer_load_dword v48, v13, s[16:19], s37 offen sc1
  s_add_u32 s37, s37, 12288
  buffer_load_dword v49, v13, s[16:19], s37 offen sc1
  s_add_u32 s37, s37, 12288
  buffer_load_dword v50, v13, s[16:19], s37 offen sc1
  s_add_u32 s37, s37, 12288
  buffer_load_dword v51, v13, s[16:19], s37 offen sc1
  s_add_u32 s37, s37, 12288
  buffer_load_dword v52, v13, s[16:19], s37 offen sc1
  s_add_u32 s37, s37, 12288
  buffer_load_dword v53, v13, s[16:19], s37 offen sc1
  s_add_u32 s37, s37, 12288
  buffer_load_dword v54, v13, s[16:19], s37 offen sc1
  s_add_u32 s37, s37, 12288
  buffer_load_dword v55, v13, s[16:19], s37 offen sc1
  s_add_u32 s37, s37, 12288
  buffer_load_dword v56, v13, s[16:19], s37 offen sc1
  s_add_u32 s37, s37, 12288
  buffer_load_dword v57, v13, s[16:19], s37 offen sc1
  s_add_u32 s37, s37, 12288
  buffer_load_dword v58, v13, s[16:19], s37 offen sc1
  s_add_u32 s37, s37, 12288
  buffer_load_dword v59, v13, s[16:19], s37 offen sc1
  s_add_u32 s37, s37, 12288
  buffer_load_dword v60, v13, s[16:19], s37 offen sc1
  s_add_u32 s37, s37, 12288
  buffer_load_dword v61, v13, s[16:19], s37 offen sc1
  s_add_u32 s37, s37, 12288
  buffer_load_dword v62, v13, s[16:19], s37 offen sc1
  s_add_u32 s37, s37, 12288
  buffer_load_dword v63, v13, s[16:19], s37 offen sc1
  s_waitcnt vmcnt(24)
  s_barrier
  s_lshl_b32 s38, s3, 8
  s_add_u32 s38, s38, 162816
  v_add_u32 v13, s38, v13
  s_waitcnt vmcnt(0)
  v_pk_add_f32 v[48:49], v[48:49], v[50:51]
  v_pk_add_f32 v[48:49], v[48:49], v[52:53]
  v_pk_add_f32 v[48:49], v[48:49], v[54:55]
  v_pk_add_f32 v[48:49], v[48:49], v[56:57]
  v_pk_add_f32 v[48:49], v[48:49], v[58:59]
  v_pk_add_f32 v[48:49], v[48:49], v[60:61]
  v_pk_add_f32 v[48:49], v[48:49], v[62:63]
  v_add_f32 v48, v48, v49
  ds_write_b32 v13, v48
  v_pk_add_f32 v[16:17], v[16:17], v[20:21]
  v_pk_add_f32 v[18:19], v[18:19], v[22:23]
  v_pk_add_f32 v[16:17], v[16:17], v[24:25]
  v_pk_add_f32 v[18:19], v[18:19], v[26:27]
  v_pk_add_f32 v[16:17], v[16:17], v[28:29]
  v_pk_add_f32 v[18:19], v[18:19], v[30:31]
  v_pk_add_f32 v[16:17], v[16:17], v[32:33]
  v_pk_add_f32 v[18:19], v[18:19], v[34:35]
  v_pk_add_f32 v[16:17], v[16:17], v[36:37]
  v_pk_add_f32 v[18:19], v[18:19], v[38:39]
  v_pk_add_f32 v[16:17], v[16:17], v[40:41]
  v_pk_add_f32 v[18:19], v[18:19], v[42:43]
  v_pk_add_f32 v[16:17], v[16:17], v[44:45]
  v_pk_add_f32 v[18:19], v[18:19], v[46:47]
  v_mov_b32 v20, v16
  v_mov_b32 v21, v17
  v_mov_b32 v22, v18
  v_mov_b32 v23, v19
  v_permlane32_swap_b32 v16, v20
  v_permlane32_swap_b32 v17, v21
  v_permlane32_swap_b32 v18, v22
  v_permlane32_swap_b32 v19, v23
  v_add_f32 v16, v16, v20
  v_add_f32 v17, v17, v21
  v_add_f32 v18, v18, v22
  v_add_f32 v19, v19, v23
  v_mov_b32 v20, v16
  v_mov_b32 v21, v17
  v_mov_b32 v22, v18
  v_mov_b32 v23, v19
  v_permlane16_swap_b32 v16, v20
  v_permlane16_swap_b32 v17, v21
  v_permlane16_swap_b32 v18, v22
  v_permlane16_swap_b32 v19, v23
  v_add_f32 v16, v16, v20
  v_add_f32 v17, v17, v21
  v_add_f32 v18, v18, v22
  v_add_f32 v19, v19, v23
  s_mov_b32 s36, 981467136
  s_mov_b32 s37, 925353388
  v_mul_f32 v16, s36, v16
  v_mul_f32 v17, s36, v17
  v_mul_f32 v18, s36, v18
  v_mul_f32 v19, s36, v19
  v_fma_f32 v17, -v16, v16, v17
  v_fma_f32 v19, -v18, v18, v19
  v_max_f32 v17, 0, v17
  v_max_f32 v19, 0, v19
  v_add_f32 v17, s37, v17
  v_add_f32 v19, s37, v19
  v_rsq_f32 v22, v17
  v_rsq_f32 v23, v19
  v_sub_f32 v20, 0, v16
  v_sub_f32 v21, 0, v18
  s_lshl_b32 s36, s3, 7
  s_add_u32 s36, s36, 161792
  v_lshlrev_b32 v3, 3, v1
  v_add_u32 v3, s36, v3
  ds_write_b64 v3, v[20:21]
  ds_write_b64 v3, v[22:23] offset:512
  s_waitcnt lgkmcnt(0)
  s_barrier
  s_branch main_at_l
main_c0:
  s_setprio 2
  s_sub_u32 s3, s3, 4
  s_lshr_b32 s32, s3, 1
  s_and_b32 s33, s3, 1
  v_and_b32 v1, 15, v0
  v_lshrrev_b32 v2, 4, v0
  s_mov_b32 s20, s84
  s_mov_b32 s21, s85
  s_mov_b32 s22, 4194304
  s_mov_b32 s23, 0x20000
  v_lshlrev_b32 v3, 3, v2
  v_lshl_add_u32 v3, v1, 11, v3
  s_lshr_b32 s38, s27, 1
  s_and_b32 s35, s27, 1
  s_lshl_b32 s35, s35, 2
  s_add_u32 s35, s35, s3
  s_lshl_b32 s35, s35, 2
  s_lshl_b32 s36, s26, 3
  s_add_u32 s36, s36, s38
  s_lshl_b32 s36, s36, 15
  s_lshl_b32 s37, s35, 6
  s_add_u32 s36, s36, s37
  v_mov_b32 v96, 0
  v_mov_b32 v97, 0
  v_mov_b32 v98, 0
  v_mov_b32 v99, 0
  v_mov_b32 v100, 0
  v_mov_b32 v101, 0
  v_mov_b32 v102, 0
  v_mov_b32 v103, 0
  v_mov_b32 v104, 0
  v_mov_b32 v105, 0
  v_mov_b32 v106, 0
  v_mov_b32 v107, 0
  v_mov_b32 v108, 0
  v_mov_b32 v109, 0
  v_mov_b32 v110, 0
  v_mov_b32 v111, 0
  v_mov_b32 v112, 0
  v_mov_b32 v113, 0
  v_mov_b32 v114, 0
  v_mov_b32 v115, 0
  v_mov_b32 v116, 0
  v_mov_b32 v117, 0
  v_mov_b32 v118, 0
  v_mov_b32 v119, 0
  v_mov_b32 v120, 0
  v_mov_b32 v121, 0
  v_mov_b32 v122, 0
  v_mov_b32 v123, 0
  v_mov_b32 v124, 0
  v_mov_b32 v125, 0
  v_mov_b32 v126, 0
  v_mov_b32 v127, 0
  v_mov_b32 v128, 0
  v_mov_b32 v129, 0
  v_mov_b32 v130, 0
  v_mov_b32 v131, 0
  v_mov_b32 v132, 0
  v_mov_b32 v133, 0
  v_mov_b32 v134, 0
  v_mov_b32 v135, 0
  v_mov_b32 v136, 0
  v_mov_b32 v137, 0
  v_mov_b32 v138, 0
  v_mov_b32 v139, 0
  v_mov_b32 v140, 0
  v_mov_b32 v141, 0
  v_mov_b32 v142, 0
  v_mov_b32 v143, 0
  v_mov_b32 v144, 0
  v_mov_b32 v145, 0
  v_mov_b32 v146, 0
  v_mov_b32 v147, 0
  v_mov_b32 v148, 0
  v_mov_b32 v149, 0
  v_mov_b32 v150, 0
  v_mov_b32 v151, 0
  v_mov_b32 v152, 0
  v_mov_b32 v153, 0
  v_mov_b32 v154, 0
  v_mov_b32 v155, 0
  v_mov_b32 v156, 0
  v_mov_b32 v157, 0
  v_mov_b32 v158, 0
  v_mov_b32 v159, 0
  v_mov_b32 v160, 0
  v_mov_b32 v161, 0
  v_mov_b32 v162, 0
  v_mov_b32 v163, 0
  v_mov_b32 v164, 0
  v_mov_b32 v165, 0
  v_mov_b32 v166, 0
  v_mov_b32 v167, 0
  v_mov_b32 v168, 0
  v_mov_b32 v169, 0
  v_mov_b32 v170, 0
  v_mov_b32 v171, 0
  v_mov_b32 v172, 0
  v_mov_b32 v173, 0
  v_mov_b32 v174, 0
  v_mov_b32 v175, 0
  v_mov_b32 v176, 0
  v_mov_b32 v177, 0
  v_mov_b32 v178, 0
  v_mov_b32 v179, 0
  v_mov_b32 v180, 0
  v_mov_b32 v181, 0
  v_mov_b32 v182, 0
  v_mov_b32 v183, 0
  v_mov_b32 v184, 0
  v_mov_b32 v185, 0
  v_mov_b32 v186, 0
  v_mov_b32 v187, 0
  v_mov_b32 v188, 0
  v_mov_b32 v189, 0
  v_mov_b32 v190, 0
  v_mov_b32 v191, 0
  buffer_load_dwordx2 v[200:201], v3, s[20:23], s36 offen offset:0
  buffer_load_dwordx2 v[202:203], v3, s[20:23], s36 offen offset:32
  buffer_load_dwordx2 v[204:205], v3, s[20:23], s36 offen offset:64
  buffer_load_dwordx2 v[206:207], v3, s[20:23], s36 offen offset:96
  buffer_load_dwordx2 v[208:209], v3, s[20:23], s36 offen offset:128
  buffer_load_dwordx2 v[210:211], v3, s[20:23], s36 offen offset:160
  buffer_load_dwordx2 v[212:213], v3, s[20:23], s36 offen offset:192
  buffer_load_dwordx2 v[214:215], v3, s[20:23], s36 offen offset:224
  s_lshl_b32 s37, s26, 5
  s_add_u32 s37, s37, s35
  s_lshl_b32 s36, s37, 3
  s_add_u32 s36, s36, s38
  s_lshl_b32 s36, s36, 10
  s_add_u32 s36, s36, 19922944
  s_add_u32 s36, s36, s6
  s_lshl_b32 s37, s37, 10
  s_lshl_b32 s38, s38, 7
  s_add_u32 s37, s37, s38
  s_add_u32 s37, s37, 47185920
  v_mov_b32 v224, 0x3f803f80
  v_mov_b32 v216, 0
  v_mov_b32 v217, 0
  v_mov_b32 v218, 0
  v_mov_b32 v219, 0
  v_mov_b32 v220, 0
  v_mov_b32 v221, 0
  v_mov_b32 v222, 0
  v_mov_b32 v223, 0
  v_and_b32 v3, 1, v2
  v_lshrrev_b32 v225, 1, v2
  v_lshl_add_u32 v3, v3, 1, v225
  v_lshlrev_b32 v3, 10, v3
  v_lshl_add_u32 v225, v1, 3, v3
  v_lshlrev_b32 v8, 4, v0
  v_and_b32 v1, 15, v0
  v_lshrrev_b32 v2, 4, v0
  s_lshl_b32 s34, s32, 12
  v_add_u32 v4, s34, v8
  s_lshl_b32 s34, s33, 11
  s_add_u32 s34, s34, 8192
  v_add_u32 v6, s34, v8
  v_bfe_u32 v3, v0, 2, 2
  v_lshl_add_u32 v3, v2, 3, v3
  v_and_b32 v13, 3, v0
  v_lshlrev_b32 v13, 3, v13
  v_lshl_add_u32 v14, v3, 7, v13
  v_bfe_u32 v15, v0, 3, 2
  s_lshl_b32 s34, s33, 1
  v_xor_b32 v15, s34, v15
  v_lshl_add_u32 v6, v15, 5, v14
  v_add_u32 v6, 8192, v6
  v_xor_b32 v7, 32, v6
  v_lshrrev_b32 v3, 1, v1
  v_xor_b32 v3, v3, v2
  v_lshlrev_b32 v3, 4, v3
  v_lshl_add_u32 v3, v1, 7, v3
  s_mul_i32 s34, s32, 20480
  v_add_u32 v4, s34, v3
  v_xor_b32 v5, 64, v4
  s_mov_b32 s44, 545392672
  s_mov_b32 s45, 0
  s_mov_b32 s43, 4294864896
  s_mov_b32 s41, 0
  s_barrier
  s_bitcmp1_b64 s[44:45], s41
  s_cselect_b32 s42, s43, 20480
  s_add_u32 s41, s41, 1
  ds_read_b128 v[16:19], v4 offset:0
  ds_read_b128 v[20:23], v4 offset:2048
  ds_read_b128 v[24:27], v4 offset:4096
  ds_read_b128 v[28:31], v4 offset:6144
  ds_read_b64_tr_b16 v[32:33], v6 offset:0
  ds_read_b64_tr_b16 v[34:35], v6 offset:512
  ds_read_b64_tr_b16 v[36:37], v7 offset:0
  ds_read_b64_tr_b16 v[38:39], v7 offset:512
  ds_read_b64_tr_b16 v[40:41], v6 offset:4096
  ds_read_b64_tr_b16 v[42:43], v6 offset:4608
  ds_read_b64_tr_b16 v[44:45], v7 offset:4096
  ds_read_b64_tr_b16 v[46:47], v7 offset:4608
  ds_read_b64_tr_b16 v[48:49], v6 offset:8192
  ds_read_b64_tr_b16 v[50:51], v6 offset:8704
  ds_read_b64_tr_b16 v[52:53], v7 offset:8192
  ds_read_b64_tr_b16 v[54:55], v7 offset:8704
  v_add_u32 v6, s42, v6
  v_add_u32 v7, s42, v7
  s_waitcnt lgkmcnt(0)
.p2align 6
qkvr_cloop:
  v_mfma_f32_16x16x32_bf16 v[96:99], v[32:35], v[16:19], v[96:99]
  ds_read_b128 v[56:59], v5 offset:0
  ds_read_b128 v[60:63], v5 offset:2048
  v_mfma_f32_16x16x32_bf16 v[120:123], v[32:35], v[20:23], v[120:123]
  ds_read_b128 v[64:67], v5 offset:4096
  ds_read_b128 v[68:71], v5 offset:6144
  v_mfma_f32_16x16x32_bf16 v[144:147], v[32:35], v[24:27], v[144:147]
  ds_read_b64_tr_b16 v[72:73], v6 offset:0
  v_mfma_f32_16x16x32_bf16 v[168:171], v[32:35], v[28:31], v[168:171]
  ds_read_b64_tr_b16 v[74:75], v6 offset:512
  v_mfma_f32_16x16x32_bf16 v[100:103], v[36:39], v[16:19], v[100:103]
  ds_read_b64_tr_b16 v[76:77], v7 offset:0
  v_mfma_f32_16x16x32_bf16 v[124:127], v[36:39], v[20:23], v[124:127]
  ds_read_b64_tr_b16 v[78:79], v7 offset:512
  v_mfma_f32_16x16x32_bf16 v[148:151], v[36:39], v[24:27], v[148:151]
  ds_read_b64_tr_b16 v[80:81], v6 offset:4096
  v_mfma_f32_16x16x32_bf16 v[172:175], v[36:39], v[28:31], v[172:175]
  ds_read_b64_tr_b16 v[82:83], v6 offset:4608
  v_mfma_f32_16x16x32_bf16 v[104:107], v[40:43], v[16:19], v[104:107]
  ds_read_b64_tr_b16 v[84:85], v7 offset:4096
  v_mfma_f32_16x16x32_bf16 v[128:131], v[40:43], v[20:23], v[128:131]
  ds_read_b64_tr_b16 v[86:87], v7 offset:4608
  v_mfma_f32_16x16x32_bf16 v[152:155], v[40:43], v[24:27], v[152:155]
  ds_read_b64_tr_b16 v[88:89], v6 offset:8192
  v_mfma_f32_16x16x32_bf16 v[176:179], v[40:43], v[28:31], v[176:179]
  ds_read_b64_tr_b16 v[90:91], v6 offset:8704
  v_mfma_f32_16x16x32_bf16 v[108:111], v[44:47], v[16:19], v[108:111]
  ds_read_b64_tr_b16 v[92:93], v7 offset:8192
  v_mfma_f32_16x16x32_bf16 v[132:135], v[44:47], v[20:23], v[132:135]
  ds_read_b64_tr_b16 v[94:95], v7 offset:8704
  v_mfma_f32_16x16x32_bf16 v[156:159], v[44:47], v[24:27], v[156:159]
  s_bitcmp1_b64 s[44:45], s41
  v_mfma_f32_16x16x32_bf16 v[180:183], v[44:47], v[28:31], v[180:183]
  s_cselect_b32 s42, s43, 20480
  v_mfma_f32_16x16x32_bf16 v[112:115], v[16:19], v[48:51], v[112:115]
  s_add_u32 s41, s41, 1
  v_mfma_f32_16x16x32_bf16 v[136:139], v[20:23], v[48:51], v[136:139]
  v_add_u32 v6, s42, v6
  v_mfma_f32_16x16x32_bf16 v[160:163], v[24:27], v[48:51], v[160:163]
  v_add_u32 v7, s42, v7
  v_mfma_f32_16x16x32_bf16 v[184:187], v[28:31], v[48:51], v[184:187]
  s_add_u32 s46, s42, 20480
  v_mfma_f32_16x16x32_bf16 v[116:119], v[16:19], v[52:55], v[116:119]
  v_add_u32 v4, s46, v4
  v_mfma_f32_16x16x32_bf16 v[140:143], v[20:23], v[52:55], v[140:143]
  s_cmp_eq_u32 s41, 8
  s_cbranch_scc1 prep_x
  s_cmp_lt_u32 s41, 14
  s_cbranch_scc1 qkvr_nv
  s_waitcnt vmcnt(0)
qkvr_nv:
  v_mfma_f32_16x16x32_bf16 v[164:167], v[24:27], v[52:55], v[164:167]
  s_waitcnt lgkmcnt(0)
  s_barrier
  v_mfma_f32_16x16x32_bf16 v[188:191], v[28:31], v[52:55], v[188:191]
  v_mfma_f32_16x16x32_bf16 v[96:99], v[72:75], v[56:59], v[96:99]
  ds_read_b128 v[16:19], v4 offset:0
  ds_read_b128 v[20:23], v4 offset:2048
  v_mfma_f32_16x16x32_bf16 v[120:123], v[72:75], v[60:63], v[120:123]
  ds_read_b128 v[24:27], v4 offset:4096
  ds_read_b128 v[28:31], v4 offset:6144
  v_mfma_f32_16x16x32_bf16 v[144:147], v[72:75], v[64:67], v[144:147]
  ds_read_b64_tr_b16 v[32:33], v6 offset:0
  v_mfma_f32_16x16x32_bf16 v[168:171], v[72:75], v[68:71], v[168:171]
  ds_read_b64_tr_b16 v[34:35], v6 offset:512
  v_mfma_f32_16x16x32_bf16 v[100:103], v[76:79], v[56:59], v[100:103]
  ds_read_b64_tr_b16 v[36:37], v7 offset:0
  v_mfma_f32_16x16x32_bf16 v[124:127], v[76:79], v[60:63], v[124:127]
  ds_read_b64_tr_b16 v[38:39], v7 offset:512
  v_mfma_f32_16x16x32_bf16 v[148:151], v[76:79], v[64:67], v[148:151]
  ds_read_b64_tr_b16 v[40:41], v6 offset:4096
  v_mfma_f32_16x16x32_bf16 v[172:175], v[76:79], v[68:71], v[172:175]
  ds_read_b64_tr_b16 v[42:43], v6 offset:4608
  v_mfma_f32_16x16x32_bf16 v[104:107], v[80:83], v[56:59], v[104:107]
  ds_read_b64_tr_b16 v[44:45], v7 offset:4096
  v_mfma_f32_16x16x32_bf16 v[128:131], v[80:83], v[60:63], v[128:131]
  ds_read_b64_tr_b16 v[46:47], v7 offset:4608
  v_mfma_f32_16x16x32_bf16 v[152:155], v[80:83], v[64:67], v[152:155]
  ds_read_b64_tr_b16 v[48:49], v6 offset:8192
  v_mfma_f32_16x16x32_bf16 v[176:179], v[80:83], v[68:71], v[176:179]
  ds_read_b64_tr_b16 v[50:51], v6 offset:8704
  v_mfma_f32_16x16x32_bf16 v[108:111], v[84:87], v[56:59], v[108:111]
  ds_read_b64_tr_b16 v[52:53], v7 offset:8192
  v_mfma_f32_16x16x32_bf16 v[132:135], v[84:87], v[60:63], v[132:135]
  ds_read_b64_tr_b16 v[54:55], v7 offset:8704
  v_mfma_f32_16x16x32_bf16 v[156:159], v[84:87], v[64:67], v[156:159]
  s_bitcmp1_b64 s[44:45], s41
  v_mfma_f32_16x16x32_bf16 v[180:183], v[84:87], v[68:71], v[180:183]
  s_cselect_b32 s42, s43, 20480
  v_mfma_f32_16x16x32_bf16 v[112:115], v[56:59], v[88:91], v[112:115]
  s_add_u32 s41, s41, 1
  v_mfma_f32_16x16x32_bf16 v[136:139], v[60:63], v[88:91], v[136:139]
  v_add_u32 v6, s42, v6
  v_mfma_f32_16x16x32_bf16 v[160:163], v[64:67], v[88:91], v[160:163]
  v_add_u32 v7, s42, v7
  v_mfma_f32_16x16x32_bf16 v[184:187], v[68:71], v[88:91], v[184:187]
  v_add_u32 v5, s46, v5
  v_mfma_f32_16x16x32_bf16 v[116:119], v[56:59], v[92:95], v[116:119]
  s_cmp_lt_u32 s41, 33
  v_mfma_f32_16x16x32_bf16 v[140:143], v[60:63], v[92:95], v[140:143]
  v_mfma_f32_16x16x32_bf16 v[164:167], v[64:67], v[92:95], v[164:167]
  s_waitcnt lgkmcnt(0)
  v_mfma_f32_16x16x32_bf16 v[188:191], v[68:71], v[92:95], v[188:191]
  s_cbranch_scc1 qkvr_cloop
  s_nop 7
  s_branch qkv_epi
prep_x:
  s_waitcnt vmcnt(0)
  buffer_store_dwordx4 v[200:203], v8, s[16:19], s36 offen sc1
  s_add_u32 s36, s36, 8192
  v_dot2c_f32_bf16 v216, v200, v224
  v_dot2c_f32_bf16 v220, v200, v200
  v_dot2c_f32_bf16 v216, v201, v224
  v_dot2c_f32_bf16 v220, v201, v201
  v_dot2c_f32_bf16 v216, v202, v224
  v_dot2c_f32_bf16 v220, v202, v202
  v_dot2c_f32_bf16 v216, v203, v224
  v_dot2c_f32_bf16 v220, v203, v203
  buffer_store_dwordx4 v[204:207], v8, s[16:19], s36 offen sc1
  s_add_u32 s36, s36, 8192
  v_dot2c_f32_bf16 v217, v204, v224
  v_dot2c_f32_bf16 v221, v204, v204
  v_dot2c_f32_bf16 v217, v205, v224
  v_dot2c_f32_bf16 v221, v205, v205
  v_dot2c_f32_bf16 v217, v206, v224
  v_dot2c_f32_bf16 v221, v206, v206
  v_dot2c_f32_bf16 v217, v207, v224
  v_dot2c_f32_bf16 v221, v207, v207
  buffer_store_dwordx4 v[208:211], v8, s[16:19], s36 offen sc1
  s_add_u32 s36, s36, 8192
  v_dot2c_f32_bf16 v218, v208, v224
  v_dot2c_f32_bf16 v222, v208, v208
  v_dot2c_f32_bf16 v218, v209, v224
  v_dot2c_f32_bf16 v222, v209, v209
  v_dot2c_f32_bf16 v218, v210, v224
  v_dot2c_f32_bf16 v222, v210, v210
  v_dot2c_f32_bf16 v218, v211, v224
  v_dot2c_f32_bf16 v222, v211, v211
  buffer_store_dwordx4 v[212:215], v8, s[16:19], s36 offen sc1
  s_add_u32 s36, s36, 8192
  v_dot2c_f32_bf16 v219, v212, v224
  v_dot2c_f32_bf16 v223, v212, v212
  v_dot2c_f32_bf16 v219, v213, v224
  v_dot2c_f32_bf16 v223, v213, v213
  v_dot2c_f32_bf16 v219, v214, v224
  v_dot2c_f32_bf16 v223, v214, v214
  v_dot2c_f32_bf16 v219, v215, v224
  v_dot2c_f32_bf16 v223, v215, v215
  v_permlane32_swap_b32 v216, v217
  s_nop 0
  v_permlane32_swap_b32 v218, v219
  v_permlane32_swap_b32 v220, v221
  v_permlane32_swap_b32 v222, v223
  v_add_f32 v216, v216, v217
  v_add_f32 v218, v218, v219
  v_add_f32 v220, v220, v221
  v_add_f32 v222, v222, v223
  v_permlane16_swap_b32 v216, v218
  s_nop 0
  v_permlane16_swap_b32 v220, v222
  v_add_f32 v216, v216, v218
  v_add_f32 v217, v220, v222
  buffer_store_dwordx2 v[216:217], v225, s[16:19], s37 offen sc1
  s_branch qkvr_nv
main_lay_l:
  v_lshlrev_b32 v8, 4, v0
  s_lshl_b32 s44, s3, 11
  s_mul_i32 s23, s26, 262144
  s_add_u32 s23, s23, s6
  s_add_u32 s23, s23, 19922944
  s_add_u32 s23, s23, s44
  s_lshl_b32 s21, s27, 14
  s_add_u32 s21, s21, s23
  s_mul_i32 s45, s3, 3072
  s_mul_i32 s24, s27, 413696
  s_add_u32 s24, s24, 98566144
  s_add_u32 s24, s24, s45
  s_mul_i32 s22, s27, 24576
  s_add_u32 s22, s22, s24
  s_add_u32 s45, s45, 8192
  s_mov_b32 s40, s21
  s_mov_b32 s41, s22
  s_add_u32 m0, 0, s45
  s_nop 0
  buffer_load_dwordx4 v8, s[16:19], s41 offen offset:0 sc1 lds
  buffer_load_dwordx4 v8, s[16:19], s41 offen offset:1024 sc1 lds
  buffer_load_dwordx4 v8, s[16:19], s41 offen offset:2048 sc1 lds
  s_add_u32 s41, s41, 12288
  s_add_u32 m0, 20480, s45
  s_nop 0
  buffer_load_dwordx4 v8, s[16:19], s41 offen offset:0 sc1 lds
  buffer_load_dwordx4 v8, s[16:19], s41 offen offset:1024 sc1 lds
  buffer_load_dwordx4 v8, s[16:19], s41 offen offset:2048 sc1 lds
  s_add_u32 s41, s41, 12288
  s_waitcnt vmcnt(0)
  s_barrier
  s_add_u32 s58, s58, 1
  v_mov_b32 v11, 161728
  s_cmp_lg_u32 s3, 0
  s_cbranch_scc1 qkv_nf
  s_mul_i32 s54, s26, 2048
  s_mul_i32 s55, s27, 8
  s_add_u32 s54, s54, s55
  s_add_u32 s54, s54, s11
  s_add_u32 s54, s54, 4294934528
  v_lshlrev_b32 v9, 7, v0
  v_mov_b32 v12, s52
  v_mov_b32 v13, s53
  s_mov_b64 exec, 65535
  buffer_store_dwordx2 v[12:13], v9, s[16:19], s54 offen sc1
  s_mov_b64 exec, -1
qkv_nf:
  s_cmp_lg_u32 s3, 0
  s_cbranch_scc1 qkv_wait
  s_mul_i32 s54, s26, 2048
  s_add_u32 s54, s54, s11
  s_add_u32 s54, s54, 4294934528
  s_lshl_b32 s55, s27, 7
  s_add_u32 s54, s54, s55
  s_mov_b32 s55, 200000
  v_lshlrev_b32 v9, 3, v0
  s_mov_b64 exec, 65535
  s_bitset0_b32 exec_lo, s27
qkv_poll:
  buffer_load_dwordx2 v[12:13], v9, s[16:19], s54 offen sc1
  s_waitcnt vmcnt(0)
  v_xor_b32 v12, s52, v12
  v_xor_b32 v13, s53, v13
  v_or_b32 v10, v12, v13
  v_cmp_ne_u32 vcc, 0, v10
  s_cbranch_vccz qkv_ok
  s_sleep 2
  s_sub_u32 s55, s55, 1
  s_cmp_lg_u32 s55, 0
  s_cbranch_scc1 qkv_poll
qkv_ok:
  s_mov_b64 exec, -1
  v_mov_b32 v10, s58
  ds_write_b32 v11, v10
  s_branch qkv_wl
qkv_wait:
qkv_wl:
  s_mov_b32 s41, s24
  s_cmp_eq_u32 s41, s22
  s_cselect_b32 s47, 24576, 0
  s_add_u32 s41, s41, s47
  s_add_u32 m0, 40960, s45
  s_nop 0
  buffer_load_dwordx4 v8, s[16:19], s41 offen offset:0 sc1 lds
  buffer_load_dwordx4 v8, s[16:19], s41 offen offset:1024 sc1 lds
  buffer_load_dwordx4 v8, s[16:19], s41 offen offset:2048 sc1 lds
  s_add_u32 s41, s41, 12288
  s_add_u32 m0, 61440, s45
  s_nop 0
  buffer_load_dwordx4 v8, s[16:19], s41 offen offset:0 sc1 lds
  buffer_load_dwordx4 v8, s[16:19], s41 offen offset:1024 sc1 lds
  buffer_load_dwordx4 v8, s[16:19], s41 offen offset:2048 sc1 lds
  s_add_u32 s41, s41, 12288
  s_cmp_eq_u32 s41, s22
  s_cselect_b32 s47, 24576, 0
  s_add_u32 s41, s41, s47
  s_add_u32 m0, 81920, s45
  s_nop 0
  buffer_load_dwordx4 v8, s[16:19], s41 offen offset:0 sc1 lds
  buffer_load_dwordx4 v8, s[16:19], s41 offen offset:1024 sc1 lds
  buffer_load_dwordx4 v8, s[16:19], s41 offen offset:2048 sc1 lds
  s_add_u32 s41, s41, 12288
  s_add_u32 m0, 102400, s45
  s_nop 0
  buffer_load_dwordx4 v8, s[16:19], s41 offen offset:0 sc1 lds
  buffer_load_dwordx4 v8, s[16:19], s41 offen offset:1024 sc1 lds
  buffer_load_dwordx4 v8, s[16:19], s41 offen offset:2048 sc1 lds
  s_add_u32 s41, s41, 12288
  s_cmp_eq_u32 s41, s22
  s_cselect_b32 s47, 24576, 0
  s_add_u32 s41, s41, s47
  s_cmp_eq_u32 s3, 0
  s_cbranch_scc1 qkv_go
  s_mov_b32 s55, s3
  s_cmp_lg_u32 s55, 1
  s_cbranch_scc1 qkv_np
  v_and_b32 v12, 15, v0
  v_lshlrev_b32 v12, 7, v12
  s_lshr_b32 s55, s2, 3
  s_lshl_b32 s55, s55, 11
  buffer_load_dword v71, v12, s[80:83], s55 offen
qkv_np:
  s_mov_b32 s55, 6400000
qkv_w2:
  ds_read_b32 v10, v11
  s_waitcnt lgkmcnt(0)
  v_cmp_ne_u32 vcc, s58, v10
  s_cbranch_vccz qkv_go
  s_sleep 1
  s_sub_u32 s55, s55, 1
  s_cmp_lg_u32 s55, 0
  s_cbranch_scc1 qkv_w2
qkv_go:
  s_mov_b32 s40, s23
  s_cmp_eq_u32 s40, s21
  s_cselect_b32 s47, 16384, 0
  s_add_u32 s40, s40, s47
  s_add_u32 m0, 40960, s44
  s_nop 0
  buffer_load_dwordx4 v8, s[16:19], s40 offen sc1 lds
  buffer_load_dwordx4 v8, s[16:19], s40 offen offset:1024 sc1 lds
  s_add_u32 s40, s40, 8192
  s_add_u32 m0, 61440, s44
  s_nop 0
  buffer_load_dwordx4 v8, s[16:19], s40 offen sc1 lds
  buffer_load_dwordx4 v8, s[16:19], s40 offen offset:1024 sc1 lds
  s_add_u32 s40, s40, 8192
  s_cmp_eq_u32 s40, s21
  s_cselect_b32 s47, 16384, 0
  s_add_u32 s40, s40, s47
  s_add_u32 m0, 81920, s44
  s_nop 0
  buffer_load_dwordx4 v8, s[16:19], s40 offen sc1 lds
  buffer_load_dwordx4 v8, s[16:19], s40 offen offset:1024 sc1 lds
  s_add_u32 s40, s40, 8192
  s_add_u32 m0, 102400, s44
  s_nop 0
  buffer_load_dwordx4 v8, s[16:19], s40 offen sc1 lds
  buffer_load_dwordx4 v8, s[16:19], s40 offen offset:1024 sc1 lds
  s_add_u32 s40, s40, 8192
  s_cmp_eq_u32 s40, s21
  s_cselect_b32 s47, 16384, 0
  s_add_u32 s40, s40, s47
  s_mov_b32 s43, 122880
  s_waitcnt vmcnt(4)
  s_barrier
  s_mov_b32 s50, 13
  s_add_u32 m0, s43, s45
  s_branch qkv_lbody
qkv_lhead:
  s_waitcnt vmcnt(10)
  s_barrier
qkv_lbody:
  buffer_load_dwordx4 v8, s[16:19], s41 offen offset:0 sc1 lds
  buffer_load_dwordx4 v8, s[16:19], s41 offen offset:1024 sc1 lds
  buffer_load_dwordx4 v8, s[16:19], s41 offen offset:2048 sc1 lds
  s_add_u32 s41, s41, 12288
  s_add_u32 m0, s43, s44
  s_nop 0
  buffer_load_dwordx4 v8, s[16:19], s40 offen sc1 lds
  buffer_load_dwordx4 v8, s[16:19], s40 offen offset:1024 sc1 lds
  s_add_u32 s40, s40, 8192
  s_add_u32 s43, s43, 20480
  s_cmp_eq_u32 s43, 143360
  s_cselect_b32 s43, 0, s43
  s_add_u32 m0, s43, s45
  s_nop 0
  buffer_load_dwordx4 v8, s[16:19], s41 offen offset:0 sc1 lds
  buffer_load_dwordx4 v8, s[16:19], s41 offen offset:1024 sc1 lds
  buffer_load_dwordx4 v8, s[16:19], s41 offen offset:2048 sc1 lds
  s_add_u32 s41, s41, 12288
  s_add_u32 m0, s43, s44
  s_nop 0
  buffer_load_dwordx4 v8, s[16:19], s40 offen sc1 lds
  buffer_load_dwordx4 v8, s[16:19], s40 offen offset:1024 sc1 lds
  s_add_u32 s40, s40, 8192
  s_add_u32 s43, s43, 20480
  s_cmp_eq_u32 s43, 143360
  s_cselect_b32 s43, 0, s43
  s_cmp_eq_u32 s41, s22
  s_cselect_b32 s47, 24576, 0
  s_add_u32 s41, s41, s47
  s_cmp_eq_u32 s40, s21
  s_cselect_b32 s47, 16384, 0
  s_add_u32 s40, s40, s47
  s_add_u32 m0, s43, s45
  s_sub_u32 s50, s50, 1
  s_cmp_lg_u32 s50, 0
  s_cbranch_scc1 qkv_lhead
  v_and_b32 v1, 15, v0
  v_lshrrev_b32 v2, 4, v0
  v_lshlrev_b32 v3, 4, v1
  v_lshl_add_u32 v3, v2, 10, v3
  s_lshl_b32 s36, s26, 15
  s_lshl_b32 s37, s3, 8
  s_add_u32 s36, s36, s37
  s_add_u32 s36, s36, s10
  s_add_u32 s36, s36, 47185920
  buffer_load_dwordx4 v[16:19], v3, s[16:19], s36 offen sc1
  s_add_u32 s36, s36, 4096
  buffer_load_dwordx4 v[20:23], v3, s[16:19], s36 offen sc1
  s_add_u32 s36, s36, 4096
  buffer_load_dwordx4 v[24:27], v3, s[16:19], s36 offen sc1
  s_add_u32 s36, s36, 4096
  buffer_load_dwordx4 v[28:31], v3, s[16:19], s36 offen sc1
  s_add_u32 s36, s36, 4096
  buffer_load_dwordx4 v[32:35], v3, s[16:19], s36 offen sc1
  s_add_u32 s36, s36, 4096
  buffer_load_dwordx4 v[36:39], v3, s[16:19], s36 offen sc1
  s_add_u32 s36, s36, 4096
  buffer_load_dwordx4 v[40:43], v3, s[16:19], s36 offen sc1
  s_add_u32 s36, s36, 4096
  buffer_load_dwordx4 v[44:47], v3, s[16:19], s36 offen sc1
  s_min_u32 s37, s3, 2
  s_lshl_b32 s37, s37, 12
  s_lshl_b32 s38, s27, 8
  s_add_u32 s37, s37, s38
  s_add_u32 s37, s37, 96468992
  v_lshlrev_b32 v13, 2, v0
  buffer_load_dword v48, v13, s[16:19], s37 offen sc1
  s_add_u32 s37, s37, 12288
  buffer_load_dword v49, v13, s[16:19], s37 offen sc1
  s_add_u32 s37, s37, 12288
  buffer_load_dword v50, v13, s[16:19], s37 offen sc1
  s_add_u32 s37, s37, 12288
  buffer_load_dword v51, v13, s[16:19], s37 offen sc1
  s_add_u32 s37, s37, 12288
  buffer_load_dword v52, v13, s[16:19], s37 offen sc1
  s_add_u32 s37, s37, 12288
  buffer_load_dword v53, v13, s[16:19], s37 offen sc1
  s_add_u32 s37, s37, 12288
  buffer_load_dword v54, v13, s[16:19], s37 offen sc1
  s_add_u32 s37, s37, 12288
  buffer_load_dword v55, v13, s[16:19], s37 offen sc1
  s_add_u32 s37, s37, 12288
  buffer_load_dword v56, v13, s[16:19], s37 offen sc1
  s_add_u32 s37, s37, 12288
  buffer_load_dword v57, v13, s[16:19], s37 offen sc1
  s_add_u32 s37, s37, 12288
  buffer_load_dword v58, v13, s[16:19], s37 offen sc1
  s_add_u32 s37, s37, 12288
  buffer_load_dword v59, v13, s[16:19], s37 offen sc1
  s_add_u32 s37, s37, 12288
  buffer_load_dword v60, v13, s[16:19], s37 offen sc1
  s_add_u32 s37, s37, 12288
  buffer_load_dword v61, v13, s[16:19], s37 offen sc1
  s_add_u32 s37, s37, 12288
  buffer_load_dword v62, v13, s[16:19], s37 offen sc1
  s_add_u32 s37, s37, 12288
  buffer_load_dword v63, v13, s[16:19], s37 offen sc1
  s_waitcnt vmcnt(34)
  s_barrier
  s_waitcnt vmcnt(24)
  s_barrier
  s_lshl_b32 s38, s3, 8
  s_add_u32 s38, s38, 162816
  v_add_u32 v13, s38, v13
  s_waitcnt vmcnt(0)
  v_pk_add_f32 v[48:49], v[48:49], v[50:51]
  v_pk_add_f32 v[48:49], v[48:49], v[52:53]
  v_pk_add_f32 v[48:49], v[48:49], v[54:55]
  v_pk_add_f32 v[48:49], v[48:49], v[56:57]
  v_pk_add_f32 v[48:49], v[48:49], v[58:59]
  v_pk_add_f32 v[48:49], v[48:49], v[60:61]
  v_pk_add_f32 v[48:49], v[48:49], v[62:63]
  v_add_f32 v48, v48, v49
  ds_write_b32 v13, v48
  v_pk_add_f32 v[16:17], v[16:17], v[20:21]
  v_pk_add_f32 v[18:19], v[18:19], v[22:23]
  v_pk_add_f32 v[16:17], v[16:17], v[24:25]
  v_pk_add_f32 v[18:19], v[18:19], v[26:27]
  v_pk_add_f32 v[16:17], v[16:17], v[28:29]
  v_pk_add_f32 v[18:19], v[18:19], v[30:31]
  v_pk_add_f32 v[16:17], v[16:17], v[32:33]
  v_pk_add_f32 v[18:19], v[18:19], v[34:35]
  v_pk_add_f32 v[16:17], v[16:17], v[36:37]
  v_pk_add_f32 v[18:19], v[18:19], v[38:39]
  v_pk_add_f32 v[16:17], v[16:17], v[40:41]
  v_pk_add_f32 v[18:19], v[18:19], v[42:43]
  v_pk_add_f32 v[16:17], v[16:17], v[44:45]
  v_pk_add_f32 v[18:19], v[18:19], v[46:47]
  v_mov_b32 v20, v16
  v_mov_b32 v21, v17
  v_mov_b32 v22, v18
  v_mov_b32 v23, v19
  v_permlane32_swap_b32 v16, v20
  v_permlane32_swap_b32 v17, v21
  v_permlane32_swap_b32 v18, v22
  v_permlane32_swap_b32 v19, v23
  v_add_f32 v16, v16, v20
  v_add_f32 v17, v17, v21
  v_add_f32 v18, v18, v22
  v_add_f32 v19, v19, v23
  v_mov_b32 v20, v16
  v_mov_b32 v21, v17
  v_mov_b32 v22, v18
  v_mov_b32 v23, v19
  v_permlane16_swap_b32 v16, v20
  v_permlane16_swap_b32 v17, v21
  v_permlane16_swap_b32 v18, v22
  v_permlane16_swap_b32 v19, v23
  v_add_f32 v16, v16, v20
  v_add_f32 v17, v17, v21
  v_add_f32 v18, v18, v22
  v_add_f32 v19, v19, v23
  s_mov_b32 s36, 981467136
  s_mov_b32 s37, 925353388
  v_mul_f32 v16, s36, v16
  v_mul_f32 v17, s36, v17
  v_mul_f32 v18, s36, v18
  v_mul_f32 v19, s36, v19
  v_fma_f32 v17, -v16, v16, v17
  v_fma_f32 v19, -v18, v18, v19
  v_max_f32 v17, 0, v17
  v_max_f32 v19, 0, v19
  v_add_f32 v17, s37, v17
  v_add_f32 v19, s37, v19
  v_rsq_f32 v22, v17
  v_rsq_f32 v23, v19
  v_sub_f32 v20, 0, v16
  v_sub_f32 v21, 0, v18
  s_lshl_b32 s36, s3, 7
  s_add_u32 s36, s36, 161792
  v_lshlrev_b32 v3, 3, v1
  v_add_u32 v3, s36, v3
  ds_write_b64 v3, v[20:21]
  ds_write_b64 v3, v[22:23] offset:512
  s_waitcnt lgkmcnt(0)
  s_barrier
main_at_l:
  v_lshlrev_b32 v2, 4, v0
  s_lshr_b32 s28, s3, 1
  s_and_b32 s29, s3, 1
  s_lshl_b32 s12, s27, 1
  s_add_u32 s12, s12, s28
  s_mul_i32 s12, s12, 282624
  s_lshl_b32 s13, s29, 13
  s_add_u32 s12, s12, s13
  s_add_u32 s12, s12, s10
  s_add_u32 s12, s12, 4194304
  s_lshl_b32 s15, s3, 13
  s_add_u32 s15, s15, 32768
  s_lshl_b32 s13, s26, 14
  s_add_u32 s13, s13, s12
  s_mov_b32 s35, 0x20000
  s_lshl_b32 s45, s3, 12
  s_add_u32 s45, s45, 131072
  s_cmp_lt_u32 s2, 32
  s_cbranch_scc1 at_pk_wo
  s_cmp_lt_u32 s2, 144
  s_cbranch_scc1 at_pk_w1
  s_sub_u32 s46, s2, 144
  s_lshr_b32 s47, s46, 4
  s_and_b32 s46, s46, 15
  s_mov_b32 s32, s62
  s_mov_b32 s33, s63
  s_mov_b32 s34, 7340032
  s_mov_b32 s36, 2048
  s_mul_i32 s42, s47, 4
  s_add_u32 s42, s42, s3
  s_mul_i32 s37, s42, 262144
  s_lshl_b32 s43, s46, 7
  s_add_u32 s37, s37, s43
  s_mov_b32 s40, 4096
  s_mov_b32 s41, 0
  s_mul_i32 s42, s42, 16384
  s_add_u32 s42, s42, 117440512
  s_mul_i32 s38, s46, 479232
  s_add_u32 s38, s38, s42
  s_add_u32 s39, s38, 2048
  s_branch at_pk1
at_pk_wo:
  s_lshr_b32 s47, s2, 4
  s_and_b32 s46, s2, 15
  s_mov_b32 s32, s56
  s_mov_b32 s33, s57
  s_mov_b32 s34, 2097152
  s_mov_b32 s36, 2048
  s_mul_i32 s42, s47, 4
  s_add_u32 s42, s42, s3
  s_mul_i32 s37, s42, 262144
  s_lshl_b32 s43, s46, 7
  s_add_u32 s37, s37, s43
  s_mov_b32 s40, 4096
  s_mov_b32 s41, 0
  s_mul_i32 s42, s42, 16384
  s_add_u32 s42, s42, 105906176
  s_mul_i32 s38, s46, 151552
  s_add_u32 s38, s38, s42
  s_add_u32 s39, s38, 2048
  s_branch at_pk1
at_pk_w1:
  s_cmp_ge_u32 s2, 88
  s_cselect_b32 s47, 1, 0
  s_cselect_b32 s46, 88, 32
  s_sub_u32 s46, s2, s46
  s_mov_b32 s32, s60
  s_mov_b32 s33, s61
  s_mov_b32 s34, 7340032
  s_mov_b32 s36, 7168
  s_mul_i32 s42, s47, 4
  s_add_u32 s42, s42, s3
  s_mul_i32 s37, s42, 917504
  s_lshl_b32 s43, s46, 7
  s_add_u32 s37, s37, s43
  s_mov_b32 s40, 14336
  s_mul_i32 s41, s42, 14336
  s_lshl_b32 s43, s46, 8
  s_add_u32 s41, s41, s43
  s_add_u32 s41, s41, 96731136
  s_mul_i32 s42, s42, 57344
  s_add_u32 s42, s42, 109051904
  s_lshl_b32 s43, s46, 1
  s_mul_i32 s44, s43, 9363
  s_lshr_b32 s44, s44, 16
  s_mul_i32 s38, s44, 464896
  s_lshl_b32 s43, s43, 11
  s_add_u32 s38, s38, s43
  s_add_u32 s38, s38, s42
  s_lshl_b32 s43, s46, 1
  s_add_u32 s43, s43, 1
  s_mul_i32 s44, s43, 9363
  s_lshr_b32 s44, s44, 16
  s_mul_i32 s39, s44, 464896
  s_lshl_b32 s43, s43, 11
  s_add_u32 s39, s39, s43
  s_add_u32 s39, s39, s42
at_pk1:
  v_lshrrev_b32 v64, 3, v0
  v_mul_lo_u32 v64, s36, v64
  v_and_b32 v25, 7, v0
  v_lshrrev_b32 v26, 4, v0
  v_lshlrev_b32 v26, 1, v26
  v_xor_b32 v25, v25, v26
  v_lshl_add_u32 v64, v25, 4, v64
  s_lshl_b32 s42, s36, 3
  s_mov_b32 s43, s45
  v_lshrrev_b32 v25, 2, v0
  v_and_b32 v26, 3, v0
  v_lshlrev_b32 v26, 3, v26
  v_lshl_add_u32 v25, v25, 7, v26
  v_bfe_u32 v26, v0, 3, 2
  v_lshl_add_u32 v24, v26, 5, v25
  v_add_u32 v24, s45, v24
  v_xor_b32 v25, 32, v24
  v_xor_b32 v26, 64, v24
  v_xor_b32 v27, 96, v24
  v_mov_b32 v28, 0x3f803f80
  v_mov_b32 v29, 0x3f803f80
  v_mov_b32 v30, 0x3f803f80
  v_mov_b32 v31, 0x3f803f80
  v_mov_b32 v32, 0
  v_mov_b32 v33, 0
  v_mov_b32 v34, 0
  v_mov_b32 v35, 0
  v_mov_b32 v36, 0
  v_mov_b32 v37, 0
  v_mov_b32 v38, 0
  v_mov_b32 v39, 0
  v_mov_b32 v40, 0
  v_mov_b32 v41, 0
  v_mov_b32 v42, 0
  v_mov_b32 v43, 0
  v_mov_b32 v44, 0
  v_mov_b32 v45, 0
  v_mov_b32 v46, 0
  v_mov_b32 v47, 0
  s_barrier
  s_add_u32 s58, s58, 1
  v_mov_b32 v11, 161728
  s_cmp_lg_u32 s3, 0
  s_cbranch_scc1 at_nf
  s_mul_i32 s54, s27, 2048
  s_mul_i32 s55, s26, 8
  s_add_u32 s54, s54, s55
  s_add_u32 s54, s54, s11
  s_add_u32 s54, s54, 0
  v_lshlrev_b32 v9, 7, v0
  v_mov_b32 v12, s52
  v_mov_b32 v13, s53
  s_mov_b64 exec, 65535
  buffer_store_dwordx2 v[12:13], v9, s[16:19], s54 offen sc1
  s_mov_b64 exec, -1
at_nf:
  s_cmp_lg_u32 s3, 0
  s_cbranch_scc1 at_wait
  s_mul_i32 s54, s27, 2048
  s_add_u32 s54, s54, s11
  s_add_u32 s54, s54, 0
  s_lshl_b32 s55, s26, 7
  s_add_u32 s54, s54, s55
  s_mov_b32 s55, 200000
  v_lshlrev_b32 v9, 3, v0
  s_mov_b64 exec, 65535
  s_bitset0_b32 exec_lo, s26
at_poll:
  buffer_load_dwordx2 v[12:13], v9, s[16:19], s54 offen sc1
  s_waitcnt vmcnt(0)
  v_xor_b32 v12, s52, v12
  v_xor_b32 v13, s53, v13
  v_or_b32 v10, v12, v13
  v_cmp_ne_u32 vcc, 0, v10
  s_cbranch_vccz at_ok
  s_sleep 2
  s_sub_u32 s55, s55, 1
  s_cmp_lg_u32 s55, 0
  s_cbranch_scc1 at_poll
at_ok:
  s_mov_b64 exec, -1
  v_mov_b32 v10, s58
  ds_write_b32 v11, v10
  s_branch at_go
at_wait:
  s_mov_b32 s55, s3
  s_cmp_lg_u32 s55, 1
  s_cbranch_scc1 at_np
  v_and_b32 v12, 15, v0
  v_lshlrev_b32 v12, 7, v12
  s_lshr_b32 s55, s2, 3
  s_lshl_b32 s55, s55, 11
  buffer_load_dword v71, v12, s[80:83], s55 offen
at_np:
  s_mov_b32 s55, 6400000
at_w2:
  ds_read_b32 v10, v11
  s_waitcnt lgkmcnt(0)
  v_cmp_ne_u32 vcc, s58, v10
  s_cbranch_vccz at_go
  s_sleep 1
  s_sub_u32 s55, s55, 1
  s_cmp_lg_u32 s55, 0
  s_cbranch_scc1 at_w2
at_go:
  s_cmp_eq_u32 s12, s13
  s_cselect_b32 s14, 16384, 0
  s_add_u32 s12, s12, s14
  s_mov_b32 m0, s15
  s_add_u32 s14, s12, 4096
  buffer_load_dwordx4 v2, s[16:19], s12 offen offset:0 sc1 lds
  buffer_load_dwordx4 v2, s[16:19], s12 offen offset:1024 sc1 lds
  buffer_load_dwordx4 v2, s[16:19], s12 offen offset:2048 sc1 lds
  buffer_load_dwordx4 v2, s[16:19], s12 offen offset:3072 sc1 lds
  s_add_u32 m0, s15, 4096
  s_add_u32 s12, s12, 16384
  buffer_load_dwordx4 v2, s[16:19], s14 offen offset:0 sc1 lds
  buffer_load_dwordx4 v2, s[16:19], s14 offen offset:1024 sc1 lds
  buffer_load_dwordx4 v2, s[16:19], s14 offen offset:2048 sc1 lds
  buffer_load_dwordx4 v2, s[16:19], s14 offen offset:3072 sc1 lds
  s_add_u32 s15, s15, 32768
  s_and_b32 s15, s15, 131071
  s_cmp_eq_u32 s12, s13
  s_cselect_b32 s14, 16384, 0
  s_add_u32 s12, s12, s14
  s_mov_b32 m0, s15
  s_add_u32 s14, s12, 4096
  buffer_load_dwordx4 v2, s[16:19], s12 offen offset:0 sc1 lds
  buffer_load_dwordx4 v2, s[16:19], s12 offen offset:1024 sc1 lds
  buffer_load_dwordx4 v2, s[16:19], s12 offen offset:2048 sc1 lds
  buffer_load_dwordx4 v2, s[16:19], s12 offen offset:3072 sc1 lds
  s_add_u32 m0, s15, 4096
  s_add_u32 s12, s12, 16384
  buffer_load_dwordx4 v2, s[16:19], s14 offen offset:0 sc1 lds
  buffer_load_dwordx4 v2, s[16:19], s14 offen offset:1024 sc1 lds
  buffer_load_dwordx4 v2, s[16:19], s14 offen offset:2048 sc1 lds
  buffer_load_dwordx4 v2, s[16:19], s14 offen offset:3072 sc1 lds
  s_add_u32 s15, s15, 32768
  s_and_b32 s15, s15, 131071
  s_waitcnt vmcnt(8)
  s_barrier
  s_cmp_eq_u32 s12, s13
  s_cselect_b32 s14, 16384, 0
  s_add_u32 s12, s12, s14
  s_mov_b32 m0, s15
  s_add_u32 s14, s12, 4096
  buffer_load_dwordx4 v2, s[16:19], s12 offen offset:0 sc1 lds
  buffer_load_dwordx4 v2, s[16:19], s12 offen offset:1024 sc1 lds
  buffer_load_dwordx4 v2, s[16:19], s12 offen offset:2048 sc1 lds
  buffer_load_dwordx4 v2, s[16:19], s12 offen offset:3072 sc1 lds
  s_add_u32 m0, s15, 4096
  s_add_u32 s12, s12, 16384
  buffer_load_dwordx4 v2, s[16:19], s14 offen offset:0 sc1 lds
  buffer_load_dwordx4 v2, s[16:19], s14 offen offset:1024 sc1 lds
  buffer_load_dwordx4 v2, s[16:19], s14 offen offset:2048 sc1 lds
  buffer_load_dwordx4 v2, s[16:19], s14 offen offset:3072 sc1 lds
  s_add_u32 s15, s15, 32768
  s_and_b32 s15, s15, 131071
  s_mul_i32 s20, s27, 151552
  s_lshl_b32 s47, s3, 13
  s_add_u32 s20, s20, s47
  s_add_u32 s20, s20, 105906176
  s_cmp_eq_u32 s10, 0
  s_cbranch_scc1 at_ldpack
  s_and_b32 s48, s27, 7
  s_lshr_b32 s49, s27, 3
  s_mul_i32 s49, s49, 56
  s_mul_i32 s22, s48, 7
  s_add_u32 s22, s22, s49
  s_add_u32 s23, s22, 7
  s_cmp_le_u32 s48, 5
  s_cselect_b32 s21, 0, 10
  s_cselect_b32 s24, 46, 0
  s_add_u32 s21, s21, s49
  s_add_u32 s25, s21, 46
  s_mul_i32 s21, s21, 4096
  s_mul_i32 s22, s22, 4096
  s_mul_i32 s23, s23, 4096
  s_mul_i32 s25, s25, 4096
  s_mul_i32 s24, s24, 4096
  s_cmp_eq_u32 s21, s22
  s_cselect_b32 s21, s23, s21
  s_sub_u32 s21, s25, 135168
  s_cmp_ge_u32 s21, s22
  s_cselect_b32 s25, 28672, 0
  s_add_u32 s21, s21, s25
  s_lshl_b32 s25, s3, 10
  s_xor_b32 s30, s27, 0
  s_mul_i32 s30, s30, 479232
  s_add_u32 s30, s30, 117440512
  s_add_u32 s30, s30, s25
  s_xor_b32 s31, s27, 8
  s_mul_i32 s31, s31, 479232
  s_add_u32 s31, s31, 117440512
  s_add_u32 s31, s31, s25
  s_cmp_eq_u32 s12, s13
  s_cselect_b32 s14, 16384, 0
  s_add_u32 s12, s12, s14
  s_mov_b32 m0, s15
  s_add_u32 s14, s12, 4096
  buffer_load_dwordx4 v2, s[16:19], s12 offen offset:0 sc1 lds
  buffer_load_dwordx4 v2, s[16:19], s12 offen offset:1024 sc1 lds
  buffer_load_dwordx4 v2, s[16:19], s12 offen offset:2048 sc1 lds
  buffer_load_dwordx4 v2, s[16:19], s12 offen offset:3072 sc1 lds
  s_add_u32 m0, s15, 4096
  s_add_u32 s12, s12, 16384
  buffer_load_dwordx4 v2, s[16:19], s14 offen offset:0 sc1 lds
  buffer_load_dwordx4 v2, s[16:19], s14 offen offset:1024 sc1 lds
  buffer_load_dwordx4 v2, s[16:19], s14 offen offset:2048 sc1 lds
  buffer_load_dwordx4 v2, s[16:19], s14 offen offset:3072 sc1 lds
  s_add_u32 s15, s15, 32768
  s_and_b32 s15, s15, 131071
  s_add_u32 s25, s31, s21
  buffer_load_dwordx4 v[72:75], v2, s[16:19], s25 offen sc1
  s_add_u32 s21, s21, 4096
  s_cmp_eq_u32 s21, s22
  s_cselect_b32 s21, s23, s21
  s_add_u32 s25, s31, s21
  buffer_load_dwordx4 v[76:79], v2, s[16:19], s25 offen sc1
  s_add_u32 s21, s21, 4096
  s_cmp_eq_u32 s21, s22
  s_cselect_b32 s21, s23, s21
  s_add_u32 s25, s31, s21
  buffer_load_dwordx4 v[80:83], v2, s[16:19], s25 offen sc1
  s_add_u32 s21, s21, 4096
  s_cmp_eq_u32 s21, s22
  s_cselect_b32 s21, s23, s21
  s_add_u32 s25, s31, s21
  buffer_load_dwordx4 v[84:87], v2, s[16:19], s25 offen sc1
  s_add_u32 s21, s21, 4096
  s_cmp_eq_u32 s21, s22
  s_cselect_b32 s21, s23, s21
  s_waitcnt vmcnt(20)
  s_barrier
  s_cmp_eq_u32 s12, s13
  s_cselect_b32 s14, 16384, 0
  s_add_u32 s12, s12, s14
  s_mov_b32 m0, s15
  s_add_u32 s14, s12, 4096
  buffer_load_dwordx4 v2, s[16:19], s12 offen offset:0 sc1 lds
  buffer_load_dwordx4 v2, s[16:19], s12 offen offset:1024 sc1 lds
  buffer_load_dwordx4 v2, s[16:19], s12 offen offset:2048 sc1 lds
  buffer_load_dwordx4 v2, s[16:19], s12 offen offset:3072 sc1 lds
  s_add_u32 m0, s15, 4096
  s_add_u32 s12, s12, 16384
  buffer_load_dwordx4 v2, s[16:19], s14 offen offset:0 sc1 lds
  buffer_load_dwordx4 v2, s[16:19], s14 offen offset:1024 sc1 lds
  buffer_load_dwordx4 v2, s[16:19], s14 offen offset:2048 sc1 lds
  buffer_load_dwordx4 v2, s[16:19], s14 offen offset:3072 sc1 lds
  s_add_u32 s15, s15, 32768
  s_and_b32 s15, s15, 131071
  s_add_u32 s25, s31, s21
  buffer_load_dwordx4 v[88:91], v2, s[16:19], s25 offen sc1
  s_add_u32 s21, s21, 4096
  s_cmp_eq_u32 s21, s22
  s_cselect_b32 s21, s23, s21
  s_add_u32 s25, s31, s21
  buffer_load_dwordx4 v[92:95], v2, s[16:19], s25 offen sc1
  s_add_u32 s21, s21, 4096
  s_cmp_eq_u32 s21, s22
  s_cselect_b32 s21, s23, s21
  s_add_u32 s25, s31, s21
  buffer_load_dwordx4 v[96:99], v2, s[16:19], s25 offen sc1
  s_add_u32 s21, s21, 4096
  s_cmp_eq_u32 s21, s22
  s_cselect_b32 s21, s23, s21
  s_add_u32 s25, s31, s21
  buffer_load_dwordx4 v[100:103], v2, s[16:19], s25 offen sc1
  s_add_u32 s21, s21, 4096
  s_cmp_eq_u32 s21, s22
  s_cselect_b32 s21, s23, s21
  s_waitcnt vmcnt(24)
  s_barrier
  s_cmp_eq_u32 s12, s13
  s_cselect_b32 s14, 16384, 0
  s_add_u32 s12, s12, s14
  s_mov_b32 m0, s15
  s_add_u32 s14, s12, 4096
  buffer_load_dwordx4 v2, s[16:19], s12 offen offset:0 sc1 lds
  buffer_load_dwordx4 v2, s[16:19], s12 offen offset:1024 sc1 lds
  buffer_load_dwordx4 v2, s[16:19], s12 offen offset:2048 sc1 lds
  buffer_load_dwordx4 v2, s[16:19], s12 offen offset:3072 sc1 lds
  s_add_u32 m0, s15, 4096
  s_add_u32 s12, s12, 16384
  buffer_load_dwordx4 v2, s[16:19], s14 offen offset:0 sc1 lds
  buffer_load_dwordx4 v2, s[16:19], s14 offen offset:1024 sc1 lds
  buffer_load_dwordx4 v2, s[16:19], s14 offen offset:2048 sc1 lds
  buffer_load_dwordx4 v2, s[16:19], s14 offen offset:3072 sc1 lds
  s_add_u32 s15, s15, 32768
  s_and_b32 s15, s15, 131071
  s_add_u32 s25, s31, s21
  buffer_load_dwordx4 v[104:107], v2, s[16:19], s25 offen sc1
  s_add_u32 s21, s21, 4096
  s_cmp_eq_u32 s21, s22
  s_cselect_b32 s21, s23, s21
  s_add_u32 s25, s31, s21
  buffer_load_dwordx4 v[108:111], v2, s[16:19], s25 offen sc1
  s_add_u32 s21, s21, 4096
  s_cmp_eq_u32 s21, s22
  s_cselect_b32 s21, s23, s21
  s_add_u32 s25, s31, s21
  buffer_load_dwordx4 v[112:115], v2, s[16:19], s25 offen sc1
  s_add_u32 s21, s21, 4096
  s_cmp_eq_u32 s21, s22
  s_cselect_b32 s21, s23, s21
  s_add_u32 s25, s31, s21
  buffer_load_dwordx4 v[116:119], v2, s[16:19], s25 offen sc1
  s_add_u32 s21, s21, 4096
  s_cmp_eq_u32 s21, s22
  s_cselect_b32 s21, s23, s21
  s_waitcnt vmcnt(28)
  s_barrier
  s_cmp_eq_u32 s12, s13
  s_cselect_b32 s14, 16384, 0
  s_add_u32 s12, s12, s14
  s_mov_b32 m0, s15
  s_add_u32 s14, s12, 4096
  buffer_load_dwordx4 v2, s[16:19], s12 offen offset:0 sc1 lds
  buffer_load_dwordx4 v2, s[16:19], s12 offen offset:1024 sc1 lds
  buffer_load_dwordx4 v2, s[16:19], s12 offen offset:2048 sc1 lds
  buffer_load_dwordx4 v2, s[16:19], s12 offen offset:3072 sc1 lds
  s_add_u32 m0, s15, 4096
  s_add_u32 s12, s12, 16384
  buffer_load_dwordx4 v2, s[16:19], s14 offen offset:0 sc1 lds
  buffer_load_dwordx4 v2, s[16:19], s14 offen offset:1024 sc1 lds
  buffer_load_dwordx4 v2, s[16:19], s14 offen offset:2048 sc1 lds
  buffer_load_dwordx4 v2, s[16:19], s14 offen offset:3072 sc1 lds
  s_add_u32 s15, s15, 32768
  s_and_b32 s15, s15, 131071
  s_add_u32 s25, s31, s21
  buffer_load_dwordx4 v[120:123], v2, s[16:19], s25 offen sc1
  s_add_u32 s21, s21, 4096
  s_cmp_eq_u32 s21, s22
  s_cselect_b32 s21, s23, s21
  s_add_u32 s25, s31, s21
  buffer_load_dwordx4 v[124:127], v2, s[16:19], s25 offen sc1
  s_add_u32 s21, s21, 4096
  s_cmp_eq_u32 s21, s22
  s_cselect_b32 s21, s23, s21
  s_add_u32 s25, s31, s21
  buffer_load_dwordx4 v[128:131], v2, s[16:19], s25 offen sc1
  s_add_u32 s21, s21, 4096
  s_cmp_eq_u32 s21, s22
  s_cselect_b32 s21, s23, s21
  s_add_u32 s25, s31, s21
  buffer_load_dwordx4 v[132:135], v2, s[16:19], s25 offen sc1
  s_add_u32 s21, s21, 4096
  s_cmp_eq_u32 s21, s22
  s_cselect_b32 s21, s23, s21
  s_waitcnt vmcnt(28)
  s_barrier
  s_cmp_eq_u32 s12, s13
  s_cselect_b32 s14, 16384, 0
  s_add_u32 s12, s12, s14
  s_mov_b32 m0, s15
  s_add_u32 s14, s12, 4096
  buffer_load_dwordx4 v2, s[16:19], s12 offen offset:0 sc1 lds
  buffer_load_dwordx4 v2, s[16:19], s12 offen offset:1024 sc1 lds
  buffer_load_dwordx4 v2, s[16:19], s12 offen offset:2048 sc1 lds
  buffer_load_dwordx4 v2, s[16:19], s12 offen offset:3072 sc1 lds
  s_add_u32 m0, s15, 4096
  s_add_u32 s12, s12, 16384
  buffer_load_dwordx4 v2, s[16:19], s14 offen offset:0 sc1 lds
  buffer_load_dwordx4 v2, s[16:19], s14 offen offset:1024 sc1 lds
  buffer_load_dwordx4 v2, s[16:19], s14 offen offset:2048 sc1 lds
  buffer_load_dwordx4 v2, s[16:19], s14 offen offset:3072 sc1 lds
  s_add_u32 s15, s15, 32768
  s_and_b32 s15, s15, 131071
  s_add_u32 s25, s31, s21
  buffer_load_dwordx4 v[136:139], v2, s[16:19], s25 offen sc1
  s_add_u32 s21, s21, 4096
  s_cmp_eq_u32 s21, s22
  s_cselect_b32 s21, s23, s21
  s_add_u32 s25, s31, s21
  buffer_load_dwordx4 v[140:143], v2, s[16:19], s25 offen sc1
  s_add_u32 s21, s21, 4096
  s_cmp_eq_u32 s21, s22
  s_cselect_b32 s21, s23, s21
  s_add_u32 s25, s31, s21
  buffer_load_dwordx4 v[144:147], v2, s[16:19], s25 offen sc1
  s_add_u32 s21, s21, 4096
  s_cmp_eq_u32 s21, s22
  s_cselect_b32 s21, s23, s21
  s_add_u32 s25, s31, s21
  buffer_load_dwordx4 v[148:151], v2, s[16:19], s25 offen sc1
  s_add_u32 s21, s21, 4096
  s_cmp_eq_u32 s21, s22
  s_cselect_b32 s21, s23, s21
  s_waitcnt vmcnt(28)
  s_barrier
  s_cmp_eq_u32 s12, s13
  s_cselect_b32 s14, 16384, 0
  s_add_u32 s12, s12, s14
  s_mov_b32 m0, s15
  s_add_u32 s14, s12, 4096
  buffer_load_dwordx4 v2, s[16:19], s12 offen offset:0 sc1 lds
  buffer_load_dwordx4 v2, s[16:19], s12 offen offset:1024 sc1 lds
  buffer_load_dwordx4 v2, s[16:19], s12 offen offset:2048 sc1 lds
  buffer_load_dwordx4 v2, s[16:19], s12 offen offset:3072 sc1 lds
  s_add_u32 m0, s15, 4096
  s_add_u32 s12, s12, 16384
  buffer_load_dwordx4 v2, s[16:19], s14 offen offset:0 sc1 lds
  buffer_load_dwordx4 v2, s[16:19], s14 offen offset:1024 sc1 lds
  buffer_load_dwordx4 v2, s[16:19], s14 offen offset:2048 sc1 lds
  buffer_load_dwordx4 v2, s[16:19], s14 offen offset:3072 sc1 lds
  s_add_u32 s15, s15, 32768
  s_and_b32 s15, s15, 131071
  s_add_u32 s25, s31, s21
  buffer_load_dwordx4 v[152:155], v2, s[16:19], s25 offen sc1
  s_add_u32 s21, s21, 4096
  s_cmp_eq_u32 s21, s22
  s_cselect_b32 s21, s23, s21
  s_add_u32 s25, s31, s21
  buffer_load_dwordx4 v[156:159], v2, s[16:19], s25 offen sc1
  s_add_u32 s21, s21, 4096
  s_cmp_eq_u32 s21, s22
  s_cselect_b32 s21, s23, s21
  s_add_u32 s25, s31, s21
  buffer_load_dwordx4 v[160:163], v2, s[16:19], s25 offen sc1
  s_add_u32 s21, s21, 4096
  s_cmp_eq_u32 s21, s22
  s_cselect_b32 s21, s23, s21
  s_add_u32 s25, s31, s21
  buffer_load_dwordx4 v[164:167], v2, s[16:19], s25 offen sc1
  s_add_u32 s21, s21, 4096
  s_cmp_eq_u32 s21, s22
  s_cselect_b32 s21, s23, s21
  s_waitcnt vmcnt(28)
  s_barrier
  s_cmp_eq_u32 s12, s13
  s_cselect_b32 s14, 16384, 0
  s_add_u32 s12, s12, s14
  s_mov_b32 m0, s15
  s_add_u32 s14, s12, 4096
  buffer_load_dwordx4 v2, s[16:19], s12 offen offset:0 sc1 lds
  buffer_load_dwordx4 v2, s[16:19], s12 offen offset:1024 sc1 lds
  buffer_load_dwordx4 v2, s[16:19], s12 offen offset:2048 sc1 lds
  buffer_load_dwordx4 v2, s[16:19], s12 offen offset:3072 sc1 lds
  s_add_u32 m0, s15, 4096
  s_add_u32 s12, s12, 16384
  buffer_load_dwordx4 v2, s[16:19], s14 offen offset:0 sc1 lds
  buffer_load_dwordx4 v2, s[16:19], s14 offen offset:1024 sc1 lds
  buffer_load_dwordx4 v2, s[16:19], s14 offen offset:2048 sc1 lds
  buffer_load_dwordx4 v2, s[16:19], s14 offen offset:3072 sc1 lds
  s_add_u32 s15, s15, 32768
  s_and_b32 s15, s15, 131071
  s_add_u32 s25, s31, s21
  buffer_load_dwordx4 v[168:171], v2, s[16:19], s25 offen sc1
  s_add_u32 s21, s21, 4096
  s_cmp_eq_u32 s21, s22
  s_cselect_b32 s21, s23, s21
  s_add_u32 s25, s31, s21
  buffer_load_dwordx4 v[172:175], v2, s[16:19], s25 offen sc1
  s_add_u32 s21, s21, 4096
  s_cmp_eq_u32 s21, s22
  s_cselect_b32 s21, s23, s21
  s_add_u32 s25, s30, s24
  s_add_u32 s25, s25, 0
  buffer_load_dwordx4 v[176:179], v2, s[16:19], s25 offen sc1
  s_add_u32 s25, s30, s24
  s_add_u32 s25, s25, 4096
  buffer_load_dwordx4 v[180:183], v2, s[16:19], s25 offen sc1
  s_waitcnt vmcnt(28)
  s_barrier
  s_cmp_eq_u32 s12, s13
  s_cselect_b32 s14, 16384, 0
  s_add_u32 s12, s12, s14
  s_mov_b32 m0, s15
  s_add_u32 s14, s12, 4096
  buffer_load_dwordx4 v2, s[16:19], s12 offen offset:0 sc1 lds
  buffer_load_dwordx4 v2, s[16:19], s12 offen offset:1024 sc1 lds
  buffer_load_dwordx4 v2, s[16:19], s12 offen offset:2048 sc1 lds
  buffer_load_dwordx4 v2, s[16:19], s12 offen offset:3072 sc1 lds
  s_add_u32 m0, s15, 4096
  s_add_u32 s12, s12, 16384
  buffer_load_dwordx4 v2, s[16:19], s14 offen offset:0 sc1 lds
  buffer_load_dwordx4 v2, s[16:19], s14 offen offset:1024 sc1 lds
  buffer_load_dwordx4 v2, s[16:19], s14 offen offset:2048 sc1 lds
  buffer_load_dwordx4 v2, s[16:19], s14 offen offset:3072 sc1 lds
  s_add_u32 s15, s15, 32768
  s_and_b32 s15, s15, 131071
  s_add_u32 s25, s30, s24
  s_add_u32 s25, s25, 8192
  buffer_load_dwordx4 v[184:187], v2, s[16:19], s25 offen sc1
  s_add_u32 s25, s30, s24
  s_add_u32 s25, s25, 12288
  buffer_load_dwordx4 v[188:191], v2, s[16:19], s25 offen sc1
  s_add_u32 s25, s30, s24
  s_add_u32 s25, s25, 16384
  buffer_load_dwordx4 v[192:195], v2, s[16:19], s25 offen sc1
  s_add_u32 s25, s30, s24
  s_add_u32 s25, s25, 20480
  buffer_load_dwordx4 v[196:199], v2, s[16:19], s25 offen sc1
  s_waitcnt vmcnt(28)
  s_barrier
  s_cmp_eq_u32 s12, s13
  s_cselect_b32 s14, 16384, 0
  s_add_u32 s12, s12, s14
  s_mov_b32 m0, s15
  s_add_u32 s14, s12, 4096
  buffer_load_dwordx4 v2, s[16:19], s12 offen offset:0 sc1 lds
  buffer_load_dwordx4 v2, s[16:19], s12 offen offset:1024 sc1 lds
  buffer_load_dwordx4 v2, s[16:19], s12 offen offset:2048 sc1 lds
  buffer_load_dwordx4 v2, s[16:19], s12 offen offset:3072 sc1 lds
  s_add_u32 m0, s15, 4096
  s_add_u32 s12, s12, 16384
  buffer_load_dwordx4 v2, s[16:19], s14 offen offset:0 sc1 lds
  buffer_load_dwordx4 v2, s[16:19], s14 offen offset:1024 sc1 lds
  buffer_load_dwordx4 v2, s[16:19], s14 offen offset:2048 sc1 lds
  buffer_load_dwordx4 v2, s[16:19], s14 offen offset:3072 sc1 lds
  s_add_u32 s15, s15, 32768
  s_and_b32 s15, s15, 131071
  s_add_u32 s25, s30, s24
  s_add_u32 s25, s25, 24576
  buffer_load_dwordx4 v[200:203], v2, s[16:19], s25 offen sc1
  s_add_u32 s25, s30, s24
  s_add_u32 s25, s25, 28672
  buffer_load_dwordx4 v[204:207], v2, s[16:19], s25 offen sc1
  s_add_u32 s25, s30, s24
  s_add_u32 s25, s25, 32768
  buffer_load_dwordx4 v[208:211], v2, s[16:19], s25 offen sc1
  s_add_u32 s25, s30, s24
  s_add_u32 s25, s25, 36864
  buffer_load_dwordx4 v[212:215], v2, s[16:19], s25 offen sc1
  s_waitcnt vmcnt(28)
  s_barrier
  s_cmp_eq_u32 s12, s13
  s_cselect_b32 s14, 16384, 0
  s_add_u32 s12, s12, s14
  s_mov_b32 m0, s15
  s_add_u32 s14, s12, 4096
  buffer_load_dwordx4 v2, s[16:19], s12 offen offset:0 sc1 lds
  buffer_load_dwordx4 v2, s[16:19], s12 offen offset:1024 sc1 lds
  buffer_load_dwordx4 v2, s[16:19], s12 offen offset:2048 sc1 lds
  buffer_load_dwordx4 v2, s[16:19], s12 offen offset:3072 sc1 lds
  s_add_u32 m0, s15, 4096
  s_add_u32 s12, s12, 16384
  buffer_load_dwordx4 v2, s[16:19], s14 offen offset:0 sc1 lds
  buffer_load_dwordx4 v2, s[16:19], s14 offen offset:1024 sc1 lds
  buffer_load_dwordx4 v2, s[16:19], s14 offen offset:2048 sc1 lds
  buffer_load_dwordx4 v2, s[16:19], s14 offen offset:3072 sc1 lds
  s_add_u32 s15, s15, 32768
  s_and_b32 s15, s15, 131071
  s_add_u32 s25, s30, s24
  s_add_u32 s25, s25, 229376
  buffer_load_dwordx4 v[216:219], v2, s[16:19], s25 offen sc1
  s_add_u32 s25, s30, s24
  s_add_u32 s25, s25, 233472
  buffer_load_dwordx4 v[220:223], v2, s[16:19], s25 offen sc1
  s_add_u32 s25, s30, s24
  s_add_u32 s25, s25, 237568
  buffer_load_dwordx4 v[224:227], v2, s[16:19], s25 offen sc1
  s_add_u32 s25, s30, s24
  s_add_u32 s25, s25, 241664
  buffer_load_dwordx4 v[228:231], v2, s[16:19], s25 offen sc1
  s_waitcnt vmcnt(28)
  s_barrier
  s_cmp_eq_u32 s12, s13
  s_cselect_b32 s14, 16384, 0
  s_add_u32 s12, s12, s14
  s_mov_b32 m0, s15
  s_add_u32 s14, s12, 4096
  buffer_load_dwordx4 v2, s[16:19], s12 offen offset:0 sc1 lds
  buffer_load_dwordx4 v2, s[16:19], s12 offen offset:1024 sc1 lds
  buffer_load_dwordx4 v2, s[16:19], s12 offen offset:2048 sc1 lds
  buffer_load_dwordx4 v2, s[16:19], s12 offen offset:3072 sc1 lds
  s_add_u32 m0, s15, 4096
  s_add_u32 s12, s12, 16384
  buffer_load_dwordx4 v2, s[16:19], s14 offen offset:0 sc1 lds
  buffer_load_dwordx4 v2, s[16:19], s14 offen offset:1024 sc1 lds
  buffer_load_dwordx4 v2, s[16:19], s14 offen offset:2048 sc1 lds
  buffer_load_dwordx4 v2, s[16:19], s14 offen offset:3072 sc1 lds
  s_add_u32 s15, s15, 32768
  s_and_b32 s15, s15, 131071
  s_add_u32 s25, s30, s24
  s_add_u32 s25, s25, 245760
  buffer_load_dwordx4 v[232:235], v2, s[16:19], s25 offen sc1
  s_add_u32 s25, s30, s24
  s_add_u32 s25, s25, 249856
  buffer_load_dwordx4 v[236:239], v2, s[16:19], s25 offen sc1
  s_add_u32 s25, s30, s24
  s_add_u32 s25, s25, 253952
  buffer_load_dwordx4 v[240:243], v2, s[16:19], s25 offen sc1
  s_add_u32 s25, s30, s24
  s_add_u32 s25, s25, 258048
  buffer_load_dwordx4 v[244:247], v2, s[16:19], s25 offen sc1
  s_waitcnt vmcnt(28)
  s_barrier
  s_cmp_eq_u32 s12, s13
  s_cselect_b32 s14, 16384, 0
  s_add_u32 s12, s12, s14
  s_mov_b32 m0, s15
  s_add_u32 s14, s12, 4096
  buffer_load_dwordx4 v2, s[16:19], s12 offen offset:0 sc1 lds
  buffer_load_dwordx4 v2, s[16:19], s12 offen offset:1024 sc1 lds
  buffer_load_dwordx4 v2, s[16:19], s12 offen offset:2048 sc1 lds
  buffer_load_dwordx4 v2, s[16:19], s12 offen offset:3072 sc1 lds
  s_add_u32 m0, s15, 4096
  s_add_u32 s12, s12, 16384
  buffer_load_dwordx4 v2, s[16:19], s14 offen offset:0 sc1 lds
  buffer_load_dwordx4 v2, s[16:19], s14 offen offset:1024 sc1 lds
  buffer_load_dwordx4 v2, s[16:19], s14 offen offset:2048 sc1 lds
  buffer_load_dwordx4 v2, s[16:19], s14 offen offset:3072 sc1 lds
  s_add_u32 s15, s15, 32768
  s_and_b32 s15, s15, 131071
  s_add_u32 s25, s30, s24
  s_add_u32 s25, s25, 262144
  buffer_load_dwordx4 v[248:251], v2, s[16:19], s25 offen sc1
  s_add_u32 s25, s30, s24
  s_add_u32 s25, s25, 266240
  buffer_load_dwordx4 v[252:255], v2, s[16:19], s25 offen sc1
  s_waitcnt vmcnt(26)
  s_barrier
  s_branch at_l13
at_ldpack:
  v_add_u32 v68, s45, v2
  s_cmp_eq_u32 s12, s13
  s_cselect_b32 s14, 16384, 0
  s_add_u32 s12, s12, s14
  s_mov_b32 m0, s15
  s_add_u32 s14, s12, 4096
  buffer_load_dwordx4 v2, s[16:19], s12 offen offset:0 sc1 lds
  buffer_load_dwordx4 v2, s[16:19], s12 offen offset:1024 sc1 lds
  buffer_load_dwordx4 v2, s[16:19], s12 offen offset:2048 sc1 lds
  buffer_load_dwordx4 v2, s[16:19], s12 offen offset:3072 sc1 lds
  s_add_u32 m0, s15, 4096
  s_add_u32 s12, s12, 16384
  buffer_load_dwordx4 v2, s[16:19], s14 offen offset:0 sc1 lds
  buffer_load_dwordx4 v2, s[16:19], s14 offen offset:1024 sc1 lds
  buffer_load_dwordx4 v2, s[16:19], s14 offen offset:2048 sc1 lds
  buffer_load_dwordx4 v2, s[16:19], s14 offen offset:3072 sc1 lds
  s_add_u32 s15, s15, 32768
  s_and_b32 s15, s15, 131071
  s_mov_b32 m0, s43
  s_add_u32 s43, s43, 1024
  buffer_load_dwordx4 v64, s[32:35], s37 offen lds
  s_add_u32 s37, s37, s42
  s_mov_b32 m0, s43
  s_add_u32 s43, s43, 1024
  buffer_load_dwordx4 v64, s[32:35], s37 offen lds
  s_add_u32 s37, s37, s42
  s_mov_b32 m0, s43
  s_add_u32 s43, s43, 1024
  buffer_load_dwordx4 v64, s[32:35], s37 offen lds
  s_add_u32 s37, s37, s42
  s_mov_b32 m0, s43
  s_add_u32 s43, s43, 1024
  buffer_load_dwordx4 v64, s[32:35], s37 offen lds
  s_add_u32 s37, s37, s42
  s_mov_b32 s43, s45
  s_waitcnt vmcnt(20)
  s_barrier
  s_cmp_eq_u32 s12, s13
  s_cselect_b32 s14, 16384, 0
  s_add_u32 s12, s12, s14
  s_mov_b32 m0, s15
  s_add_u32 s14, s12, 4096
  buffer_load_dwordx4 v2, s[16:19], s12 offen offset:0 sc1 lds
  buffer_load_dwordx4 v2, s[16:19], s12 offen offset:1024 sc1 lds
  buffer_load_dwordx4 v2, s[16:19], s12 offen offset:2048 sc1 lds
  buffer_load_dwordx4 v2, s[16:19], s12 offen offset:3072 sc1 lds
  s_add_u32 m0, s15, 4096
  s_add_u32 s12, s12, 16384
  buffer_load_dwordx4 v2, s[16:19], s14 offen offset:0 sc1 lds
  buffer_load_dwordx4 v2, s[16:19], s14 offen offset:1024 sc1 lds
  buffer_load_dwordx4 v2, s[16:19], s14 offen offset:2048 sc1 lds
  buffer_load_dwordx4 v2, s[16:19], s14 offen offset:3072 sc1 lds
  s_add_u32 s15, s15, 32768
  s_and_b32 s15, s15, 131071
  buffer_store_dwordx4 v[72:75], v2, s[16:19], s88 offen offset:0 sc1
  buffer_store_dwordx4 v[76:79], v2, s[16:19], s88 offen offset:1024 sc1
  buffer_store_dwordx4 v[80:83], v2, s[16:19], s88 offen offset:2048 sc1
  buffer_store_dwordx4 v[84:87], v2, s[16:19], s88 offen offset:3072 sc1
  s_add_u32 s88, s88, 12288
  s_waitcnt vmcnt(24)
  s_barrier
  s_cmp_eq_u32 s12, s13
  s_cselect_b32 s14, 16384, 0
  s_add_u32 s12, s12, s14
  s_mov_b32 m0, s15
  s_add_u32 s14, s12, 4096
  buffer_load_dwordx4 v2, s[16:19], s12 offen offset:0 sc1 lds
  buffer_load_dwordx4 v2, s[16:19], s12 offen offset:1024 sc1 lds
  buffer_load_dwordx4 v2, s[16:19], s12 offen offset:2048 sc1 lds
  buffer_load_dwordx4 v2, s[16:19], s12 offen offset:3072 sc1 lds
  s_add_u32 m0, s15, 4096
  s_add_u32 s12, s12, 16384
  buffer_load_dwordx4 v2, s[16:19], s14 offen offset:0 sc1 lds
  buffer_load_dwordx4 v2, s[16:19], s14 offen offset:1024 sc1 lds
  buffer_load_dwordx4 v2, s[16:19], s14 offen offset:2048 sc1 lds
  buffer_load_dwordx4 v2, s[16:19], s14 offen offset:3072 sc1 lds
  s_add_u32 s15, s15, 32768
  s_and_b32 s15, s15, 131071
  s_waitcnt vmcnt(20)
  ds_read_b64_tr_b16 v[48:49], v24 offset:0
  ds_read_b64_tr_b16 v[50:51], v24 offset:2048
  ds_read_b64_tr_b16 v[52:53], v25 offset:0
  ds_read_b64_tr_b16 v[54:55], v25 offset:2048
  ds_read_b64_tr_b16 v[56:57], v26 offset:0
  ds_read_b64_tr_b16 v[58:59], v26 offset:2048
  ds_read_b64_tr_b16 v[60:61], v27 offset:0
  ds_read_b64_tr_b16 v[62:63], v27 offset:2048
  s_waitcnt lgkmcnt(0)
  buffer_store_dwordx4 v[48:51], v2, s[16:19], s38 offen offset:0 sc1
  v_mfma_f32_16x16x32_bf16 v[32:35], v[28:31], v[48:51], v[32:35]
  buffer_store_dwordx4 v[52:55], v2, s[16:19], s38 offen offset:1024 sc1
  v_mfma_f32_16x16x32_bf16 v[36:39], v[28:31], v[52:55], v[36:39]
  buffer_store_dwordx4 v[56:59], v2, s[16:19], s39 offen offset:0 sc1
  v_mfma_f32_16x16x32_bf16 v[40:43], v[28:31], v[56:59], v[40:43]
  buffer_store_dwordx4 v[60:63], v2, s[16:19], s39 offen offset:1024 sc1
  v_mfma_f32_16x16x32_bf16 v[44:47], v[28:31], v[60:63], v[44:47]
  s_add_u32 s38, s38, s40
  s_add_u32 s39, s39, s40
  s_mov_b32 m0, s43
  s_add_u32 s43, s43, 1024
  buffer_load_dwordx4 v64, s[32:35], s37 offen lds
  s_add_u32 s37, s37, s42
  s_mov_b32 m0, s43
  s_add_u32 s43, s43, 1024
  buffer_load_dwordx4 v64, s[32:35], s37 offen lds
  s_add_u32 s37, s37, s42
  s_mov_b32 m0, s43
  s_add_u32 s43, s43, 1024
  buffer_load_dwordx4 v64, s[32:35], s37 offen lds
  s_add_u32 s37, s37, s42
  s_mov_b32 m0, s43
  s_add_u32 s43, s43, 1024
  buffer_load_dwordx4 v64, s[32:35], s37 offen lds
  s_add_u32 s37, s37, s42
  s_mov_b32 s43, s45
  s_waitcnt vmcnt(28)
  s_barrier
  s_cmp_eq_u32 s12, s13
  s_cselect_b32 s14, 16384, 0
  s_add_u32 s12, s12, s14
  s_mov_b32 m0, s15
  s_add_u32 s14, s12, 4096
  buffer_load_dwordx4 v2, s[16:19], s12 offen offset:0 sc1 lds
  buffer_load_dwordx4 v2, s[16:19], s12 offen offset:1024 sc1 lds
  buffer_load_dwordx4 v2, s[16:19], s12 offen offset:2048 sc1 lds
  buffer_load_dwordx4 v2, s[16:19], s12 offen offset:3072 sc1 lds
  s_add_u32 m0, s15, 4096
  s_add_u32 s12, s12, 16384
  buffer_load_dwordx4 v2, s[16:19], s14 offen offset:0 sc1 lds
  buffer_load_dwordx4 v2, s[16:19], s14 offen offset:1024 sc1 lds
  buffer_load_dwordx4 v2, s[16:19], s14 offen offset:2048 sc1 lds
  buffer_load_dwordx4 v2, s[16:19], s14 offen offset:3072 sc1 lds
  s_add_u32 s15, s15, 32768
  s_and_b32 s15, s15, 131071
  buffer_store_dwordx4 v[88:91], v2, s[16:19], s88 offen offset:0 sc1
  buffer_store_dwordx4 v[92:95], v2, s[16:19], s88 offen offset:1024 sc1
  buffer_store_dwordx4 v[96:99], v2, s[16:19], s88 offen offset:2048 sc1
  buffer_store_dwordx4 v[100:103], v2, s[16:19], s88 offen offset:3072 sc1
  s_add_u32 s88, s88, 12288
  s_waitcnt vmcnt(32)
  s_barrier
  s_cmp_eq_u32 s12, s13
  s_cselect_b32 s14, 16384, 0
  s_add_u32 s12, s12, s14
  s_mov_b32 m0, s15
  s_add_u32 s14, s12, 4096
  buffer_load_dwordx4 v2, s[16:19], s12 offen offset:0 sc1 lds
  buffer_load_dwordx4 v2, s[16:19], s12 offen offset:1024 sc1 lds
  buffer_load_dwordx4 v2, s[16:19], s12 offen offset:2048 sc1 lds
  buffer_load_dwordx4 v2, s[16:19], s12 offen offset:3072 sc1 lds
  s_add_u32 m0, s15, 4096
  s_add_u32 s12, s12, 16384
  buffer_load_dwordx4 v2, s[16:19], s14 offen offset:0 sc1 lds
  buffer_load_dwordx4 v2, s[16:19], s14 offen offset:1024 sc1 lds
  buffer_load_dwordx4 v2, s[16:19], s14 offen offset:2048 sc1 lds
  buffer_load_dwordx4 v2, s[16:19], s14 offen offset:3072 sc1 lds
  s_add_u32 s15, s15, 32768
  s_and_b32 s15, s15, 131071
  s_waitcnt vmcnt(20)
  ds_read_b64_tr_b16 v[48:49], v24 offset:0
  ds_read_b64_tr_b16 v[50:51], v24 offset:2048
  ds_read_b64_tr_b16 v[52:53], v25 offset:0
  ds_read_b64_tr_b16 v[54:55], v25 offset:2048
  ds_read_b64_tr_b16 v[56:57], v26 offset:0
  ds_read_b64_tr_b16 v[58:59], v26 offset:2048
  ds_read_b64_tr_b16 v[60:61], v27 offset:0
  ds_read_b64_tr_b16 v[62:63], v27 offset:2048
  s_waitcnt lgkmcnt(0)
  buffer_store_dwordx4 v[48:51], v2, s[16:19], s38 offen offset:0 sc1
  v_mfma_f32_16x16x32_bf16 v[32:35], v[28:31], v[48:51], v[32:35]
  buffer_store_dwordx4 v[52:55], v2, s[16:19], s38 offen offset:1024 sc1
  v_mfma_f32_16x16x32_bf16 v[36:39], v[28:31], v[52:55], v[36:39]
  buffer_store_dwordx4 v[56:59], v2, s[16:19], s39 offen offset:0 sc1
  v_mfma_f32_16x16x32_bf16 v[40:43], v[28:31], v[56:59], v[40:43]
  buffer_store_dwordx4 v[60:63], v2, s[16:19], s39 offen offset:1024 sc1
  v_mfma_f32_16x16x32_bf16 v[44:47], v[28:31], v[60:63], v[44:47]
  s_add_u32 s38, s38, s40
  s_add_u32 s39, s39, s40
  s_mov_b32 m0, s43
  s_add_u32 s43, s43, 1024
  buffer_load_dwordx4 v64, s[32:35], s37 offen lds
  s_add_u32 s37, s37, s42
  s_mov_b32 m0, s43
  s_add_u32 s43, s43, 1024
  buffer_load_dwordx4 v64, s[32:35], s37 offen lds
  s_add_u32 s37, s37, s42
  s_mov_b32 m0, s43
  s_add_u32 s43, s43, 1024
  buffer_load_dwordx4 v64, s[32:35], s37 offen lds
  s_add_u32 s37, s37, s42
  s_mov_b32 m0, s43
  s_add_u32 s43, s43, 1024
  buffer_load_dwordx4 v64, s[32:35], s37 offen lds
  s_add_u32 s37, s37, s42
  s_mov_b32 s43, s45
  s_waitcnt vmcnt(28)
  s_barrier
  s_cmp_eq_u32 s12, s13
  s_cselect_b32 s14, 16384, 0
  s_add_u32 s12, s12, s14
  s_mov_b32 m0, s15
  s_add_u32 s14, s12, 4096
  buffer_load_dwordx4 v2, s[16:19], s12 offen offset:0 sc1 lds
  buffer_load_dwordx4 v2, s[16:19], s12 offen offset:1024 sc1 lds
  buffer_load_dwordx4 v2, s[16:19], s12 offen offset:2048 sc1 lds
  buffer_load_dwordx4 v2, s[16:19], s12 offen offset:3072 sc1 lds
  s_add_u32 m0, s15, 4096
  s_add_u32 s12, s12, 16384
  buffer_load_dwordx4 v2, s[16:19], s14 offen offset:0 sc1 lds
  buffer_load_dwordx4 v2, s[16:19], s14 offen offset:1024 sc1 lds
  buffer_load_dwordx4 v2, s[16:19], s14 offen offset:2048 sc1 lds
  buffer_load_dwordx4 v2, s[16:19], s14 offen offset:3072 sc1 lds
  s_add_u32 s15, s15, 32768
  s_and_b32 s15, s15, 131071
  s_waitcnt vmcnt(28)
  s_barrier
  s_cmp_eq_u32 s12, s13
  s_cselect_b32 s14, 16384, 0
  s_add_u32 s12, s12, s14
  s_mov_b32 m0, s15
  s_add_u32 s14, s12, 4096
  buffer_load_dwordx4 v2, s[16:19], s12 offen offset:0 sc1 lds
  buffer_load_dwordx4 v2, s[16:19], s12 offen offset:1024 sc1 lds
  buffer_load_dwordx4 v2, s[16:19], s12 offen offset:2048 sc1 lds
  buffer_load_dwordx4 v2, s[16:19], s12 offen offset:3072 sc1 lds
  s_add_u32 m0, s15, 4096
  s_add_u32 s12, s12, 16384
  buffer_load_dwordx4 v2, s[16:19], s14 offen offset:0 sc1 lds
  buffer_load_dwordx4 v2, s[16:19], s14 offen offset:1024 sc1 lds
  buffer_load_dwordx4 v2, s[16:19], s14 offen offset:2048 sc1 lds
  buffer_load_dwordx4 v2, s[16:19], s14 offen offset:3072 sc1 lds
  s_add_u32 s15, s15, 32768
  s_and_b32 s15, s15, 131071
  s_waitcnt vmcnt(16)
  ds_read_b64_tr_b16 v[48:49], v24 offset:0
  ds_read_b64_tr_b16 v[50:51], v24 offset:2048
  ds_read_b64_tr_b16 v[52:53], v25 offset:0
  ds_read_b64_tr_b16 v[54:55], v25 offset:2048
  ds_read_b64_tr_b16 v[56:57], v26 offset:0
  ds_read_b64_tr_b16 v[58:59], v26 offset:2048
  ds_read_b64_tr_b16 v[60:61], v27 offset:0
  ds_read_b64_tr_b16 v[62:63], v27 offset:2048
  s_waitcnt lgkmcnt(0)
  buffer_store_dwordx4 v[48:51], v2, s[16:19], s38 offen offset:0 sc1
  v_mfma_f32_16x16x32_bf16 v[32:35], v[28:31], v[48:51], v[32:35]
  buffer_store_dwordx4 v[52:55], v2, s[16:19], s38 offen offset:1024 sc1
  v_mfma_f32_16x16x32_bf16 v[36:39], v[28:31], v[52:55], v[36:39]
  buffer_store_dwordx4 v[56:59], v2, s[16:19], s39 offen offset:0 sc1
  v_mfma_f32_16x16x32_bf16 v[40:43], v[28:31], v[56:59], v[40:43]
  buffer_store_dwordx4 v[60:63], v2, s[16:19], s39 offen offset:1024 sc1
  v_mfma_f32_16x16x32_bf16 v[44:47], v[28:31], v[60:63], v[44:47]
  s_add_u32 s38, s38, s40
  s_add_u32 s39, s39, s40
  s_mov_b32 m0, s43
  s_add_u32 s43, s43, 1024
  buffer_load_dwordx4 v64, s[32:35], s37 offen lds
  s_add_u32 s37, s37, s42
  s_mov_b32 m0, s43
  s_add_u32 s43, s43, 1024
  buffer_load_dwordx4 v64, s[32:35], s37 offen lds
  s_add_u32 s37, s37, s42
  s_mov_b32 m0, s43
  s_add_u32 s43, s43, 1024
  buffer_load_dwordx4 v64, s[32:35], s37 offen lds
  s_add_u32 s37, s37, s42
  s_mov_b32 m0, s43
  s_add_u32 s43, s43, 1024
  buffer_load_dwordx4 v64, s[32:35], s37 offen lds
  s_add_u32 s37, s37, s42
  s_mov_b32 s43, s45
  s_waitcnt vmcnt(24)
  s_barrier
  s_cmp_eq_u32 s12, s13
  s_cselect_b32 s14, 16384, 0
  s_add_u32 s12, s12, s14
  s_mov_b32 m0, s15
  s_add_u32 s14, s12, 4096
  buffer_load_dwordx4 v2, s[16:19], s12 offen offset:0 sc1 lds
  buffer_load_dwordx4 v2, s[16:19], s12 offen offset:1024 sc1 lds
  buffer_load_dwordx4 v2, s[16:19], s12 offen offset:2048 sc1 lds
  buffer_load_dwordx4 v2, s[16:19], s12 offen offset:3072 sc1 lds
  s_add_u32 m0, s15, 4096
  s_add_u32 s12, s12, 16384
  buffer_load_dwordx4 v2, s[16:19], s14 offen offset:0 sc1 lds
  buffer_load_dwordx4 v2, s[16:19], s14 offen offset:1024 sc1 lds
  buffer_load_dwordx4 v2, s[16:19], s14 offen offset:2048 sc1 lds
  buffer_load_dwordx4 v2, s[16:19], s14 offen offset:3072 sc1 lds
  s_add_u32 s15, s15, 32768
  s_and_b32 s15, s15, 131071
  s_waitcnt vmcnt(24)
  s_barrier
  s_cmp_eq_u32 s12, s13
  s_cselect_b32 s14, 16384, 0
  s_add_u32 s12, s12, s14
  s_mov_b32 m0, s15
  s_add_u32 s14, s12, 4096
  buffer_load_dwordx4 v2, s[16:19], s12 offen offset:0 sc1 lds
  buffer_load_dwordx4 v2, s[16:19], s12 offen offset:1024 sc1 lds
  buffer_load_dwordx4 v2, s[16:19], s12 offen offset:2048 sc1 lds
  buffer_load_dwordx4 v2, s[16:19], s12 offen offset:3072 sc1 lds
  s_add_u32 m0, s15, 4096
  s_add_u32 s12, s12, 16384
  buffer_load_dwordx4 v2, s[16:19], s14 offen offset:0 sc1 lds
  buffer_load_dwordx4 v2, s[16:19], s14 offen offset:1024 sc1 lds
  buffer_load_dwordx4 v2, s[16:19], s14 offen offset:2048 sc1 lds
  buffer_load_dwordx4 v2, s[16:19], s14 offen offset:3072 sc1 lds
  s_add_u32 s15, s15, 32768
  s_and_b32 s15, s15, 131071
  s_waitcnt vmcnt(16)
  ds_read_b64_tr_b16 v[48:49], v24 offset:0
  ds_read_b64_tr_b16 v[50:51], v24 offset:2048
  ds_read_b64_tr_b16 v[52:53], v25 offset:0
  ds_read_b64_tr_b16 v[54:55], v25 offset:2048
  ds_read_b64_tr_b16 v[56:57], v26 offset:0
  ds_read_b64_tr_b16 v[58:59], v26 offset:2048
  ds_read_b64_tr_b16 v[60:61], v27 offset:0
  ds_read_b64_tr_b16 v[62:63], v27 offset:2048
  s_waitcnt lgkmcnt(0)
  buffer_store_dwordx4 v[48:51], v2, s[16:19], s38 offen offset:0 sc1
  v_mfma_f32_16x16x32_bf16 v[32:35], v[28:31], v[48:51], v[32:35]
  buffer_store_dwordx4 v[52:55], v2, s[16:19], s38 offen offset:1024 sc1
  v_mfma_f32_16x16x32_bf16 v[36:39], v[28:31], v[52:55], v[36:39]
  buffer_store_dwordx4 v[56:59], v2, s[16:19], s39 offen offset:0 sc1
  v_mfma_f32_16x16x32_bf16 v[40:43], v[28:31], v[56:59], v[40:43]
  buffer_store_dwordx4 v[60:63], v2, s[16:19], s39 offen offset:1024 sc1
  v_mfma_f32_16x16x32_bf16 v[44:47], v[28:31], v[60:63], v[44:47]
  s_add_u32 s38, s38, s40
  s_add_u32 s39, s39, s40
  s_waitcnt vmcnt(20)
  s_cmp_eq_u32 s41, 0
  s_cbranch_scc1 at_nocs
  v_and_b32 v24, 15, v0
  v_lshlrev_b32 v24, 2, v24
  s_mov_b64 exec, 0xffff
  buffer_store_dword v32, v24, s[16:19], s41 offen offset:0 sc1
  buffer_store_dword v36, v24, s[16:19], s41 offen offset:64 sc1
  buffer_store_dword v40, v24, s[16:19], s41 offen offset:128 sc1
  buffer_store_dword v44, v24, s[16:19], s41 offen offset:192 sc1
  s_mov_b64 exec, -1
at_nocs:
  s_barrier
  s_cmp_eq_u32 s12, s13
  s_cselect_b32 s14, 16384, 0
  s_add_u32 s12, s12, s14
  s_mov_b32 m0, s15
  s_add_u32 s14, s12, 4096
  buffer_load_dwordx4 v2, s[16:19], s12 offen offset:0 sc1 lds
  buffer_load_dwordx4 v2, s[16:19], s12 offen offset:1024 sc1 lds
  buffer_load_dwordx4 v2, s[16:19], s12 offen offset:2048 sc1 lds
  buffer_load_dwordx4 v2, s[16:19], s12 offen offset:3072 sc1 lds
  s_add_u32 m0, s15, 4096
  s_add_u32 s12, s12, 16384
  buffer_load_dwordx4 v2, s[16:19], s14 offen offset:0 sc1 lds
  buffer_load_dwordx4 v2, s[16:19], s14 offen offset:1024 sc1 lds
  buffer_load_dwordx4 v2, s[16:19], s14 offen offset:2048 sc1 lds
  buffer_load_dwordx4 v2, s[16:19], s14 offen offset:3072 sc1 lds
  s_add_u32 s15, s15, 32768
  s_and_b32 s15, s15, 131071
  s_waitcnt vmcnt(8)
  s_barrier
  s_cmp_lg_u32 s3, 0
  s_cbranch_scc1 at_npf
  s_lshl_b32 s46, s2, 3
  s_add_u32 s46, s46, 97517568
  v_lshlrev_b32 v9, 7, v0
  v_mov_b32 v12, s52
  v_mov_b32 v13, s53
  s_mov_b64 exec, 1
  buffer_store_dwordx2 v[12:13], v9, s[16:19], s46 offen sc1
  s_mov_b64 exec, -1
at_npf:
  s_cmp_eq_u32 s12, s13
  s_cselect_b32 s14, 16384, 0
  s_add_u32 s12, s12, s14
  s_mov_b32 m0, s15
  s_add_u32 s14, s12, 4096
  buffer_load_dwordx4 v2, s[16:19], s12 offen offset:0 sc1 lds
  buffer_load_dwordx4 v2, s[16:19], s12 offen offset:1024 sc1 lds
  buffer_load_dwordx4 v2, s[16:19], s12 offen offset:2048 sc1 lds
  buffer_load_dwordx4 v2, s[16:19], s12 offen offset:3072 sc1 lds
  s_add_u32 m0, s15, 4096
  s_add_u32 s12, s12, 16384
  buffer_load_dwordx4 v2, s[16:19], s14 offen offset:0 sc1 lds
  buffer_load_dwordx4 v2, s[16:19], s14 offen offset:1024 sc1 lds
  buffer_load_dwordx4 v2, s[16:19], s14 offen offset:2048 sc1 lds
  buffer_load_dwordx4 v2, s[16:19], s14 offen offset:3072 sc1 lds
  s_add_u32 s15, s15, 32768
  s_and_b32 s15, s15, 131071
  s_waitcnt vmcnt(16)
  s_barrier
  s_cmp_eq_u32 s12, s13
  s_cselect_b32 s14, 16384, 0
  s_add_u32 s12, s12, s14
  s_mov_b32 m0, s15
  s_add_u32 s14, s12, 4096
  buffer_load_dwordx4 v2, s[16:19], s12 offen offset:0 sc1 lds
  buffer_load_dwordx4 v2, s[16:19], s12 offen offset:1024 sc1 lds
  buffer_load_dwordx4 v2, s[16:19], s12 offen offset:2048 sc1 lds
  buffer_load_dwordx4 v2, s[16:19], s12 offen offset:3072 sc1 lds
  s_add_u32 m0, s15, 4096
  s_add_u32 s12, s12, 16384
  buffer_load_dwordx4 v2, s[16:19], s14 offen offset:0 sc1 lds
  buffer_load_dwordx4 v2, s[16:19], s14 offen offset:1024 sc1 lds
  buffer_load_dwordx4 v2, s[16:19], s14 offen offset:2048 sc1 lds
  buffer_load_dwordx4 v2, s[16:19], s14 offen offset:3072 sc1 lds
  s_add_u32 s15, s15, 32768
  s_and_b32 s15, s15, 131071
  s_waitcnt vmcnt(16)
  s_barrier
  s_cmp_lg_u32 s3, 0
  s_cbranch_scc1 at_l13
  s_mov_b32 s54, 97517568
  s_mov_b32 s55, 200000
  v_lshlrev_b32 v9, 4, v0
at_pk_poll:
  buffer_load_dwordx4 v[12:15], v9, s[16:19], s54 offen offset:0 sc1
  buffer_load_dwordx4 v[16:19], v9, s[16:19], s54 offen offset:1024 sc1
  s_waitcnt vmcnt(0)
  v_xor_b32 v12, s52, v12
  v_xor_b32 v13, s53, v13
  v_xor_b32 v14, s52, v14
  v_xor_b32 v15, s53, v15
  v_xor_b32 v16, s52, v16
  v_xor_b32 v17, s53, v17
  v_xor_b32 v18, s52, v18
  v_xor_b32 v19, s53, v19
  v_or_b32 v10, v12, v13
  v_or3_b32 v10, v10, v14, v15
  v_or3_b32 v10, v10, v16, v17
  v_or3_b32 v10, v10, v18, v19
  v_cmp_ne_u32 vcc, 0, v10
  s_cbranch_vccz at_pk_ok
  s_sleep 2
  s_sub_u32 s55, s55, 1
  s_cmp_lg_u32 s55, 0
  s_cbranch_scc1 at_pk_poll
at_pk_ok:
at_l13:
  s_waitcnt vmcnt(8)
  s_barrier
  s_mov_b32 m0, s15
  s_add_u32 s14, s20, 4096
  buffer_load_dwordx4 v2, s[16:19], s20 offen offset:0 sc1 lds
  buffer_load_dwordx4 v2, s[16:19], s20 offen offset:1024 sc1 lds
  buffer_load_dwordx4 v2, s[16:19], s20 offen offset:2048 sc1 lds
  buffer_load_dwordx4 v2, s[16:19], s20 offen offset:3072 sc1 lds
  s_add_u32 m0, s15, 4096
  s_add_u32 s20, s20, 32768
  buffer_load_dwordx4 v2, s[16:19], s14 offen offset:0 sc1 lds
  buffer_load_dwordx4 v2, s[16:19], s14 offen offset:1024 sc1 lds
  buffer_load_dwordx4 v2, s[16:19], s14 offen offset:2048 sc1 lds
  buffer_load_dwordx4 v2, s[16:19], s14 offen offset:3072 sc1 lds
  s_add_u32 s15, s15, 32768
  s_mov_b32 m0, s15
  s_add_u32 s14, s20, 4096
  buffer_load_dwordx4 v2, s[16:19], s20 offen offset:0 sc1 lds
  buffer_load_dwordx4 v2, s[16:19], s20 offen offset:1024 sc1 lds
  buffer_load_dwordx4 v2, s[16:19], s20 offen offset:2048 sc1 lds
  buffer_load_dwordx4 v2, s[16:19], s20 offen offset:3072 sc1 lds
  s_add_u32 m0, s15, 4096
  s_add_u32 s20, s20, 32768
  buffer_load_dwordx4 v2, s[16:19], s14 offen offset:0 sc1 lds
  buffer_load_dwordx4 v2, s[16:19], s14 offen offset:1024 sc1 lds
  buffer_load_dwordx4 v2, s[16:19], s14 offen offset:2048 sc1 lds
  buffer_load_dwordx4 v2, s[16:19], s14 offen offset:3072 sc1 lds
  s_add_u32 s15, s15, 32768
  s_waitcnt vmcnt(16)
  s_barrier
  s_mov_b32 m0, s15
  s_add_u32 s14, s20, 4096
  buffer_load_dwordx4 v2, s[16:19], s20 offen offset:0 sc1 lds
  buffer_load_dwordx4 v2, s[16:19], s20 offen offset:1024 sc1 lds
  buffer_load_dwordx4 v2, s[16:19], s20 offen offset:2048 sc1 lds
  buffer_load_dwordx4 v2, s[16:19], s20 offen offset:3072 sc1 lds
  s_add_u32 m0, s15, 4096
  s_add_u32 s20, s20, 32768
  buffer_load_dwordx4 v2, s[16:19], s14 offen offset:0 sc1 lds
  buffer_load_dwordx4 v2, s[16:19], s14 offen offset:1024 sc1 lds
  buffer_load_dwordx4 v2, s[16:19], s14 offen offset:2048 sc1 lds
  buffer_load_dwordx4 v2, s[16:19], s14 offen offset:3072 sc1 lds
  s_add_u32 s15, s15, 32768
  s_barrier
  s_mov_b32 m0, s15
  s_add_u32 s14, s20, 4096
  buffer_load_dwordx4 v2, s[16:19], s20 offen offset:0 sc1 lds
  buffer_load_dwordx4 v2, s[16:19], s20 offen offset:1024 sc1 lds
  buffer_load_dwordx4 v2, s[16:19], s20 offen offset:2048 sc1 lds
  buffer_load_dwordx4 v2, s[16:19], s20 offen offset:3072 sc1 lds
  s_add_u32 m0, s15, 4096
  s_add_u32 s20, s20, 32768
  buffer_load_dwordx4 v2, s[16:19], s14 offen offset:0 sc1 lds
  buffer_load_dwordx4 v2, s[16:19], s14 offen offset:1024 sc1 lds
  buffer_load_dwordx4 v2, s[16:19], s14 offen offset:2048 sc1 lds
  buffer_load_dwordx4 v2, s[16:19], s14 offen offset:3072 sc1 lds
  s_add_u32 s15, s15, 32768
  s_barrier
  s_add_u32 s58, s58, 1
  v_mov_b32 v11, 161728
  s_cmp_lg_u32 s3, 0
  s_cbranch_scc1 wo_nf
  s_mul_i32 s54, s26, 2048
  s_mul_i32 s55, s27, 8
  s_add_u32 s54, s54, s55
  s_add_u32 s54, s54, s11
  s_add_u32 s54, s54, 32768
  v_lshlrev_b32 v9, 7, v0
  v_mov_b32 v12, s52
  v_mov_b32 v13, s53
  s_mov_b64 exec, 65535
  buffer_store_dwordx2 v[12:13], v9, s[16:19], s54 offen sc1
  s_mov_b64 exec, -1
wo_nf:
  s_cmp_lg_u32 s3, 0
  s_cbranch_scc1 wo_wait
  s_mul_i32 s54, s26, 2048
  s_add_u32 s54, s54, s11
  s_add_u32 s54, s54, 32768
  s_lshl_b32 s55, s27, 7
  s_add_u32 s54, s54, s55
  s_mov_b32 s55, 200000
  v_lshlrev_b32 v9, 3, v0
  s_mov_b64 exec, 65535
  s_bitset0_b32 exec_lo, s27
wo_poll:
  buffer_load_dwordx2 v[12:13], v9, s[16:19], s54 offen sc1
  s_waitcnt vmcnt(0)
  v_xor_b32 v12, s52, v12
  v_xor_b32 v13, s53, v13
  v_or_b32 v10, v12, v13
  v_cmp_ne_u32 vcc, 0, v10
  s_cbranch_vccz wo_ok
  s_sleep 2
  s_sub_u32 s55, s55, 1
  s_cmp_lg_u32 s55, 0
  s_cbranch_scc1 wo_poll
wo_ok:
  s_mov_b64 exec, -1
  v_mov_b32 v10, s58
  ds_write_b32 v11, v10
  s_branch wo_go
wo_wait:
  s_mov_b32 s55, s3
  s_cmp_lg_u32 s55, 1
  s_cbranch_scc1 wo_np
  v_and_b32 v12, 15, v0
  v_lshlrev_b32 v12, 7, v12
  s_lshr_b32 s55, s2, 3
  s_lshl_b32 s55, s55, 11
  buffer_load_dword v71, v12, s[80:83], s55 offen
wo_np:
  s_mov_b32 s55, 6400000
wo_w2:
  ds_read_b32 v10, v11
  s_waitcnt lgkmcnt(0)
  v_cmp_ne_u32 vcc, s58, v10
  s_cbranch_vccz wo_go
  s_sleep 1
  s_sub_u32 s55, s55, 1
  s_cmp_lg_u32 s55, 0
  s_cbranch_scc1 wo_w2
wo_go:
  s_waitcnt vmcnt(0)
  s_barrier
  s_barrier
  v_lshlrev_b32 v8, 4, v0
  s_lshl_b32 s44, s3, 11
  s_mul_i32 s23, s26, 262144
  s_add_u32 s23, s23, s6
  s_add_u32 s23, s23, 25165824
  s_add_u32 s23, s23, s44
  s_lshl_b32 s21, s27, 14
  s_add_u32 s21, s21, s23
  s_mul_i32 s45, s3, 3072
  s_mul_i32 s24, s27, 479232
  s_add_u32 s24, s24, 109051904
  s_add_u32 s24, s24, s45
  s_mul_i32 s22, s27, 28672
  s_add_u32 s22, s22, s24
  s_lshl_b32 s46, s3, 9
  s_add_u32 s46, s46, 12288
  s_sub_u32 s49, s46, s45
  s_add_u32 s46, s46, 8192
  s_add_u32 s45, s45, 8192
  s_mov_b32 s40, s21
  s_mov_b32 s41, s22
  s_add_u32 m0, 0, s45
  s_add_u32 s42, s41, s49
  buffer_load_dwordx4 v8, s[16:19], s41 offen offset:0 sc1 lds
  buffer_load_dwordx4 v8, s[16:19], s41 offen offset:1024 sc1 lds
  buffer_load_dwordx4 v8, s[16:19], s41 offen offset:2048 sc1 lds
  s_add_u32 m0, 0, s46
  s_mov_b32 exec_hi, 0
  buffer_load_dwordx4 v8, s[16:19], s42 offen sc1 lds
  s_mov_b32 exec_hi, -1
  s_add_u32 s41, s41, 14336
  s_add_u32 m0, 22528, s45
  s_add_u32 s42, s41, s49
  buffer_load_dwordx4 v8, s[16:19], s41 offen offset:0 sc1 lds
  buffer_load_dwordx4 v8, s[16:19], s41 offen offset:1024 sc1 lds
  buffer_load_dwordx4 v8, s[16:19], s41 offen offset:2048 sc1 lds
  s_add_u32 m0, 22528, s46
  s_mov_b32 exec_hi, 0
  buffer_load_dwordx4 v8, s[16:19], s42 offen sc1 lds
  s_mov_b32 exec_hi, -1
  s_add_u32 s41, s41, 14336
  s_waitcnt vmcnt(0)
  s_barrier
  s_add_u32 s58, s58, 1
  v_mov_b32 v11, 161728
  s_cmp_lg_u32 s3, 0
  s_cbranch_scc1 w1_nf
  s_mul_i32 s54, s26, 2048
  s_mul_i32 s55, s27, 8
  s_add_u32 s54, s54, s55
  s_add_u32 s54, s54, s11
  s_add_u32 s54, s54, 65536
  v_lshlrev_b32 v9, 7, v0
  v_mov_b32 v12, s52
  v_mov_b32 v13, s53
  s_mov_b64 exec, 65535
  buffer_store_dwordx2 v[12:13], v9, s[16:19], s54 offen sc1
  s_mov_b64 exec, -1
w1_nf:
  s_cmp_lg_u32 s3, 0
  s_cbranch_scc1 w1_wait
  s_mul_i32 s54, s26, 2048
  s_add_u32 s54, s54, s11
  s_add_u32 s54, s54, 65536
  s_lshl_b32 s55, s27, 7
  s_add_u32 s54, s54, s55
  s_mov_b32 s55, 200000
  v_lshlrev_b32 v9, 3, v0
  s_mov_b64 exec, 65535
  s_bitset0_b32 exec_lo, s27
w1_poll:
  buffer_load_dwordx2 v[12:13], v9, s[16:19], s54 offen sc1
  s_waitcnt vmcnt(0)
  v_xor_b32 v12, s52, v12
  v_xor_b32 v13, s53, v13
  v_or_b32 v10, v12, v13
  v_cmp_ne_u32 vcc, 0, v10
  s_cbranch_vccz w1_ok
  s_sleep 2
  s_sub_u32 s55, s55, 1
  s_cmp_lg_u32 s55, 0
  s_cbranch_scc1 w1_poll
w1_ok:
  s_mov_b64 exec, -1
  v_mov_b32 v10, s58
  ds_write_b32 v11, v10
  s_branch w1_wl
w1_wait:
w1_wl:
  s_mov_b32 s41, s24
  s_cmp_eq_u32 s41, s22
  s_cselect_b32 s47, 28672, 0
  s_add_u32 s41, s41, s47
  s_add_u32 m0, 45056, s45
  s_add_u32 s42, s41, s49
  buffer_load_dwordx4 v8, s[16:19], s41 offen offset:0 sc1 lds
  buffer_load_dwordx4 v8, s[16:19], s41 offen offset:1024 sc1 lds
  buffer_load_dwordx4 v8, s[16:19], s41 offen offset:2048 sc1 lds
  s_add_u32 m0, 45056, s46
  s_mov_b32 exec_hi, 0
  buffer_load_dwordx4 v8, s[16:19], s42 offen sc1 lds
  s_mov_b32 exec_hi, -1
  s_add_u32 s41, s41, 14336
  s_add_u32 m0, 67584, s45
  s_add_u32 s42, s41, s49
  buffer_load_dwordx4 v8, s[16:19], s41 offen offset:0 sc1 lds
  buffer_load_dwordx4 v8, s[16:19], s41 offen offset:1024 sc1 lds
  buffer_load_dwordx4 v8, s[16:19], s41 offen offset:2048 sc1 lds
  s_add_u32 m0, 67584, s46
  s_mov_b32 exec_hi, 0
  buffer_load_dwordx4 v8, s[16:19], s42 offen sc1 lds
  s_mov_b32 exec_hi, -1
  s_add_u32 s41, s41, 14336
  s_cmp_eq_u32 s41, s22
  s_cselect_b32 s47, 28672, 0
  s_add_u32 s41, s41, s47
  s_add_u32 m0, 90112, s45
  s_add_u32 s42, s41, s49
  buffer_load_dwordx4 v8, s[16:19], s41 offen offset:0 sc1 lds
  buffer_load_dwordx4 v8, s[16:19], s41 offen offset:1024 sc1 lds
  buffer_load_dwordx4 v8, s[16:19], s41 offen offset:2048 sc1 lds
  s_add_u32 m0, 90112, s46
  s_mov_b32 exec_hi, 0
  buffer_load_dwordx4 v8, s[16:19], s42 offen sc1 lds
  s_mov_b32 exec_hi, -1
  s_add_u32 s41, s41, 14336
  s_add_u32 m0, 112640, s45
  s_add_u32 s42, s41, s49
  buffer_load_dwordx4 v8, s[16:19], s41 offen offset:0 sc1 lds
  buffer_load_dwordx4 v8, s[16:19], s41 offen offset:1024 sc1 lds
  buffer_load_dwordx4 v8, s[16:19], s41 offen offset:2048 sc1 lds
  s_add_u32 m0, 112640, s46
  s_mov_b32 exec_hi, 0
  buffer_load_dwordx4 v8, s[16:19], s42 offen sc1 lds
  s_mov_b32 exec_hi, -1
  s_add_u32 s41, s41, 14336
  s_cmp_eq_u32 s41, s22
  s_cselect_b32 s47, 28672, 0
  s_add_u32 s41, s41, s47
  s_cmp_eq_u32 s3, 0
  s_cbranch_scc1 w1_go
  s_mov_b32 s55, s3
  s_cmp_lg_u32 s55, 1
  s_cbranch_scc1 w1_np
  v_and_b32 v12, 15, v0
  v_lshlrev_b32 v12, 7, v12
  s_lshr_b32 s55, s2, 3
  s_lshl_b32 s55, s55, 11
  buffer_load_dword v71, v12, s[80:83], s55 offen
w1_np:
  s_mov_b32 s55, 6400000
w1_w2:
  ds_read_b32 v10, v11
  s_waitcnt lgkmcnt(0)
  v_cmp_ne_u32 vcc, s58, v10
  s_cbranch_vccz w1_go
  s_sleep 1
  s_sub_u32 s55, s55, 1
  s_cmp_lg_u32 s55, 0
  s_cbranch_scc1 w1_w2
w1_go:
  s_mov_b32 s40, s23
  s_cmp_eq_u32 s40, s21
  s_cselect_b32 s47, 16384, 0
  s_add_u32 s40, s40, s47
  s_add_u32 m0, 45056, s44
  s_nop 0
  buffer_load_dwordx4 v8, s[16:19], s40 offen sc1 lds
  buffer_load_dwordx4 v8, s[16:19], s40 offen offset:1024 sc1 lds
  s_add_u32 s40, s40, 8192
  s_add_u32 m0, 67584, s44
  s_nop 0
  buffer_load_dwordx4 v8, s[16:19], s40 offen sc1 lds
  buffer_load_dwordx4 v8, s[16:19], s40 offen offset:1024 sc1 lds
  s_add_u32 s40, s40, 8192
  s_cmp_eq_u32 s40, s21
  s_cselect_b32 s47, 16384, 0
  s_add_u32 s40, s40, s47
  s_add_u32 m0, 90112, s44
  s_nop 0
  buffer_load_dwordx4 v8, s[16:19], s40 offen sc1 lds
  buffer_load_dwordx4 v8, s[16:19], s40 offen offset:1024 sc1 lds
  s_add_u32 s40, s40, 8192
  s_add_u32 m0, 112640, s44
  s_nop 0
  buffer_load_dwordx4 v8, s[16:19], s40 offen sc1 lds
  buffer_load_dwordx4 v8, s[16:19], s40 offen offset:1024 sc1 lds
  s_add_u32 s40, s40, 8192
  s_cmp_eq_u32 s40, s21
  s_cselect_b32 s47, 16384, 0
  s_add_u32 s40, s40, s47
  s_mov_b32 s43, 135168
  s_waitcnt vmcnt(4)
  s_barrier
  s_mov_b32 s50, 13
  s_add_u32 m0, s43, s45
  s_branch w1_lbody
w1_lhead:
  s_waitcnt vmcnt(12)
  s_barrier
w1_lbody:
  s_add_u32 s42, s41, s49
  buffer_load_dwordx4 v8, s[16:19], s41 offen offset:0 sc1 lds
  buffer_load_dwordx4 v8, s[16:19], s41 offen offset:1024 sc1 lds
  buffer_load_dwordx4 v8, s[16:19], s41 offen offset:2048 sc1 lds
  s_add_u32 m0, s43, s46
  s_mov_b32 exec_hi, 0
  buffer_load_dwordx4 v8, s[16:19], s42 offen sc1 lds
  s_mov_b32 exec_hi, -1
  s_add_u32 s41, s41, 14336
  s_add_u32 m0, s43, s44
  s_nop 0
  buffer_load_dwordx4 v8, s[16:19], s40 offen sc1 lds
  buffer_load_dwordx4 v8, s[16:19], s40 offen offset:1024 sc1 lds
  s_add_u32 s40, s40, 8192
  s_add_u32 s43, s43, 22528
  s_cmp_eq_u32 s43, 157696
  s_cselect_b32 s43, 0, s43
  s_add_u32 m0, s43, s45
  s_add_u32 s42, s41, s49
  buffer_load_dwordx4 v8, s[16:19], s41 offen offset:0 sc1 lds
  buffer_load_dwordx4 v8, s[16:19], s41 offen offset:1024 sc1 lds
  buffer_load_dwordx4 v8, s[16:19], s41 offen offset:2048 sc1 lds
  s_add_u32 m0, s43, s46
  s_mov_b32 exec_hi, 0
  buffer_load_dwordx4 v8, s[16:19], s42 offen sc1 lds
  s_mov_b32 exec_hi, -1
  s_add_u32 s41, s41, 14336
  s_add_u32 m0, s43, s44
  s_nop 0
  buffer_load_dwordx4 v8, s[16:19], s40 offen sc1 lds
  buffer_load_dwordx4 v8, s[16:19], s40 offen offset:1024 sc1 lds
  s_add_u32 s40, s40, 8192
  s_add_u32 s43, s43, 22528
  s_cmp_eq_u32 s43, 157696
  s_cselect_b32 s43, 0, s43
  s_cmp_eq_u32 s41, s22
  s_cselect_b32 s47, 28672, 0
  s_add_u32 s41, s41, s47
  s_cmp_eq_u32 s40, s21
  s_cselect_b32 s47, 16384, 0
  s_add_u32 s40, s40, s47
  s_add_u32 m0, s43, s45
  s_sub_u32 s50, s50, 1
  s_cmp_lg_u32 s50, 0
  s_cbranch_scc1 w1_lhead
  v_and_b32 v1, 15, v0
  v_lshrrev_b32 v2, 4, v0
  v_lshlrev_b32 v3, 4, v1
  v_lshl_add_u32 v3, v2, 10, v3
  s_lshl_b32 s36, s26, 15
  s_lshl_b32 s37, s3, 8
  s_add_u32 s36, s36, s37
  s_add_u32 s36, s36, s10
  s_add_u32 s36, s36, 47710208
  buffer_load_dwordx4 v[16:19], v3, s[16:19], s36 offen sc1
  s_add_u32 s36, s36, 4096
  buffer_load_dwordx4 v[20:23], v3, s[16:19], s36 offen sc1
  s_add_u32 s36, s36, 4096
  buffer_load_dwordx4 v[24:27], v3, s[16:19], s36 offen sc1
  s_add_u32 s36, s36, 4096
  buffer_load_dwordx4 v[28:31], v3, s[16:19], s36 offen sc1
  s_add_u32 s36, s36, 4096
  buffer_load_dwordx4 v[32:35], v3, s[16:19], s36 offen sc1
  s_add_u32 s36, s36, 4096
  buffer_load_dwordx4 v[36:39], v3, s[16:19], s36 offen sc1
  s_add_u32 s36, s36, 4096
  buffer_load_dwordx4 v[40:43], v3, s[16:19], s36 offen sc1
  s_add_u32 s36, s36, 4096
  buffer_load_dwordx4 v[44:47], v3, s[16:19], s36 offen sc1
  s_lshl_b32 s37, s3, 8
  s_mul_i32 s38, s27, 896
  s_add_u32 s37, s37, s38
  s_add_u32 s37, s37, 96731136
  v_lshlrev_b32 v13, 2, v0
  buffer_load_dword v48, v13, s[16:19], s37 offen sc1
  s_add_u32 s37, s37, 14336
  buffer_load_dword v49, v13, s[16:19], s37 offen sc1
  s_add_u32 s37, s37, 14336
  buffer_load_dword v50, v13, s[16:19], s37 offen sc1
  s_add_u32 s37, s37, 14336
  buffer_load_dword v51, v13, s[16:19], s37 offen sc1
  s_add_u32 s37, s37, 14336
  buffer_load_dword v52, v13, s[16:19], s37 offen sc1
  s_add_u32 s37, s37, 14336
  buffer_load_dword v53, v13, s[16:19], s37 offen sc1
  s_add_u32 s37, s37, 14336
  buffer_load_dword v54, v13, s[16:19], s37 offen sc1
  s_add_u32 s37, s37, 14336
  buffer_load_dword v55, v13, s[16:19], s37 offen sc1
  s_waitcnt vmcnt(28)
  s_barrier
  s_and_b32 s48, s27, 7
  s_lshr_b32 s49, s27, 3
  s_mul_i32 s49, s49, 56
  s_mul_i32 s21, s48, 7
  s_add_u32 s21, s21, s49
  s_add_u32 s22, s21, 7
  s_cmp_le_u32 s48, 5
  s_cselect_b32 s40, 0, 10
  s_cselect_b32 s24, 46, 0
  s_add_u32 s40, s40, s49
  s_add_u32 s23, s40, 46
  s_mul_i32 s40, s40, 4096
  s_mul_i32 s21, s21, 4096
  s_mul_i32 s22, s22, 4096
  s_mul_i32 s23, s23, 4096
  s_mul_i32 s24, s24, 4096
  s_cmp_eq_u32 s40, s21
  s_cselect_b32 s40, s22, s40
  s_lshl_b32 s45, s3, 10
  s_xor_b32 s41, s27, 0
  s_mul_i32 s41, s41, 479232
  s_add_u32 s41, s41, 117440512
  s_add_u32 s41, s41, s45
  s_xor_b32 s42, s27, 8
  s_mul_i32 s42, s42, 479232
  s_add_u32 s42, s42, 117440512
  s_add_u32 s42, s42, s45
  s_add_u32 s45, s45, 90112
  s_mov_b32 s43, 0
  s_mov_b32 s46, s21
  s_add_u32 m0, s43, s45
  s_add_u32 s44, s41, s46
  buffer_load_dwordx4 v8, s[16:19], s44 offen sc1 lds
  s_add_u32 m0, m0, 4096
  s_add_u32 s44, s42, s46
  buffer_load_dwordx4 v8, s[16:19], s44 offen sc1 lds
  s_add_u32 s46, s46, 4096
  s_add_u32 s43, s43, 8192
  s_and_b32 s43, s43, 65535
  s_add_u32 m0, s43, s45
  s_add_u32 s44, s41, s46
  buffer_load_dwordx4 v8, s[16:19], s44 offen sc1 lds
  s_add_u32 m0, m0, 4096
  s_add_u32 s44, s42, s46
  buffer_load_dwordx4 v8, s[16:19], s44 offen sc1 lds
  s_add_u32 s46, s46, 4096
  s_add_u32 s43, s43, 8192
  s_and_b32 s43, s43, 65535
  s_add_u32 m0, s43, s45
  s_add_u32 s44, s41, s46
  buffer_load_dwordx4 v8, s[16:19], s44 offen sc1 lds
  s_add_u32 m0, m0, 4096
  s_add_u32 s44, s42, s46
  buffer_load_dwordx4 v8, s[16:19], s44 offen sc1 lds
  s_add_u32 s46, s46, 4096
  s_add_u32 s43, s43, 8192
  s_and_b32 s43, s43, 65535
  s_add_u32 m0, s43, s45
  s_add_u32 s44, s41, s46
  buffer_load_dwordx4 v8, s[16:19], s44 offen sc1 lds
  s_add_u32 m0, m0, 4096
  s_add_u32 s44, s42, s46
  buffer_load_dwordx4 v8, s[16:19], s44 offen sc1 lds
  s_add_u32 s46, s46, 4096
  s_add_u32 s43, s43, 8192
  s_and_b32 s43, s43, 65535
  s_waitcnt vmcnt(24)
  s_barrier
  s_add_u32 m0, s43, s45
  s_add_u32 s44, s41, s46
  buffer_load_dwordx4 v8, s[16:19], s44 offen sc1 lds
  s_add_u32 m0, m0, 4096
  s_add_u32 s44, s42, s46
  buffer_load_dwordx4 v8, s[16:19], s44 offen sc1 lds
  s_add_u32 s46, s46, 4096
  s_add_u32 s43, s43, 8192
  s_and_b32 s43, s43, 65535
  s_add_u32 m0, s43, s45
  s_add_u32 s44, s41, s46
  buffer_load_dwordx4 v8, s[16:19], s44 offen sc1 lds
  s_add_u32 m0, m0, 4096
  s_add_u32 s44, s42, s46
  buffer_load_dwordx4 v8, s[16:19], s44 offen sc1 lds
  s_add_u32 s46, s46, 4096
  s_add_u32 s43, s43, 8192
  s_and_b32 s43, s43, 65535
  s_add_u32 m0, s43, s45
  s_add_u32 s44, s41, s46
  buffer_load_dwordx4 v8, s[16:19], s44 offen sc1 lds
  s_add_u32 m0, m0, 4096
  s_add_u32 s44, s42, s46
  buffer_load_dwordx4 v8, s[16:19], s44 offen sc1 lds
  s_add_u32 s46, s46, 4096
  s_add_u32 s43, s43, 8192
  s_and_b32 s43, s43, 65535
  s_add_u32 m0, s43, s45
  s_add_u32 s44, s41, s40
  buffer_load_dwordx4 v8, s[16:19], s44 offen sc1 lds
  s_add_u32 m0, m0, 4096
  s_add_u32 s44, s42, s40
  buffer_load_dwordx4 v8, s[16:19], s44 offen sc1 lds
  s_add_u32 s40, s40, 4096
  s_cmp_eq_u32 s40, s21
  s_cselect_b32 s40, s22, s40
  s_cmp_eq_u32 s40, s23
  s_cselect_b32 s40, s24, s40
  s_add_u32 s43, s43, 8192
  s_and_b32 s43, s43, 65535
  s_lshl_b32 s38, s3, 8
  s_add_u32 s38, s38, 162816
  v_add_u32 v13, s38, v13
  s_waitcnt vmcnt(16)
  v_pk_add_f32 v[48:49], v[48:49], v[50:51]
  v_pk_add_f32 v[48:49], v[48:49], v[52:53]
  v_pk_add_f32 v[48:49], v[48:49], v[54:55]
  v_add_f32 v48, v48, v49
  ds_write_b32 v13, v48
  v_pk_add_f32 v[16:17], v[16:17], v[20:21]
  v_pk_add_f32 v[18:19], v[18:19], v[22:23]
  v_pk_add_f32 v[16:17], v[16:17], v[24:25]
  v_pk_add_f32 v[18:19], v[18:19], v[26:27]
  v_pk_add_f32 v[16:17], v[16:17], v[28:29]
  v_pk_add_f32 v[18:19], v[18:19], v[30:31]
  v_pk_add_f32 v[16:17], v[16:17], v[32:33]
  v_pk_add_f32 v[18:19], v[18:19], v[34:35]
  v_pk_add_f32 v[16:17], v[16:17], v[36:37]
  v_pk_add_f32 v[18:19], v[18:19], v[38:39]
  v_pk_add_f32 v[16:17], v[16:17], v[40:41]
  v_pk_add_f32 v[18:19], v[18:19], v[42:43]
  v_pk_add_f32 v[16:17], v[16:17], v[44:45]
  v_pk_add_f32 v[18:19], v[18:19], v[46:47]
  v_mov_b32 v20, v16
  v_mov_b32 v21, v17
  v_mov_b32 v22, v18
  v_mov_b32 v23, v19
  v_permlane32_swap_b32 v16, v20
  v_permlane32_swap_b32 v17, v21
  v_permlane32_swap_b32 v18, v22
  v_permlane32_swap_b32 v19, v23
  v_add_f32 v16, v16, v20
  v_add_f32 v17, v17, v21
  v_add_f32 v18, v18, v22
  v_add_f32 v19, v19, v23
  v_mov_b32 v20, v16
  v_mov_b32 v21, v17
  v_mov_b32 v22, v18
  v_mov_b32 v23, v19
  v_permlane16_swap_b32 v16, v20
  v_permlane16_swap_b32 v17, v21
  v_permlane16_swap_b32 v18, v22
  v_permlane16_swap_b32 v19, v23
  v_add_f32 v16, v16, v20
  v_add_f32 v17, v17, v21
  v_add_f32 v18, v18, v22
  v_add_f32 v19, v19, v23
  s_mov_b32 s36, 981467136
  s_mov_b32 s37, 925353388
  v_mul_f32 v16, s36, v16
  v_mul_f32 v17, s36, v17
  v_mul_f32 v18, s36, v18
  v_mul_f32 v19, s36, v19
  v_fma_f32 v17, -v16, v16, v17
  v_fma_f32 v19, -v18, v18, v19
  v_max_f32 v17, 0, v17
  v_max_f32 v19, 0, v19
  v_add_f32 v17, s37, v17
  v_add_f32 v19, s37, v19
  v_rsq_f32 v22, v17
  v_rsq_f32 v23, v19
  v_sub_f32 v20, 0, v16
  v_sub_f32 v21, 0, v18
  s_lshl_b32 s36, s3, 7
  s_add_u32 s36, s36, 161792
  v_lshlrev_b32 v3, 3, v1
  v_add_u32 v3, s36, v3
  ds_write_b64 v3, v[20:21]
  ds_write_b64 v3, v[22:23] offset:512
  s_waitcnt lgkmcnt(0)
  s_barrier
  v_add_u32 v20, s45, v8
  s_waitcnt vmcnt(0)
  s_barrier
  s_barrier
  s_add_u32 s58, s58, 1
  v_mov_b32 v11, 161728
  s_cmp_lg_u32 s3, 0
  s_cbranch_scc1 w2_nf
  s_mul_i32 s54, s26, 2048
  s_mul_i32 s55, s27, 8
  s_add_u32 s54, s54, s55
  s_add_u32 s54, s54, s11
  s_add_u32 s54, s54, 98304
  v_lshlrev_b32 v9, 7, v0
  v_mov_b32 v12, s52
  v_mov_b32 v13, s53
  s_mov_b64 exec, 65535
  buffer_store_dwordx2 v[12:13], v9, s[16:19], s54 offen sc1
  s_mov_b64 exec, -1
w2_nf:
  s_cmp_lg_u32 s3, 0
  s_cbranch_scc1 w2_wait
  s_mul_i32 s54, s26, 2048
  s_add_u32 s54, s54, s11
  s_add_u32 s54, s54, 98304
  s_lshl_b32 s55, s27, 7
  s_add_u32 s54, s54, s55
  s_mov_b32 s55, 200000
  v_lshlrev_b32 v9, 3, v0
  s_mov_b64 exec, 65535
  s_bitset0_b32 exec_lo, s27
w2_poll:
  buffer_load_dwordx2 v[12:13], v9, s[16:19], s54 offen sc1
  s_waitcnt vmcnt(0)
  v_xor_b32 v12, s52, v12
  v_xor_b32 v13, s53, v13
  v_or_b32 v10, v12, v13
  v_cmp_ne_u32 vcc, 0, v10
  s_cbranch_vccz w2_ok
  s_sleep 2
  s_sub_u32 s55, s55, 1
  s_cmp_lg_u32 s55, 0
  s_cbranch_scc1 w2_poll
w2_ok:
  s_mov_b64 exec, -1
  v_mov_b32 v10, s58
  ds_write_b32 v11, v10
  s_branch w2_wl
w2_wait:
w2_wl:
  s_add_u32 m0, s43, s45
  s_add_u32 s44, s41, s40
  buffer_load_dwordx4 v8, s[16:19], s44 offen sc1 lds
  s_add_u32 m0, m0, 4096
  s_add_u32 s44, s42, s40
  buffer_load_dwordx4 v8, s[16:19], s44 offen sc1 lds
  s_add_u32 s40, s40, 4096
  s_cmp_eq_u32 s40, s21
  s_cselect_b32 s40, s22, s40
  s_cmp_eq_u32 s40, s23
  s_cselect_b32 s40, s24, s40
  s_add_u32 s43, s43, 8192
  s_and_b32 s43, s43, 65535
  s_add_u32 m0, s43, s45
  s_add_u32 s44, s41, s40
  buffer_load_dwordx4 v8, s[16:19], s44 offen sc1 lds
  s_add_u32 m0, m0, 4096
  s_add_u32 s44, s42, s40
  buffer_load_dwordx4 v8, s[16:19], s44 offen sc1 lds
  s_add_u32 s40, s40, 4096
  s_cmp_eq_u32 s40, s21
  s_cselect_b32 s40, s22, s40
  s_cmp_eq_u32 s40, s23
  s_cselect_b32 s40, s24, s40
  s_add_u32 s43, s43, 8192
  s_and_b32 s43, s43, 65535
  s_cmp_eq_u32 s3, 0
  s_cbranch_scc1 w2_go
  s_mov_b32 s55, s3
  s_cmp_lg_u32 s55, 1
  s_cbranch_scc1 w2_np
  v_and_b32 v12, 15, v0
  v_lshlrev_b32 v12, 7, v12
  s_lshr_b32 s55, s2, 3
  s_lshl_b32 s55, s55, 11
  buffer_load_dword v71, v12, s[80:83], s55 offen
w2_np:
  s_mov_b32 s55, 6400000
w2_w2:
  ds_read_b32 v10, v11
  s_waitcnt lgkmcnt(0)
  v_cmp_ne_u32 vcc, s58, v10
  s_cbranch_vccz w2_go
  s_sleep 1
  s_sub_u32 s55, s55, 1
  s_cmp_lg_u32 s55, 0
  s_cbranch_scc1 w2_w2
w2_go:
  s_barrier
  s_add_u32 m0, s43, s45
  s_add_u32 s44, s41, s40
  buffer_load_dwordx4 v8, s[16:19], s44 offen sc1 lds
  s_add_u32 m0, m0, 4096
  s_add_u32 s44, s42, s40
  buffer_load_dwordx4 v8, s[16:19], s44 offen sc1 lds
  s_add_u32 s40, s40, 4096
  s_cmp_eq_u32 s40, s21
  s_cselect_b32 s40, s22, s40
  s_cmp_eq_u32 s40, s23
  s_cselect_b32 s40, s24, s40
  s_add_u32 s43, s43, 8192
  s_and_b32 s43, s43, 65535
  s_add_u32 m0, s43, s45
  s_add_u32 s44, s41, s40
  buffer_load_dwordx4 v8, s[16:19], s44 offen sc1 lds
  s_add_u32 m0, m0, 4096
  s_add_u32 s44, s42, s40
  buffer_load_dwordx4 v8, s[16:19], s44 offen sc1 lds
  s_add_u32 s40, s40, 4096
  s_cmp_eq_u32 s40, s21
  s_cselect_b32 s40, s22, s40
  s_cmp_eq_u32 s40, s23
  s_cselect_b32 s40, s24, s40
  s_add_u32 s43, s43, 8192
  s_and_b32 s43, s43, 65535
  s_add_u32 s46, s2, s3
  s_cmp_eq_u32 s10, 0
  s_cselect_b32 s46, 1, s46
  s_cmp_lg_u32 s46, 0
  s_cbranch_scc1 w2_nt
  s_mov_b32 s46, 97525760
  v_lshlrev_b32 v9, 7, v0
  v_mov_b32 v12, s52
  v_mov_b32 v13, s53
  s_mov_b64 exec, 1
  buffer_store_dwordx2 v[12:13], v9, s[16:19], s46 offen sc1
  s_mov_b64 exec, -1
w2_nt:
  s_cmp_eq_u32 s10, 0
  s_cselect_b32 s46, 0, 32768
  s_add_u32 s46, s46, 97910784
  s_mul_i32 s47, s26, 2048
  s_add_u32 s46, s46, s47
  s_xor_b32 s47, s27, 8
  s_mul_i32 s47, s47, 64
  s_add_u32 s47, s47, s46
  s_mul_i32 s49, s27, 64
  s_add_u32 s46, s46, s49
  v_mov_b32 v14, 0
  s_cmp_lg_u32 s10, 0
  s_cbranch_scc1 w2_regs
  s_mov_b32 s50, 17
w2a_l0:
  s_add_u32 m0, s43, s45
  s_add_u32 s44, s41, s40
  buffer_load_dwordx4 v8, s[16:19], s44 offen sc1 lds
  s_add_u32 m0, m0, 4096
  s_add_u32 s44, s42, s40
  buffer_load_dwordx4 v8, s[16:19], s44 offen sc1 lds
  s_add_u32 s40, s40, 4096
  s_cmp_eq_u32 s40, s21
  s_cselect_b32 s40, s22, s40
  s_cmp_eq_u32 s40, s23
  s_cselect_b32 s40, s24, s40
  s_add_u32 s43, s43, 8192
  s_and_b32 s43, s43, 65535
  s_add_u32 m0, s43, s45
  s_add_u32 s44, s41, s40
  buffer_load_dwordx4 v8, s[16:19], s44 offen sc1 lds
  s_add_u32 m0, m0, 4096
  s_add_u32 s44, s42, s40
  buffer_load_dwordx4 v8, s[16:19], s44 offen sc1 lds
  s_add_u32 s40, s40, 4096
  s_cmp_eq_u32 s40, s21
  s_cselect_b32 s40, s22, s40
  s_cmp_eq_u32 s40, s23
  s_cselect_b32 s40, s24, s40
  s_add_u32 s43, s43, 8192
  s_and_b32 s43, s43, 65535
  s_waitcnt vmcnt(8) lgkmcnt(0)
  s_barrier
  s_sub_u32 s50, s50, 1
  s_cmp_lg_u32 s50, 0
  s_cbranch_scc1 w2a_l0
  s_add_u32 m0, s43, s45
  s_add_u32 s44, s41, s40
  buffer_load_dwordx4 v8, s[16:19], s44 offen sc1 lds
  s_add_u32 s40, s40, 4096
  s_add_u32 s43, s43, 8192
  s_and_b32 s43, s43, 65535
  s_add_u32 m0, s43, s45
  s_add_u32 s44, s41, s40
  buffer_load_dwordx4 v8, s[16:19], s44 offen sc1 lds
  s_add_u32 s40, s40, 4096
  s_add_u32 s43, s43, 8192
  s_and_b32 s43, s43, 65535
  s_waitcnt vmcnt(6) lgkmcnt(0)
  s_barrier
  s_mov_b32 s50, 4
w2a_l1:
  s_add_u32 m0, s43, s45
  s_add_u32 s44, s41, s40
  buffer_load_dwordx4 v8, s[16:19], s44 offen sc1 lds
  s_add_u32 s40, s40, 4096
  s_add_u32 s43, s43, 8192
  s_and_b32 s43, s43, 65535
  s_add_u32 m0, s43, s45
  s_add_u32 s44, s41, s40
  buffer_load_dwordx4 v8, s[16:19], s44 offen sc1 lds
  s_add_u32 s40, s40, 4096
  s_add_u32 s43, s43, 8192
  s_and_b32 s43, s43, 65535
  s_waitcnt vmcnt(4) lgkmcnt(0)
  s_barrier
  s_sub_u32 s50, s50, 1
  s_cmp_lg_u32 s50, 0
  s_cbranch_scc1 w2a_l1
  s_add_u32 s40, s24, 229376
  s_add_u32 m0, s43, s45
  s_add_u32 s44, s41, s40
  buffer_load_dwordx4 v8, s[16:19], s44 offen sc1 lds
  s_add_u32 s40, s40, 4096
  s_add_u32 s43, s43, 8192
  s_and_b32 s43, s43, 65535
  s_add_u32 m0, s43, s45
  s_add_u32 s44, s41, s40
  buffer_load_dwordx4 v8, s[16:19], s44 offen sc1 lds
  s_add_u32 s40, s40, 4096
  s_add_u32 s43, s43, 8192
  s_and_b32 s43, s43, 65535
  s_waitcnt vmcnt(4) lgkmcnt(0)
  s_barrier
  s_cmp_lg_u32 s3, 0
  s_cbranch_scc1 w2a_nf2
  v_lshlrev_b32 v9, 7, v0
  v_mov_b32 v12, s52
  v_mov_b32 v13, s53
  s_mov_b64 exec, 1
  buffer_store_dwordx2 v[12:13], v9, s[16:19], s46 offen sc1
  s_mov_b64 exec, -1
w2a_nf2:
  s_add_u32 m0, s43, s45
  s_add_u32 s44, s41, s40
  buffer_load_dwordx4 v8, s[16:19], s44 offen sc1 lds
  s_add_u32 s40, s40, 4096
  s_add_u32 s43, s43, 8192
  s_and_b32 s43, s43, 65535
  s_add_u32 m0, s43, s45
  s_add_u32 s44, s41, s40
  buffer_load_dwordx4 v8, s[16:19], s44 offen sc1 lds
  s_add_u32 s40, s40, 4096
  s_add_u32 s43, s43, 8192
  s_and_b32 s43, s43, 65535
  s_waitcnt vmcnt(4) lgkmcnt(0)
  s_barrier
  s_mov_b32 s50, 2
w2a_l2:
  s_add_u32 m0, s43, s45
  s_add_u32 s44, s41, s40
  buffer_load_dwordx4 v8, s[16:19], s44 offen sc1 lds
  s_add_u32 s40, s40, 4096
  s_add_u32 s43, s43, 8192
  s_and_b32 s43, s43, 65535
  s_add_u32 m0, s43, s45
  s_add_u32 s44, s41, s40
  buffer_load_dwordx4 v8, s[16:19], s44 offen sc1 lds
  s_add_u32 s40, s40, 4096
  s_add_u32 s43, s43, 8192
  s_and_b32 s43, s43, 65535
  s_waitcnt vmcnt(4) lgkmcnt(0)
  s_barrier
  s_sub_u32 s50, s50, 1
  s_cmp_lg_u32 s50, 0
  s_cbranch_scc1 w2a_l2
  s_add_u32 m0, s43, s45
  s_add_u32 s44, s41, s40
  buffer_load_dwordx4 v8, s[16:19], s44 offen sc1 lds
  s_add_u32 s40, s40, 4096
  s_add_u32 s43, s43, 8192
  s_and_b32 s43, s43, 65535
  s_add_u32 m0, s43, s45
  s_add_u32 s44, s41, s40
  buffer_load_dwordx4 v8, s[16:19], s44 offen sc1 lds
  s_add_u32 s40, s40, 4096
  s_add_u32 s43, s43, 8192
  s_and_b32 s43, s43, 65535
  buffer_load_dwordx2 v[16:17], v14, s[16:19], s47 offen sc1
  s_waitcnt vmcnt(4) lgkmcnt(0)
  s_barrier
  s_waitcnt vmcnt(0)
  v_xor_b32 v16, s52, v16
  v_xor_b32 v17, s53, v17
  v_or_b32 v16, v16, v17
  v_cmp_ne_u32 vcc, 0, v16
  s_cbranch_vccz w2a_x_ok
  s_mov_b32 s55, 200000
  v_lshlrev_b32 v9, 2, v0
  s_mov_b64 exec, 1
w2a_x_poll:
  buffer_load_dwordx2 v[12:13], v9, s[16:19], s47 offen sc1
  s_waitcnt vmcnt(0)
  v_xor_b32 v12, s52, v12
  v_xor_b32 v13, s53, v13
  v_or_b32 v10, v12, v13
  v_cmp_ne_u32 vcc, 0, v10
  s_cbranch_vccz w2a_x_ok
  s_sleep 2
  s_sub_u32 s55, s55, 1
  s_cmp_lg_u32 s55, 0
  s_cbranch_scc1 w2a_x_poll
w2a_x_ok:
  s_mov_b64 exec, -1
  s_waitcnt vmcnt(2) lgkmcnt(0)
  s_barrier
  s_mov_b32 s50, 2
w2a_l3:
  s_waitcnt vmcnt(0) lgkmcnt(0)
  s_barrier
  s_sub_u32 s50, s50, 1
  s_cmp_lg_u32 s50, 0
  s_cbranch_scc1 w2a_l3
  s_branch w2_lend
w2_regs:
  s_mov_b32 s50, 4
w2b_l0:
  s_add_u32 m0, s43, s45
  s_add_u32 s44, s41, s40
  buffer_load_dwordx4 v8, s[16:19], s44 offen sc1 lds
  s_add_u32 m0, m0, 4096
  s_add_u32 s44, s42, s40
  buffer_load_dwordx4 v8, s[16:19], s44 offen sc1 lds
  s_add_u32 s40, s40, 4096
  s_cmp_eq_u32 s40, s21
  s_cselect_b32 s40, s22, s40
  s_cmp_eq_u32 s40, s23
  s_cselect_b32 s40, s24, s40
  s_add_u32 s43, s43, 8192
  s_and_b32 s43, s43, 65535
  s_add_u32 m0, s43, s45
  s_add_u32 s44, s41, s40
  buffer_load_dwordx4 v8, s[16:19], s44 offen sc1 lds
  s_add_u32 m0, m0, 4096
  s_add_u32 s44, s42, s40
  buffer_load_dwordx4 v8, s[16:19], s44 offen sc1 lds
  s_add_u32 s40, s40, 4096
  s_cmp_eq_u32 s40, s21
  s_cselect_b32 s40, s22, s40
  s_cmp_eq_u32 s40, s23
  s_cselect_b32 s40, s24, s40
  s_add_u32 s43, s43, 8192
  s_and_b32 s43, s43, 65535
  s_waitcnt vmcnt(8) lgkmcnt(0)
  s_barrier
  s_sub_u32 s50, s50, 1
  s_cmp_lg_u32 s50, 0
  s_cbranch_scc1 w2b_l0
  s_add_u32 m0, s43, s45
  s_add_u32 s44, s41, s40
  buffer_load_dwordx4 v8, s[16:19], s44 offen sc1 lds
  ds_write_b128 v20, v[72:75] offset:36864
  s_add_u32 s40, s40, 4096
  s_cmp_eq_u32 s40, s21
  s_cselect_b32 s40, s22, s40
  s_cmp_eq_u32 s40, s23
  s_cselect_b32 s40, s24, s40
  s_add_u32 s43, s43, 8192
  s_and_b32 s43, s43, 65535
  s_add_u32 m0, s43, s45
  s_add_u32 s44, s41, s40
  buffer_load_dwordx4 v8, s[16:19], s44 offen sc1 lds
  ds_write_b128 v20, v[76:79] offset:45056
  s_add_u32 s40, s40, 4096
  s_cmp_eq_u32 s40, s21
  s_cselect_b32 s40, s22, s40
  s_cmp_eq_u32 s40, s23
  s_cselect_b32 s40, s24, s40
  s_add_u32 s43, s43, 8192
  s_and_b32 s43, s43, 65535
  s_waitcnt vmcnt(6) lgkmcnt(0)
  s_barrier
  s_add_u32 m0, s43, s45
  s_add_u32 s44, s41, s40
  buffer_load_dwordx4 v8, s[16:19], s44 offen sc1 lds
  ds_write_b128 v20, v[80:83] offset:53248
  s_add_u32 s40, s40, 4096
  s_cmp_eq_u32 s40, s21
  s_cselect_b32 s40, s22, s40
  s_cmp_eq_u32 s40, s23
  s_cselect_b32 s40, s24, s40
  s_add_u32 s43, s43, 8192
  s_and_b32 s43, s43, 65535
  s_add_u32 m0, s43, s45
  s_add_u32 s44, s41, s40
  buffer_load_dwordx4 v8, s[16:19], s44 offen sc1 lds
  ds_write_b128 v20, v[84:87] offset:61440
  s_add_u32 s40, s40, 4096
  s_cmp_eq_u32 s40, s21
  s_cselect_b32 s40, s22, s40
  s_cmp_eq_u32 s40, s23
  s_cselect_b32 s40, s24, s40
  s_add_u32 s43, s43, 8192
  s_and_b32 s43, s43, 65535
  s_waitcnt vmcnt(4) lgkmcnt(0)
  s_barrier
  s_add_u32 m0, s43, s45
  s_add_u32 s44, s41, s40
  buffer_load_dwordx4 v8, s[16:19], s44 offen sc1 lds
  ds_write_b128 v20, v[88:91] offset:4096
  s_add_u32 s40, s40, 4096
  s_cmp_eq_u32 s40, s21
  s_cselect_b32 s40, s22, s40
  s_cmp_eq_u32 s40, s23
  s_cselect_b32 s40, s24, s40
  s_add_u32 s43, s43, 8192
  s_and_b32 s43, s43, 65535
  s_add_u32 m0, s43, s45
  s_add_u32 s44, s41, s40
  buffer_load_dwordx4 v8, s[16:19], s44 offen sc1 lds
  ds_write_b128 v20, v[92:95] offset:12288
  s_add_u32 s40, s40, 4096
  s_cmp_eq_u32 s40, s21
  s_cselect_b32 s40, s22, s40
  s_cmp_eq_u32 s40, s23
  s_cselect_b32 s40, s24, s40
  s_add_u32 s43, s43, 8192
  s_and_b32 s43, s43, 65535
  s_waitcnt vmcnt(4) lgkmcnt(0)
  s_barrier
  s_add_u32 m0, s43, s45
  s_add_u32 s44, s41, s40
  buffer_load_dwordx4 v8, s[16:19], s44 offen sc1 lds
  ds_write_b128 v20, v[96:99] offset:20480
  s_add_u32 s40, s40, 4096
  s_cmp_eq_u32 s40, s21
  s_cselect_b32 s40, s22, s40
  s_cmp_eq_u32 s40, s23
  s_cselect_b32 s40, s24, s40
  s_add_u32 s43, s43, 8192
  s_and_b32 s43, s43, 65535
  s_add_u32 m0, s43, s45
  s_add_u32 s44, s41, s40
  buffer_load_dwordx4 v8, s[16:19], s44 offen sc1 lds
  ds_write_b128 v20, v[100:103] offset:28672
  s_add_u32 s40, s40, 4096
  s_cmp_eq_u32 s40, s21
  s_cselect_b32 s40, s22, s40
  s_cmp_eq_u32 s40, s23
  s_cselect_b32 s40, s24, s40
  s_add_u32 s43, s43, 8192
  s_and_b32 s43, s43, 65535
  s_waitcnt vmcnt(4) lgkmcnt(0)
  s_barrier
  s_add_u32 m0, s43, s45
  s_add_u32 s44, s41, s40
  buffer_load_dwordx4 v8, s[16:19], s44 offen sc1 lds
  ds_write_b128 v20, v[104:107] offset:36864
  s_add_u32 s40, s40, 4096
  s_cmp_eq_u32 s40, s21
  s_cselect_b32 s40, s22, s40
  s_cmp_eq_u32 s40, s23
  s_cselect_b32 s40, s24, s40
  s_add_u32 s43, s43, 8192
  s_and_b32 s43, s43, 65535
  s_add_u32 m0, s43, s45
  s_add_u32 s44, s41, s40
  buffer_load_dwordx4 v8, s[16:19], s44 offen sc1 lds
  ds_write_b128 v20, v[108:111] offset:45056
  s_add_u32 s40, s40, 4096
  s_cmp_eq_u32 s40, s21
  s_cselect_b32 s40, s22, s40
  s_cmp_eq_u32 s40, s23
  s_cselect_b32 s40, s24, s40
  s_add_u32 s43, s43, 8192
  s_and_b32 s43, s43, 65535
  s_waitcnt vmcnt(4) lgkmcnt(0)
  s_barrier
  s_add_u32 m0, s43, s45
  s_add_u32 s44, s41, s40
  buffer_load_dwordx4 v8, s[16:19], s44 offen sc1 lds
  ds_write_b128 v20, v[112:115] offset:53248
  s_add_u32 s40, s40, 4096
  s_cmp_eq_u32 s40, s21
  s_cselect_b32 s40, s22, s40
  s_cmp_eq_u32 s40, s23
  s_cselect_b32 s40, s24, s40
  s_add_u32 s43, s43, 8192
  s_and_b32 s43, s43, 65535
  s_add_u32 m0, s43, s45
  s_add_u32 s44, s41, s40
  buffer_load_dwordx4 v8, s[16:19], s44 offen sc1 lds
  ds_write_b128 v20, v[116:119] offset:61440
  s_add_u32 s40, s40, 4096
  s_cmp_eq_u32 s40, s21
  s_cselect_b32 s40, s22, s40
  s_cmp_eq_u32 s40, s23
  s_cselect_b32 s40, s24, s40
  s_add_u32 s43, s43, 8192
  s_and_b32 s43, s43, 65535
  s_waitcnt vmcnt(4) lgkmcnt(0)
  s_barrier
  s_add_u32 m0, s43, s45
  s_add_u32 s44, s41, s40
  buffer_load_dwordx4 v8, s[16:19], s44 offen sc1 lds
  ds_write_b128 v20, v[120:123] offset:4096
  s_add_u32 s40, s40, 4096
  s_cmp_eq_u32 s40, s21
  s_cselect_b32 s40, s22, s40
  s_cmp_eq_u32 s40, s23
  s_cselect_b32 s40, s24, s40
  s_add_u32 s43, s43, 8192
  s_and_b32 s43, s43, 65535
  s_add_u32 m0, s43, s45
  s_add_u32 s44, s41, s40
  buffer_load_dwordx4 v8, s[16:19], s44 offen sc1 lds
  ds_write_b128 v20, v[124:127] offset:12288
  s_add_u32 s40, s40, 4096
  s_cmp_eq_u32 s40, s21
  s_cselect_b32 s40, s22, s40
  s_cmp_eq_u32 s40, s23
  s_cselect_b32 s40, s24, s40
  s_add_u32 s43, s43, 8192
  s_and_b32 s43, s43, 65535
  s_waitcnt vmcnt(4) lgkmcnt(0)
  s_barrier
  s_add_u32 m0, s43, s45
  s_add_u32 s44, s41, s40
  buffer_load_dwordx4 v8, s[16:19], s44 offen sc1 lds
  ds_write_b128 v20, v[128:131] offset:20480
  s_add_u32 s40, s40, 4096
  s_cmp_eq_u32 s40, s21
  s_cselect_b32 s40, s22, s40
  s_cmp_eq_u32 s40, s23
  s_cselect_b32 s40, s24, s40
  s_add_u32 s43, s43, 8192
  s_and_b32 s43, s43, 65535
  s_add_u32 m0, s43, s45
  s_add_u32 s44, s41, s40
  buffer_load_dwordx4 v8, s[16:19], s44 offen sc1 lds
  ds_write_b128 v20, v[132:135] offset:28672
  s_add_u32 s40, s40, 4096
  s_cmp_eq_u32 s40, s21
  s_cselect_b32 s40, s22, s40
  s_cmp_eq_u32 s40, s23
  s_cselect_b32 s40, s24, s40
  s_add_u32 s43, s43, 8192
  s_and_b32 s43, s43, 65535
  s_waitcnt vmcnt(4) lgkmcnt(0)
  s_barrier
  s_add_u32 m0, s43, s45
  s_add_u32 s44, s41, s40
  buffer_load_dwordx4 v8, s[16:19], s44 offen sc1 lds
  ds_write_b128 v20, v[136:139] offset:36864
  s_add_u32 s40, s40, 4096
  s_cmp_eq_u32 s40, s21
  s_cselect_b32 s40, s22, s40
  s_cmp_eq_u32 s40, s23
  s_cselect_b32 s40, s24, s40
  s_add_u32 s43, s43, 8192
  s_and_b32 s43, s43, 65535
  s_add_u32 m0, s43, s45
  s_add_u32 s44, s41, s40
  buffer_load_dwordx4 v8, s[16:19], s44 offen sc1 lds
  ds_write_b128 v20, v[140:143] offset:45056
  s_add_u32 s40, s40, 4096
  s_cmp_eq_u32 s40, s21
  s_cselect_b32 s40, s22, s40
  s_cmp_eq_u32 s40, s23
  s_cselect_b32 s40, s24, s40
  s_add_u32 s43, s43, 8192
  s_and_b32 s43, s43, 65535
  s_waitcnt vmcnt(4) lgkmcnt(0)
  s_barrier
  s_add_u32 m0, s43, s45
  s_add_u32 s44, s41, s40
  buffer_load_dwordx4 v8, s[16:19], s44 offen sc1 lds
  ds_write_b128 v20, v[144:147] offset:53248
  s_add_u32 s40, s40, 4096
  s_cmp_eq_u32 s40, s21
  s_cselect_b32 s40, s22, s40
  s_cmp_eq_u32 s40, s23
  s_cselect_b32 s40, s24, s40
  s_add_u32 s43, s43, 8192
  s_and_b32 s43, s43, 65535
  s_add_u32 m0, s43, s45
  s_add_u32 s44, s41, s40
  buffer_load_dwordx4 v8, s[16:19], s44 offen sc1 lds
  ds_write_b128 v20, v[148:151] offset:61440
  s_add_u32 s40, s40, 4096
  s_cmp_eq_u32 s40, s21
  s_cselect_b32 s40, s22, s40
  s_cmp_eq_u32 s40, s23
  s_cselect_b32 s40, s24, s40
  s_add_u32 s43, s43, 8192
  s_and_b32 s43, s43, 65535
  s_waitcnt vmcnt(4) lgkmcnt(0)
  s_barrier
  s_add_u32 m0, s43, s45
  s_add_u32 s44, s41, s40
  buffer_load_dwordx4 v8, s[16:19], s44 offen sc1 lds
  ds_write_b128 v20, v[152:155] offset:4096
  s_add_u32 s40, s40, 4096
  s_cmp_eq_u32 s40, s21
  s_cselect_b32 s40, s22, s40
  s_cmp_eq_u32 s40, s23
  s_cselect_b32 s40, s24, s40
  s_add_u32 s43, s43, 8192
  s_and_b32 s43, s43, 65535
  s_add_u32 m0, s43, s45
  s_add_u32 s44, s41, s40
  buffer_load_dwordx4 v8, s[16:19], s44 offen sc1 lds
  ds_write_b128 v20, v[156:159] offset:12288
  s_add_u32 s40, s40, 4096
  s_cmp_eq_u32 s40, s21
  s_cselect_b32 s40, s22, s40
  s_cmp_eq_u32 s40, s23
  s_cselect_b32 s40, s24, s40
  s_add_u32 s43, s43, 8192
  s_and_b32 s43, s43, 65535
  s_waitcnt vmcnt(4) lgkmcnt(0)
  s_barrier
  s_add_u32 m0, s43, s45
  s_add_u32 s44, s41, s40
  buffer_load_dwordx4 v8, s[16:19], s44 offen sc1 lds
  ds_write_b128 v20, v[160:163] offset:20480
  s_add_u32 s40, s40, 4096
  s_cmp_eq_u32 s40, s21
  s_cselect_b32 s40, s22, s40
  s_cmp_eq_u32 s40, s23
  s_cselect_b32 s40, s24, s40
  s_add_u32 s43, s43, 8192
  s_and_b32 s43, s43, 65535
  s_add_u32 m0, s43, s45
  s_add_u32 s44, s41, s40
  buffer_load_dwordx4 v8, s[16:19], s44 offen sc1 lds
  ds_write_b128 v20, v[164:167] offset:28672
  s_add_u32 s40, s40, 4096
  s_cmp_eq_u32 s40, s21
  s_cselect_b32 s40, s22, s40
  s_cmp_eq_u32 s40, s23
  s_cselect_b32 s40, s24, s40
  s_add_u32 s43, s43, 8192
  s_and_b32 s43, s43, 65535
  s_waitcnt vmcnt(4) lgkmcnt(0)
  s_barrier
  s_add_u32 m0, s43, s45
  s_add_u32 s44, s41, s40
  buffer_load_dwordx4 v8, s[16:19], s44 offen sc1 lds
  ds_write_b128 v20, v[168:171] offset:36864
  s_add_u32 s40, s40, 4096
  s_cmp_eq_u32 s40, s21
  s_cselect_b32 s40, s22, s40
  s_cmp_eq_u32 s40, s23
  s_cselect_b32 s40, s24, s40
  s_add_u32 s43, s43, 8192
  s_and_b32 s43, s43, 65535
  s_add_u32 m0, s43, s45
  s_add_u32 s44, s41, s40
  buffer_load_dwordx4 v8, s[16:19], s44 offen sc1 lds
  ds_write_b128 v20, v[172:175] offset:45056
  s_add_u32 s40, s40, 4096
  s_cmp_eq_u32 s40, s21
  s_cselect_b32 s40, s22, s40
  s_cmp_eq_u32 s40, s23
  s_cselect_b32 s40, s24, s40
  s_add_u32 s43, s43, 8192
  s_and_b32 s43, s43, 65535
  s_waitcnt vmcnt(4) lgkmcnt(0)
  s_barrier
  ds_write_b128 v20, v[176:179] offset:49152
  s_add_u32 s40, s40, 4096
  s_add_u32 s43, s43, 8192
  s_and_b32 s43, s43, 65535
  ds_write_b128 v20, v[180:183] offset:57344
  s_add_u32 s40, s40, 4096
  s_add_u32 s43, s43, 8192
  s_and_b32 s43, s43, 65535
  s_waitcnt vmcnt(2) lgkmcnt(0)
  s_barrier
  ds_write_b128 v20, v[184:187] offset:0
  s_add_u32 s40, s40, 4096
  s_add_u32 s43, s43, 8192
  s_and_b32 s43, s43, 65535
  ds_write_b128 v20, v[188:191] offset:8192
  s_add_u32 s40, s40, 4096
  s_add_u32 s43, s43, 8192
  s_and_b32 s43, s43, 65535
  s_waitcnt vmcnt(0) lgkmcnt(0)
  s_barrier
  ds_write_b128 v20, v[192:195] offset:16384
  s_add_u32 s40, s40, 4096
  s_add_u32 s43, s43, 8192
  s_and_b32 s43, s43, 65535
  ds_write_b128 v20, v[196:199] offset:24576
  s_add_u32 s40, s40, 4096
  s_add_u32 s43, s43, 8192
  s_and_b32 s43, s43, 65535
  s_waitcnt vmcnt(0) lgkmcnt(0)
  s_barrier
  ds_write_b128 v20, v[200:203] offset:32768
  s_add_u32 s40, s40, 4096
  s_add_u32 s43, s43, 8192
  s_and_b32 s43, s43, 65535
  ds_write_b128 v20, v[204:207] offset:40960
  s_add_u32 s40, s40, 4096
  s_add_u32 s43, s43, 8192
  s_and_b32 s43, s43, 65535
  s_waitcnt vmcnt(0) lgkmcnt(0)
  s_barrier
  ds_write_b128 v20, v[208:211] offset:49152
  s_add_u32 s40, s40, 4096
  s_add_u32 s43, s43, 8192
  s_and_b32 s43, s43, 65535
  ds_write_b128 v20, v[212:215] offset:57344
  s_add_u32 s40, s40, 4096
  s_add_u32 s43, s43, 8192
  s_and_b32 s43, s43, 65535
  s_waitcnt vmcnt(0) lgkmcnt(0)
  s_barrier
  s_add_u32 s40, s24, 229376
  ds_write_b128 v20, v[216:219] offset:0
  s_add_u32 s40, s40, 4096
  s_add_u32 s43, s43, 8192
  s_and_b32 s43, s43, 65535
  ds_write_b128 v20, v[220:223] offset:8192
  s_add_u32 s40, s40, 4096
  s_add_u32 s43, s43, 8192
  s_and_b32 s43, s43, 65535
  s_waitcnt vmcnt(0) lgkmcnt(0)
  s_barrier
  s_cmp_lg_u32 s3, 0
  s_cbranch_scc1 w2b_nf2
  v_lshlrev_b32 v9, 7, v0
  v_mov_b32 v12, s52
  v_mov_b32 v13, s53
  s_mov_b64 exec, 1
  buffer_store_dwordx2 v[12:13], v9, s[16:19], s46 offen sc1
  s_mov_b64 exec, -1
w2b_nf2:
  ds_write_b128 v20, v[224:227] offset:16384
  s_add_u32 s40, s40, 4096
  s_add_u32 s43, s43, 8192
  s_and_b32 s43, s43, 65535
  ds_write_b128 v20, v[228:231] offset:24576
  s_add_u32 s40, s40, 4096
  s_add_u32 s43, s43, 8192
  s_and_b32 s43, s43, 65535
  s_waitcnt vmcnt(0) lgkmcnt(0)
  s_barrier
  ds_write_b128 v20, v[232:235] offset:32768
  s_add_u32 s40, s40, 4096
  s_add_u32 s43, s43, 8192
  s_and_b32 s43, s43, 65535
  ds_write_b128 v20, v[236:239] offset:40960
  s_add_u32 s40, s40, 4096
  s_add_u32 s43, s43, 8192
  s_and_b32 s43, s43, 65535
  s_waitcnt vmcnt(0) lgkmcnt(0)
  s_barrier
  ds_write_b128 v20, v[240:243] offset:49152
  s_add_u32 s40, s40, 4096
  s_add_u32 s43, s43, 8192
  s_and_b32 s43, s43, 65535
  ds_write_b128 v20, v[244:247] offset:57344
  s_add_u32 s40, s40, 4096
  s_add_u32 s43, s43, 8192
  s_and_b32 s43, s43, 65535
  s_waitcnt vmcnt(0) lgkmcnt(0)
  s_barrier
  ds_write_b128 v20, v[248:251] offset:0
  s_add_u32 s40, s40, 4096
  s_add_u32 s43, s43, 8192
  s_and_b32 s43, s43, 65535
  ds_write_b128 v20, v[252:255] offset:8192
  s_add_u32 s40, s40, 4096
  s_add_u32 s43, s43, 8192
  s_and_b32 s43, s43, 65535
  buffer_load_dwordx2 v[16:17], v14, s[16:19], s47 offen sc1
  s_waitcnt vmcnt(0) lgkmcnt(0)
  s_barrier
  s_waitcnt vmcnt(0)
  v_xor_b32 v16, s52, v16
  v_xor_b32 v17, s53, v17
  v_or_b32 v16, v16, v17
  v_cmp_ne_u32 vcc, 0, v16
  s_cbranch_vccz w2b_x_ok
  s_mov_b32 s55, 200000
  v_lshlrev_b32 v9, 2, v0
  s_mov_b64 exec, 1
w2b_x_poll:
  buffer_load_dwordx2 v[12:13], v9, s[16:19], s47 offen sc1
  s_waitcnt vmcnt(0)
  v_xor_b32 v12, s52, v12
  v_xor_b32 v13, s53, v13
  v_or_b32 v10, v12, v13
  v_cmp_ne_u32 vcc, 0, v10
  s_cbranch_vccz w2b_x_ok
  s_sleep 2
  s_sub_u32 s55, s55, 1
  s_cmp_lg_u32 s55, 0
  s_cbranch_scc1 w2b_x_poll
w2b_x_ok:
  s_mov_b64 exec, -1
  s_waitcnt vmcnt(0) lgkmcnt(0)
  s_barrier
  s_mov_b32 s50, 2
w2b_l1:
  s_waitcnt vmcnt(0) lgkmcnt(0)
  s_barrier
  s_sub_u32 s50, s50, 1
  s_cmp_lg_u32 s50, 0
  s_cbranch_scc1 w2b_l1
w2_lend:
  s_cmp_lg_u32 s10, 0
  s_cbranch_scc1 main_exit
  s_mov_b32 s10, 48234496
  s_add_u32 s6, s6, 48234496
  s_mov_b32 s11, 97746944
  s_branch main_lay_l
main_exit:
  s_endpgm
.p2align 6
main_cons:
main_lay_c:
  s_waitcnt vmcnt(0) lgkmcnt(0)
  s_barrier
  v_lshlrev_b32 v8, 4, v0
  v_and_b32 v1, 15, v0
  v_lshrrev_b32 v2, 4, v0
  s_lshl_b32 s34, s32, 12
  v_add_u32 v4, s34, v8
  s_lshl_b32 s34, s33, 11
  s_add_u32 s34, s34, 8192
  v_add_u32 v6, s34, v8
  v_mov_b32 v96, 0
  v_mov_b32 v97, 0
  v_mov_b32 v98, 0
  v_mov_b32 v99, 0
  v_mov_b32 v100, 0
  v_mov_b32 v101, 0
  v_mov_b32 v102, 0
  v_mov_b32 v103, 0
  v_mov_b32 v104, 0
  v_mov_b32 v105, 0
  v_mov_b32 v106, 0
  v_mov_b32 v107, 0
  v_mov_b32 v108, 0
  v_mov_b32 v109, 0
  v_mov_b32 v110, 0
  v_mov_b32 v111, 0
  v_mov_b32 v112, 0
  v_mov_b32 v113, 0
  v_mov_b32 v114, 0
  v_mov_b32 v115, 0
  v_mov_b32 v116, 0
  v_mov_b32 v117, 0
  v_mov_b32 v118, 0
  v_mov_b32 v119, 0
  v_mov_b32 v120, 0
  v_mov_b32 v121, 0
  v_mov_b32 v122, 0
  v_mov_b32 v123, 0
  v_mov_b32 v124, 0
  v_mov_b32 v125, 0
  v_mov_b32 v126, 0
  v_mov_b32 v127, 0
  v_mov_b32 v128, 0
  v_mov_b32 v129, 0
  v_mov_b32 v130, 0
  v_mov_b32 v131, 0
  v_mov_b32 v132, 0
  v_mov_b32 v133, 0
  v_mov_b32 v134, 0
  v_mov_b32 v135, 0
  v_mov_b32 v136, 0
  v_mov_b32 v137, 0
  v_mov_b32 v138, 0
  v_mov_b32 v139, 0
  v_mov_b32 v140, 0
  v_mov_b32 v141, 0
  v_mov_b32 v142, 0
  v_mov_b32 v143, 0
  v_mov_b32 v144, 0
  v_mov_b32 v145, 0
  v_mov_b32 v146, 0
  v_mov_b32 v147, 0
  v_mov_b32 v148, 0
  v_mov_b32 v149, 0
  v_mov_b32 v150, 0
  v_mov_b32 v151, 0
  v_mov_b32 v152, 0
  v_mov_b32 v153, 0
  v_mov_b32 v154, 0
  v_mov_b32 v155, 0
  v_mov_b32 v156, 0
  v_mov_b32 v157, 0
  v_mov_b32 v158, 0
  v_mov_b32 v159, 0
  v_mov_b32 v160, 0
  v_mov_b32 v161, 0
  v_mov_b32 v162, 0
  v_mov_b32 v163, 0
  v_mov_b32 v164, 0
  v_mov_b32 v165, 0
  v_mov_b32 v166, 0
  v_mov_b32 v167, 0
  v_mov_b32 v168, 0
  v_mov_b32 v169, 0
  v_mov_b32 v170, 0
  v_mov_b32 v171, 0
  v_mov_b32 v172, 0
  v_mov_b32 v173, 0
  v_mov_b32 v174, 0
  v_mov_b32 v175, 0
  v_mov_b32 v176, 0
  v_mov_b32 v177, 0
  v_mov_b32 v178, 0
  v_mov_b32 v179, 0
  v_mov_b32 v180, 0
  v_mov_b32 v181, 0
  v_mov_b32 v182, 0
  v_mov_b32 v183, 0
  v_mov_b32 v184, 0
  v_mov_b32 v185, 0
  v_mov_b32 v186, 0
  v_mov_b32 v187, 0
  v_mov_b32 v188, 0
  v_mov_b32 v189, 0
  v_mov_b32 v190, 0
  v_mov_b32 v191, 0
  s_mov_b32 s44, 135274560
  s_mov_b32 s45, 0
  s_mov_b32 s43, 4294844416
  s_mov_b32 s41, 0
  s_bitcmp1_b64 s[44:45], s41
  s_cselect_b32 s42, s43, 20480
  s_add_u32 s41, s41, 1
  ds_read_b128 v[16:19], v4 offset:0
  ds_read_b128 v[20:23], v4 offset:1024
  ds_read_b128 v[24:27], v4 offset:2048
  ds_read_b128 v[28:31], v4 offset:3072
  ds_read_b128 v[32:35], v6 offset:0
  ds_read_b128 v[36:39], v6 offset:1024
  ds_read_b128 v[40:43], v6 offset:4096
  ds_read_b128 v[44:47], v6 offset:5120
  ds_read_b128 v[48:51], v6 offset:8192
  ds_read_b128 v[52:55], v6 offset:9216
  v_add_u32 v4, s42, v4
  v_add_u32 v6, s42, v6
  s_waitcnt lgkmcnt(0)
.p2align 6
qkv_cloop:
  v_mfma_f32_16x16x32_bf16 v[96:99], v[32:35], v[16:19], v[96:99]
  ds_read_b128 v[56:59], v4 offset:0
  v_mfma_f32_16x16x32_bf16 v[120:123], v[32:35], v[20:23], v[120:123]
  ds_read_b128 v[60:63], v4 offset:1024
  v_mfma_f32_16x16x32_bf16 v[144:147], v[32:35], v[24:27], v[144:147]
  ds_read_b128 v[64:67], v4 offset:2048
  v_mfma_f32_16x16x32_bf16 v[168:171], v[32:35], v[28:31], v[168:171]
  ds_read_b128 v[68:71], v4 offset:3072
  v_mfma_f32_16x16x32_bf16 v[100:103], v[36:39], v[16:19], v[100:103]
  ds_read_b128 v[72:75], v6 offset:0
  v_mfma_f32_16x16x32_bf16 v[124:127], v[36:39], v[20:23], v[124:127]
  ds_read_b128 v[76:79], v6 offset:1024
  v_mfma_f32_16x16x32_bf16 v[148:151], v[36:39], v[24:27], v[148:151]
  ds_read_b128 v[80:83], v6 offset:4096
  v_mfma_f32_16x16x32_bf16 v[172:175], v[36:39], v[28:31], v[172:175]
  ds_read_b128 v[84:87], v6 offset:5120
  v_mfma_f32_16x16x32_bf16 v[104:107], v[40:43], v[16:19], v[104:107]
  ds_read_b128 v[88:91], v6 offset:8192
  v_mfma_f32_16x16x32_bf16 v[128:131], v[40:43], v[20:23], v[128:131]
  ds_read_b128 v[92:95], v6 offset:9216
  v_mfma_f32_16x16x32_bf16 v[152:155], v[40:43], v[24:27], v[152:155]
  s_bitcmp1_b64 s[44:45], s41
  v_mfma_f32_16x16x32_bf16 v[176:179], v[40:43], v[28:31], v[176:179]
  s_cselect_b32 s42, s43, 20480
  v_mfma_f32_16x16x32_bf16 v[108:111], v[44:47], v[16:19], v[108:111]
  s_add_u32 s41, s41, 1
  v_mfma_f32_16x16x32_bf16 v[132:135], v[44:47], v[20:23], v[132:135]
  v_add_u32 v4, s42, v4
  v_mfma_f32_16x16x32_bf16 v[156:159], v[44:47], v[24:27], v[156:159]
  v_add_u32 v6, s42, v6
  v_mfma_f32_16x16x32_bf16 v[180:183], v[44:47], v[28:31], v[180:183]
  v_mfma_f32_16x16x32_bf16 v[112:115], v[16:19], v[48:51], v[112:115]
  v_mfma_f32_16x16x32_bf16 v[136:139], v[20:23], v[48:51], v[136:139]
  v_mfma_f32_16x16x32_bf16 v[160:163], v[24:27], v[48:51], v[160:163]
  v_mfma_f32_16x16x32_bf16 v[184:187], v[28:31], v[48:51], v[184:187]
  v_mfma_f32_16x16x32_bf16 v[116:119], v[16:19], v[52:55], v[116:119]
  v_mfma_f32_16x16x32_bf16 v[140:143], v[20:23], v[52:55], v[140:143]
  v_mfma_f32_16x16x32_bf16 v[164:167], v[24:27], v[52:55], v[164:167]
  s_waitcnt lgkmcnt(0)
  s_barrier
  v_mfma_f32_16x16x32_bf16 v[188:191], v[28:31], v[52:55], v[188:191]
  v_mfma_f32_16x16x32_bf16 v[96:99], v[72:75], v[56:59], v[96:99]
  ds_read_b128 v[16:19], v4 offset:0
  v_mfma_f32_16x16x32_bf16 v[120:123], v[72:75], v[60:63], v[120:123]
  ds_read_b128 v[20:23], v4 offset:1024
  v_mfma_f32_16x16x32_bf16 v[144:147], v[72:75], v[64:67], v[144:147]
  ds_read_b128 v[24:27], v4 offset:2048
  v_mfma_f32_16x16x32_bf16 v[168:171], v[72:75], v[68:71], v[168:171]
  ds_read_b128 v[28:31], v4 offset:3072
  v_mfma_f32_16x16x32_bf16 v[100:103], v[76:79], v[56:59], v[100:103]
  ds_read_b128 v[32:35], v6 offset:0
  v_mfma_f32_16x16x32_bf16 v[124:127], v[76:79], v[60:63], v[124:127]
  ds_read_b128 v[36:39], v6 offset:1024
  v_mfma_f32_16x16x32_bf16 v[148:151], v[76:79], v[64:67], v[148:151]
  ds_read_b128 v[40:43], v6 offset:4096
  v_mfma_f32_16x16x32_bf16 v[172:175], v[76:79], v[68:71], v[172:175]
  ds_read_b128 v[44:47], v6 offset:5120
  v_mfma_f32_16x16x32_bf16 v[104:107], v[80:83], v[56:59], v[104:107]
  ds_read_b128 v[48:51], v6 offset:8192
  v_mfma_f32_16x16x32_bf16 v[128:131], v[80:83], v[60:63], v[128:131]
  ds_read_b128 v[52:55], v6 offset:9216
  v_mfma_f32_16x16x32_bf16 v[152:155], v[80:83], v[64:67], v[152:155]
  s_bitcmp1_b64 s[44:45], s41
  v_mfma_f32_16x16x32_bf16 v[176:179], v[80:83], v[68:71], v[176:179]
  s_cselect_b32 s42, s43, 20480
  v_mfma_f32_16x16x32_bf16 v[108:111], v[84:87], v[56:59], v[108:111]
  s_add_u32 s41, s41, 1
  v_mfma_f32_16x16x32_bf16 v[132:135], v[84:87], v[60:63], v[132:135]
  v_add_u32 v4, s42, v4
  v_mfma_f32_16x16x32_bf16 v[156:159], v[84:87], v[64:67], v[156:159]
  v_add_u32 v6, s42, v6
  v_mfma_f32_16x16x32_bf16 v[180:183], v[84:87], v[68:71], v[180:183]
  v_mfma_f32_16x16x32_bf16 v[112:115], v[56:59], v[88:91], v[112:115]
  v_mfma_f32_16x16x32_bf16 v[136:139], v[60:63], v[88:91], v[136:139]
  v_mfma_f32_16x16x32_bf16 v[160:163], v[64:67], v[88:91], v[160:163]
  v_mfma_f32_16x16x32_bf16 v[184:187], v[68:71], v[88:91], v[184:187]
  v_mfma_f32_16x16x32_bf16 v[116:119], v[56:59], v[92:95], v[116:119]
  s_cmp_lt_u32 s41, 33
  v_mfma_f32_16x16x32_bf16 v[140:143], v[60:63], v[92:95], v[140:143]
  v_mfma_f32_16x16x32_bf16 v[164:167], v[64:67], v[92:95], v[164:167]
  s_waitcnt lgkmcnt(0)
  v_mfma_f32_16x16x32_bf16 v[188:191], v[68:71], v[92:95], v[188:191]
  s_cbranch_scc1 qkv_cloop
qkv_epi:
  s_lshl_b32 s34, s32, 8
  s_add_u32 s34, s34, 161792
  v_lshlrev_b32 v3, 2, v1
  v_add_u32 v3, s34, v3
  ds_read_b32 v16, v3 offset:0
  ds_read_b32 v17, v3 offset:512
  ds_read_b32 v18, v3 offset:64
  ds_read_b32 v19, v3 offset:576
  ds_read_b32 v20, v3 offset:128
  ds_read_b32 v21, v3 offset:640
  ds_read_b32 v22, v3 offset:192
  ds_read_b32 v23, v3 offset:704
  v_lshlrev_b32 v13, 4, v2
  v_add_u32 v13, 162816, v13
  s_lshl_b32 s35, s33, 7
  v_add_u32 v15, s35, v13
  ds_read_b128 v[24:27], v15 offset:0
  ds_read_b128 v[28:31], v15 offset:64
  ds_read_b128 v[32:35], v15 offset:256
  ds_read_b128 v[36:39], v15 offset:320
  v_lshlrev_b32 v14, 2, v1
  v_add_u32 v14, s35, v14
  v_add_u32 v14, 163328, v14
  ds_read_b32 v40, v14
  ds_read_b32 v41, v14 offset:64
  v_lshlrev_b32 v14, 4, v2
  v_add_u32 v14, s34, v14
  s_waitcnt lgkmcnt(6)
  ds_read_b128 v[44:47], v14 offset:0
  ds_read_b128 v[48:51], v14 offset:512
  ds_read_b128 v[52:55], v14 offset:64
  ds_read_b128 v[56:59], v14 offset:576
  ds_read_b128 v[60:63], v14 offset:128
  ds_read_b128 v[64:67], v14 offset:640
  ds_read_b128 v[68:71], v14 offset:192
  ds_read_b128 v[72:75], v14 offset:704
  v_lshlrev_b32 v3, 4, v1
  v_lshl_add_u32 v3, v2, 9, v3
  v_and_b32 v13, 8, v1
  v_lshl_add_u32 v15, v13, 4, v3
  s_lshl_b32 s34, s27, 1
  s_add_u32 s34, s34, s33
  s_lshl_b32 s35, s26, 2
  s_lshl_b32 s36, s32, 1
  s_add_u32 s35, s35, s36
  s_lshl_b32 s36, s34, 17
  s_lshl_b32 s37, s35, 11
  s_add_u32 s36, s36, s37
  s_lshl_b32 s37, s36, 1
  s_mul_i32 s38, s34, 20480
  s_add_u32 s37, s37, s38
  s_add_u32 s37, s37, s10
  s_add_u32 s37, s37, 4194304
  s_add_u32 s38, s37, 4096
  s_add_u32 s36, s36, s10
  s_lshl_b32 s34, s33, 14
  s_lshl_b32 s35, s32, 13
  s_add_u32 s34, s34, s35
  v_add_u32 v9, s34, v15
  v_add_u32 v10, s34, v3
  s_lshl_b32 s35, s3, 12
  s_add_u32 s35, s35, 131072
  v_add_u32 v11, s35, v3
  s_mov_b32 s39, 1048744942
  s_waitcnt lgkmcnt(0)
  v_pk_fma_f32 v[104:105], v[32:33], v[16:17], v[104:105] op_sel:[0,0,0] op_sel_hi:[1,0,1]
  v_pk_fma_f32 v[106:107], v[34:35], v[16:17], v[106:107] op_sel:[0,0,0] op_sel_hi:[1,0,1]
  v_pk_mul_f32 v[104:105], v[104:105], v[16:17] op_sel:[0,1] op_sel_hi:[1,1]
  v_pk_mul_f32 v[106:107], v[106:107], v[16:17] op_sel:[0,1] op_sel_hi:[1,1]
  v_cvt_pk_bf16_f32 v76, v104, v105
  v_cvt_pk_bf16_f32 v77, v106, v107
  v_pk_fma_f32 v[108:109], v[36:37], v[16:17], v[108:109] op_sel:[0,0,0] op_sel_hi:[1,0,1]
  v_pk_fma_f32 v[110:111], v[38:39], v[16:17], v[110:111] op_sel:[0,0,0] op_sel_hi:[1,0,1]
  v_pk_mul_f32 v[108:109], v[108:109], v[16:17] op_sel:[0,1] op_sel_hi:[1,1]
  v_pk_mul_f32 v[110:111], v[110:111], v[16:17] op_sel:[0,1] op_sel_hi:[1,1]
  v_cvt_pk_bf16_f32 v78, v108, v109
  v_cvt_pk_bf16_f32 v79, v110, v111
  buffer_store_dwordx4 v[76:79], v15, s[16:19], s37 offen offset:0 sc1
  ds_write_b128 v9, v[76:79] offset:0
  v_pk_fma_f32 v[128:129], v[32:33], v[18:19], v[128:129] op_sel:[0,0,0] op_sel_hi:[1,0,1]
  v_pk_fma_f32 v[130:131], v[34:35], v[18:19], v[130:131] op_sel:[0,0,0] op_sel_hi:[1,0,1]
  v_pk_mul_f32 v[128:129], v[128:129], v[18:19] op_sel:[0,1] op_sel_hi:[1,1]
  v_pk_mul_f32 v[130:131], v[130:131], v[18:19] op_sel:[0,1] op_sel_hi:[1,1]
  v_cvt_pk_bf16_f32 v80, v128, v129
  v_cvt_pk_bf16_f32 v81, v130, v131
  v_pk_fma_f32 v[132:133], v[36:37], v[18:19], v[132:133] op_sel:[0,0,0] op_sel_hi:[1,0,1]
  v_pk_fma_f32 v[134:135], v[38:39], v[18:19], v[134:135] op_sel:[0,0,0] op_sel_hi:[1,0,1]
  v_pk_mul_f32 v[132:133], v[132:133], v[18:19] op_sel:[0,1] op_sel_hi:[1,1]
  v_pk_mul_f32 v[134:135], v[134:135], v[18:19] op_sel:[0,1] op_sel_hi:[1,1]
  v_cvt_pk_bf16_f32 v82, v132, v133
  v_cvt_pk_bf16_f32 v83, v134, v135
  buffer_store_dwordx4 v[80:83], v15, s[16:19], s37 offen offset:128 sc1
  ds_write_b128 v9, v[80:83] offset:128
  v_pk_fma_f32 v[152:153], v[32:33], v[20:21], v[152:153] op_sel:[0,0,0] op_sel_hi:[1,0,1]
  v_pk_fma_f32 v[154:155], v[34:35], v[20:21], v[154:155] op_sel:[0,0,0] op_sel_hi:[1,0,1]
  v_pk_mul_f32 v[152:153], v[152:153], v[20:21] op_sel:[0,1] op_sel_hi:[1,1]
  v_pk_mul_f32 v[154:155], v[154:155], v[20:21] op_sel:[0,1] op_sel_hi:[1,1]
  v_cvt_pk_bf16_f32 v84, v152, v153
  v_cvt_pk_bf16_f32 v85, v154, v155
  v_pk_fma_f32 v[156:157], v[36:37], v[20:21], v[156:157] op_sel:[0,0,0] op_sel_hi:[1,0,1]
  v_pk_fma_f32 v[158:159], v[38:39], v[20:21], v[158:159] op_sel:[0,0,0] op_sel_hi:[1,0,1]
  v_pk_mul_f32 v[156:157], v[156:157], v[20:21] op_sel:[0,1] op_sel_hi:[1,1]
  v_pk_mul_f32 v[158:159], v[158:159], v[20:21] op_sel:[0,1] op_sel_hi:[1,1]
  v_cvt_pk_bf16_f32 v86, v156, v157
  v_cvt_pk_bf16_f32 v87, v158, v159
  buffer_store_dwordx4 v[84:87], v15, s[16:19], s38 offen offset:0 sc1
  ds_write_b128 v9, v[84:87] offset:4096
  v_pk_fma_f32 v[176:177], v[32:33], v[22:23], v[176:177] op_sel:[0,0,0] op_sel_hi:[1,0,1]
  v_pk_fma_f32 v[178:179], v[34:35], v[22:23], v[178:179] op_sel:[0,0,0] op_sel_hi:[1,0,1]
  v_pk_mul_f32 v[176:177], v[176:177], v[22:23] op_sel:[0,1] op_sel_hi:[1,1]
  v_pk_mul_f32 v[178:179], v[178:179], v[22:23] op_sel:[0,1] op_sel_hi:[1,1]
  v_cvt_pk_bf16_f32 v88, v176, v177
  v_cvt_pk_bf16_f32 v89, v178, v179
  v_pk_fma_f32 v[180:181], v[36:37], v[22:23], v[180:181] op_sel:[0,0,0] op_sel_hi:[1,0,1]
  v_pk_fma_f32 v[182:183], v[38:39], v[22:23], v[182:183] op_sel:[0,0,0] op_sel_hi:[1,0,1]
  v_pk_mul_f32 v[180:181], v[180:181], v[22:23] op_sel:[0,1] op_sel_hi:[1,1]
  v_pk_mul_f32 v[182:183], v[182:183], v[22:23] op_sel:[0,1] op_sel_hi:[1,1]
  v_cvt_pk_bf16_f32 v90, v180, v181
  v_cvt_pk_bf16_f32 v91, v182, v183
  buffer_store_dwordx4 v[88:91], v15, s[16:19], s38 offen offset:128 sc1
  ds_write_b128 v9, v[88:91] offset:4224
  v_pk_fma_f32 v[112:113], v[44:45], v[40:41], v[112:113] op_sel:[0,0,0] op_sel_hi:[1,0,1]
  v_pk_fma_f32 v[114:115], v[46:47], v[40:41], v[114:115] op_sel:[0,0,0] op_sel_hi:[1,0,1]
  v_pk_mul_f32 v[112:113], v[112:113], v[48:49]
  v_pk_mul_f32 v[114:115], v[114:115], v[50:51]
  v_cvt_pk_bf16_f32 v76, v112, v113
  v_cvt_pk_bf16_f32 v77, v114, v115
  v_pk_fma_f32 v[136:137], v[52:53], v[40:41], v[136:137] op_sel:[0,0,0] op_sel_hi:[1,0,1]
  v_pk_fma_f32 v[138:139], v[54:55], v[40:41], v[138:139] op_sel:[0,0,0] op_sel_hi:[1,0,1]
  v_pk_mul_f32 v[136:137], v[136:137], v[56:57]
  v_pk_mul_f32 v[138:139], v[138:139], v[58:59]
  v_cvt_pk_bf16_f32 v78, v136, v137
  v_cvt_pk_bf16_f32 v79, v138, v139
  buffer_store_dwordx4 v[76:79], v3, s[16:19], s37 offen offset:2048 sc1
  ds_write_b128 v10, v[76:79] offset:2048
  v_pk_fma_f32 v[116:117], v[44:45], v[40:41], v[116:117] op_sel:[0,1,0] op_sel_hi:[1,1,1]
  v_pk_fma_f32 v[118:119], v[46:47], v[40:41], v[118:119] op_sel:[0,1,0] op_sel_hi:[1,1,1]
  v_pk_mul_f32 v[116:117], v[116:117], v[48:49]
  v_pk_mul_f32 v[118:119], v[118:119], v[50:51]
  v_cvt_pk_bf16_f32 v80, v116, v117
  v_cvt_pk_bf16_f32 v81, v118, v119
  v_pk_fma_f32 v[140:141], v[52:53], v[40:41], v[140:141] op_sel:[0,1,0] op_sel_hi:[1,1,1]
  v_pk_fma_f32 v[142:143], v[54:55], v[40:41], v[142:143] op_sel:[0,1,0] op_sel_hi:[1,1,1]
  v_pk_mul_f32 v[140:141], v[140:141], v[56:57]
  v_pk_mul_f32 v[142:143], v[142:143], v[58:59]
  v_cvt_pk_bf16_f32 v82, v140, v141
  v_cvt_pk_bf16_f32 v83, v142, v143
  buffer_store_dwordx4 v[80:83], v3, s[16:19], s37 offen offset:2304 sc1
  ds_write_b128 v10, v[80:83] offset:2304
  v_pk_fma_f32 v[160:161], v[60:61], v[40:41], v[160:161] op_sel:[0,0,0] op_sel_hi:[1,0,1]
  v_pk_fma_f32 v[162:163], v[62:63], v[40:41], v[162:163] op_sel:[0,0,0] op_sel_hi:[1,0,1]
  v_pk_mul_f32 v[160:161], v[160:161], v[64:65]
  v_pk_mul_f32 v[162:163], v[162:163], v[66:67]
  v_cvt_pk_bf16_f32 v84, v160, v161
  v_cvt_pk_bf16_f32 v85, v162, v163
  v_pk_fma_f32 v[184:185], v[68:69], v[40:41], v[184:185] op_sel:[0,0,0] op_sel_hi:[1,0,1]
  v_pk_fma_f32 v[186:187], v[70:71], v[40:41], v[186:187] op_sel:[0,0,0] op_sel_hi:[1,0,1]
  v_pk_mul_f32 v[184:185], v[184:185], v[72:73]
  v_pk_mul_f32 v[186:187], v[186:187], v[74:75]
  v_cvt_pk_bf16_f32 v86, v184, v185
  v_cvt_pk_bf16_f32 v87, v186, v187
  buffer_store_dwordx4 v[84:87], v3, s[16:19], s38 offen offset:2048 sc1
  ds_write_b128 v10, v[84:87] offset:6144
  v_pk_fma_f32 v[164:165], v[60:61], v[40:41], v[164:165] op_sel:[0,1,0] op_sel_hi:[1,1,1]
  v_pk_fma_f32 v[166:167], v[62:63], v[40:41], v[166:167] op_sel:[0,1,0] op_sel_hi:[1,1,1]
  v_pk_mul_f32 v[164:165], v[164:165], v[64:65]
  v_pk_mul_f32 v[166:167], v[166:167], v[66:67]
  v_cvt_pk_bf16_f32 v88, v164, v165
  v_cvt_pk_bf16_f32 v89, v166, v167
  v_pk_fma_f32 v[188:189], v[68:69], v[40:41], v[188:189] op_sel:[0,1,0] op_sel_hi:[1,1,1]
  v_pk_fma_f32 v[190:191], v[70:71], v[40:41], v[190:191] op_sel:[0,1,0] op_sel_hi:[1,1,1]
  v_pk_mul_f32 v[188:189], v[188:189], v[72:73]
  v_pk_mul_f32 v[190:191], v[190:191], v[74:75]
  v_cvt_pk_bf16_f32 v90, v188, v189
  v_cvt_pk_bf16_f32 v91, v190, v191
  buffer_store_dwordx4 v[88:91], v3, s[16:19], s38 offen offset:2304 sc1
  ds_write_b128 v10, v[88:91] offset:6400
  v_mul_f32 v17, s39, v17
  v_mul_f32 v19, s39, v19
  v_mul_f32 v21, s39, v21
  v_mul_f32 v23, s39, v23
  v_pk_fma_f32 v[96:97], v[24:25], v[16:17], v[96:97] op_sel:[0,0,0] op_sel_hi:[1,0,1]
  v_pk_fma_f32 v[98:99], v[26:27], v[16:17], v[98:99] op_sel:[0,0,0] op_sel_hi:[1,0,1]
  v_pk_mul_f32 v[96:97], v[96:97], v[16:17] op_sel:[0,1] op_sel_hi:[1,1]
  v_pk_mul_f32 v[98:99], v[98:99], v[16:17] op_sel:[0,1] op_sel_hi:[1,1]
  v_cvt_pk_bf16_f32 v76, v96, v97
  v_cvt_pk_bf16_f32 v77, v98, v99
  v_pk_fma_f32 v[100:101], v[28:29], v[16:17], v[100:101] op_sel:[0,0,0] op_sel_hi:[1,0,1]
  v_pk_fma_f32 v[102:103], v[30:31], v[16:17], v[102:103] op_sel:[0,0,0] op_sel_hi:[1,0,1]
  v_pk_mul_f32 v[100:101], v[100:101], v[16:17] op_sel:[0,1] op_sel_hi:[1,1]
  v_pk_mul_f32 v[102:103], v[102:103], v[16:17] op_sel:[0,1] op_sel_hi:[1,1]
  v_cvt_pk_bf16_f32 v78, v100, v101
  v_cvt_pk_bf16_f32 v79, v102, v103
  ds_write_b128 v11, v[76:79] offset:0
  v_pk_fma_f32 v[120:121], v[24:25], v[18:19], v[120:121] op_sel:[0,0,0] op_sel_hi:[1,0,1]
  v_pk_fma_f32 v[122:123], v[26:27], v[18:19], v[122:123] op_sel:[0,0,0] op_sel_hi:[1,0,1]
  v_pk_mul_f32 v[120:121], v[120:121], v[18:19] op_sel:[0,1] op_sel_hi:[1,1]
  v_pk_mul_f32 v[122:123], v[122:123], v[18:19] op_sel:[0,1] op_sel_hi:[1,1]
  v_cvt_pk_bf16_f32 v80, v120, v121
  v_cvt_pk_bf16_f32 v81, v122, v123
  v_pk_fma_f32 v[124:125], v[28:29], v[18:19], v[124:125] op_sel:[0,0,0] op_sel_hi:[1,0,1]
  v_pk_fma_f32 v[126:127], v[30:31], v[18:19], v[126:127] op_sel:[0,0,0] op_sel_hi:[1,0,1]
  v_pk_mul_f32 v[124:125], v[124:125], v[18:19] op_sel:[0,1] op_sel_hi:[1,1]
  v_pk_mul_f32 v[126:127], v[126:127], v[18:19] op_sel:[0,1] op_sel_hi:[1,1]
  v_cvt_pk_bf16_f32 v82, v124, v125
  v_cvt_pk_bf16_f32 v83, v126, v127
  ds_write_b128 v11, v[80:83] offset:256
  v_pk_fma_f32 v[144:145], v[24:25], v[20:21], v[144:145] op_sel:[0,0,0] op_sel_hi:[1,0,1]
  v_pk_fma_f32 v[146:147], v[26:27], v[20:21], v[146:147] op_sel:[0,0,0] op_sel_hi:[1,0,1]
  v_pk_mul_f32 v[144:145], v[144:145], v[20:21] op_sel:[0,1] op_sel_hi:[1,1]
  v_pk_mul_f32 v[146:147], v[146:147], v[20:21] op_sel:[0,1] op_sel_hi:[1,1]
  v_cvt_pk_bf16_f32 v84, v144, v145
  v_cvt_pk_bf16_f32 v85, v146, v147
  v_pk_fma_f32 v[148:149], v[28:29], v[20:21], v[148:149] op_sel:[0,0,0] op_sel_hi:[1,0,1]
  v_pk_fma_f32 v[150:151], v[30:31], v[20:21], v[150:151] op_sel:[0,0,0] op_sel_hi:[1,0,1]
  v_pk_mul_f32 v[148:149], v[148:149], v[20:21] op_sel:[0,1] op_sel_hi:[1,1]
  v_pk_mul_f32 v[150:151], v[150:151], v[20:21] op_sel:[0,1] op_sel_hi:[1,1]
  v_cvt_pk_bf16_f32 v86, v148, v149
  v_cvt_pk_bf16_f32 v87, v150, v151
  ds_write_b128 v11, v[84:87] offset:2048
  v_pk_fma_f32 v[168:169], v[24:25], v[22:23], v[168:169] op_sel:[0,0,0] op_sel_hi:[1,0,1]
  v_pk_fma_f32 v[170:171], v[26:27], v[22:23], v[170:171] op_sel:[0,0,0] op_sel_hi:[1,0,1]
  v_pk_mul_f32 v[168:169], v[168:169], v[22:23] op_sel:[0,1] op_sel_hi:[1,1]
  v_pk_mul_f32 v[170:171], v[170:171], v[22:23] op_sel:[0,1] op_sel_hi:[1,1]
  v_cvt_pk_bf16_f32 v88, v168, v169
  v_cvt_pk_bf16_f32 v89, v170, v171
  v_pk_fma_f32 v[172:173], v[28:29], v[22:23], v[172:173] op_sel:[0,0,0] op_sel_hi:[1,0,1]
  v_pk_fma_f32 v[174:175], v[30:31], v[22:23], v[174:175] op_sel:[0,0,0] op_sel_hi:[1,0,1]
  v_pk_mul_f32 v[172:173], v[172:173], v[22:23] op_sel:[0,1] op_sel_hi:[1,1]
  v_pk_mul_f32 v[174:175], v[174:175], v[22:23] op_sel:[0,1] op_sel_hi:[1,1]
  v_cvt_pk_bf16_f32 v90, v172, v173
  v_cvt_pk_bf16_f32 v91, v174, v175
  ds_write_b128 v11, v[88:91] offset:2304
  v_lshlrev_b32 v2, 4, v0
  s_lshl_b32 s28, s27, 1
  s_add_u32 s28, s28, s33
  s_lshl_b32 s13, s3, 12
  s_add_u32 s13, s13, 131072
  v_add_u32 v3, s13, v2
  s_waitcnt lgkmcnt(0)
  ds_read_b128 v[8:11], v3 offset:0
  ds_read_b128 v[12:15], v3 offset:1024
  ds_read_b128 v[16:19], v3 offset:2048
  ds_read_b128 v[20:23], v3 offset:3072
  v_lshrrev_b32 v3, 2, v0
  v_mov_b32 v6, 0x3f803f80
  v_and_b32 v1, 1, v3
  v_cmp_eq_u32 vcc, 0, v1
  s_nop 1
  v_cndmask_b32 v64, 0, v6, vcc
  v_mov_b32 v65, v64
  v_xor_b32 v66, v6, v64
  v_mov_b32 v67, v66
  v_and_b32 v1, 1, v0
  v_cmp_eq_u32 vcc, 0, v1
  v_mov_b32 v6, 0x44444444
  v_mov_b32 v7, 0xeeeeeeee
  v_cndmask_b32 v76, v7, v6, vcc
  v_mov_b32 v68, 0
  v_mov_b32 v69, 0
  v_mov_b32 v70, 0
  v_mov_b32 v71, 0
  v_mov_b32 v72, 0
  v_mov_b32 v73, 0
  v_mov_b32 v74, 0
  v_mov_b32 v75, 0
  v_mov_b32 v80, 0
  v_mov_b32 v81, 0
  v_mov_b32 v82, 0
  v_mov_b32 v83, 0
  v_mov_b32 v84, 0
  v_mov_b32 v85, 0
  v_mov_b32 v86, 0
  v_mov_b32 v87, 0
  v_mov_b32 v88, 0
  v_mov_b32 v89, 0
  v_mov_b32 v90, 0
  v_mov_b32 v91, 0
  v_mov_b32 v92, 0
  v_mov_b32 v93, 0
  v_mov_b32 v94, 0
  v_mov_b32 v95, 0
  v_mov_b32 v96, 0
  v_mov_b32 v97, 0
  v_mov_b32 v98, 0
  v_mov_b32 v99, 0
  v_mov_b32 v100, 0
  v_mov_b32 v101, 0
  v_mov_b32 v102, 0
  v_mov_b32 v103, 0
  v_mov_b32 v104, 0
  v_mov_b32 v105, 0
  v_mov_b32 v106, 0
  v_mov_b32 v107, 0
  v_mov_b32 v108, 0
  v_mov_b32 v109, 0
  v_mov_b32 v110, 0
  v_mov_b32 v111, 0
  v_mov_b32 v56, 0
  v_mov_b32 v57, 0
  v_mov_b32 v58, 0
  v_mov_b32 v59, 0
  v_mov_b32 v60, 0
  v_mov_b32 v61, 0
  v_mov_b32 v62, 0
  v_mov_b32 v63, 0
  v_mov_b32 v52, 0
  v_mov_b32 v53, 0
  v_mov_b32 v54, 0
  v_mov_b32 v55, 0
  s_lshl_b32 s14, s33, 14
  v_add_u32 v5, s14, v2
  v_mov_b32 v4, v5
  s_mov_b32 s20, 0
  s_mov_b32 s21, 0
  s_waitcnt vmcnt(0) lgkmcnt(0)
  s_barrier
  ds_read_b128 v[24:27], v4 offset:0
  ds_read_b128 v[28:31], v4 offset:1024
  ds_read_b128 v[40:43], v4 offset:2048
  ds_read_b128 v[44:47], v4 offset:3072
  s_waitcnt lgkmcnt(2)
  v_mfma_f32_32x32x16_bf16 v[144:159], v[24:27], v[8:11], 0
  v_mfma_f32_32x32x16_bf16 v[144:159], v[28:31], v[12:15], v[144:159]
  v_mfma_f32_32x32x16_bf16 v[160:175], v[24:27], v[16:19], 0
  v_mfma_f32_32x32x16_bf16 v[160:175], v[28:31], v[20:23], v[160:175]
  s_nop 9
  v_max3_f32 v6, v144, v145, v146
  v_max3_f32 v6, v6, v147, v148
  v_max3_f32 v6, v6, v149, v150
  v_max3_f32 v6, v6, v151, v152
  v_max3_f32 v6, v6, v153, v154
  v_max3_f32 v6, v6, v155, v156
  v_max3_f32 v6, v6, v157, v158
  v_max_f32 v6, v6, v159
  v_max3_f32 v7, v160, v161, v162
  v_max3_f32 v7, v7, v163, v164
  v_max3_f32 v7, v7, v165, v166
  v_max3_f32 v7, v7, v167, v168
  v_max3_f32 v7, v7, v169, v170
  v_max3_f32 v7, v7, v171, v172
  v_max3_f32 v7, v7, v173, v174
  v_max_f32 v7, v7, v175
  v_mov_b32 v1, v6
  v_mov_b32 v3, v7
  s_nop 0
  v_permlane32_swap_b32 v6, v1
  v_permlane32_swap_b32 v7, v3
  v_max_f32 v6, v6, v1
  v_max_f32 v7, v7, v3
  v_sub_f32 v112, 0, v6
  v_sub_f32 v113, 0, v6
  v_sub_f32 v114, 0, v6
  v_sub_f32 v115, 0, v6
  v_sub_f32 v116, 0, v6
  v_sub_f32 v117, 0, v6
  v_sub_f32 v118, 0, v6
  v_sub_f32 v119, 0, v6
  v_sub_f32 v120, 0, v6
  v_sub_f32 v121, 0, v6
  v_sub_f32 v122, 0, v6
  v_sub_f32 v123, 0, v6
  v_sub_f32 v124, 0, v6
  v_sub_f32 v125, 0, v6
  v_sub_f32 v126, 0, v6
  v_sub_f32 v127, 0, v6
  s_nop 1
  v_mfma_f32_32x32x16_bf16 v[144:159], v[24:27], v[8:11], v[112:127]
  v_mfma_f32_32x32x16_bf16 v[144:159], v[28:31], v[12:15], v[144:159]
  v_sub_f32 v128, 0, v7
  v_sub_f32 v129, 0, v7
  v_sub_f32 v130, 0, v7
  v_sub_f32 v131, 0, v7
  v_sub_f32 v132, 0, v7
  v_sub_f32 v133, 0, v7
  v_sub_f32 v134, 0, v7
  v_sub_f32 v135, 0, v7
  v_sub_f32 v136, 0, v7
  v_sub_f32 v137, 0, v7
  v_sub_f32 v138, 0, v7
  v_sub_f32 v139, 0, v7
  v_sub_f32 v140, 0, v7
  v_sub_f32 v141, 0, v7
  v_sub_f32 v142, 0, v7
  v_sub_f32 v143, 0, v7
  s_waitcnt lgkmcnt(0)
  s_nop 0
.p2align 6
at_loop:
  v_mfma_f32_32x32x16_bf16 v[160:175], v[24:27], v[16:19], v[128:143]
  ds_read_b128 v[32:35], v4 offset:4096
  v_exp_f32 v144, v144
  v_exp_f32 v145, v145
  v_exp_f32 v146, v146
  v_smfmac_f32_16x16x64_bf16 v[72:75], v[64:67], v[56:63], v76
  ds_read_b128 v[36:39], v4 offset:5120
  v_exp_f32 v147, v147
  v_exp_f32 v148, v148
  v_exp_f32 v149, v149
  v_mfma_f32_32x32x16_bf16 v[96:111], v[52:55], v[60:63], v[96:111]
  ds_read_b128 v[52:55], v4 offset:7168
  v_exp_f32 v150, v150
  v_exp_f32 v151, v151
  v_cvt_pk_bf16_f32 v56, v144, v145
  v_cvt_pk_bf16_f32 v57, v146, v147
  v_mfma_f32_32x32x16_bf16 v[160:175], v[28:31], v[20:23], v[160:175]
  ds_read_b128 v[48:51], v4 offset:6144
  v_cvt_pk_bf16_f32 v58, v148, v149
  v_cvt_pk_bf16_f32 v59, v150, v151
  v_exp_f32 v152, v152
  v_exp_f32 v153, v153
  v_mfma_f32_32x32x16_bf16 v[80:95], v[40:43], v[56:59], v[80:95]
  s_waitcnt lgkmcnt(2)
  v_exp_f32 v154, v154
  v_exp_f32 v155, v155
  v_exp_f32 v156, v156
  v_exp_f32 v157, v157
  v_exp_f32 v158, v158
  v_exp_f32 v159, v159
  v_cvt_pk_bf16_f32 v60, v152, v153
  v_cvt_pk_bf16_f32 v61, v154, v155
  v_cvt_pk_bf16_f32 v62, v156, v157
  v_cvt_pk_bf16_f32 v63, v158, v159
  v_mfma_f32_32x32x16_bf16 v[144:159], v[32:35], v[8:11], v[112:127]
  v_exp_f32 v160, v160
  v_exp_f32 v161, v161
  v_exp_f32 v162, v162
  v_smfmac_f32_16x16x64_bf16 v[68:71], v[64:67], v[56:63], v76
  s_waitcnt lgkmcnt(0)
  v_exp_f32 v163, v163
  v_exp_f32 v164, v164
  v_exp_f32 v165, v165
  v_mfma_f32_32x32x16_bf16 v[80:95], v[44:47], v[60:63], v[80:95]
  v_exp_f32 v166, v166
  v_exp_f32 v167, v167
  v_cvt_pk_bf16_f32 v56, v160, v161
  v_cvt_pk_bf16_f32 v57, v162, v163
  v_mfma_f32_32x32x16_bf16 v[144:159], v[36:39], v[12:15], v[144:159]
  v_cvt_pk_bf16_f32 v58, v164, v165
  v_cvt_pk_bf16_f32 v59, v166, v167
  v_exp_f32 v168, v168
  v_exp_f32 v169, v169
  v_mfma_f32_32x32x16_bf16 v[96:111], v[40:43], v[56:59], v[96:111]
  v_exp_f32 v170, v170
  v_exp_f32 v171, v171
  v_exp_f32 v172, v172
  v_exp_f32 v173, v173
  v_exp_f32 v174, v174
  v_exp_f32 v175, v175
  v_cvt_pk_bf16_f32 v60, v168, v169
  v_cvt_pk_bf16_f32 v61, v170, v171
  v_cvt_pk_bf16_f32 v62, v172, v173
  v_cvt_pk_bf16_f32 v63, v174, v175
  v_mfma_f32_32x32x16_bf16 v[160:175], v[32:35], v[16:19], v[128:143]
  ds_read_b128 v[24:27], v4 offset:8192
  v_exp_f32 v144, v144
  v_exp_f32 v145, v145
  v_exp_f32 v146, v146
  v_smfmac_f32_16x16x64_bf16 v[72:75], v[64:67], v[56:63], v76
  ds_read_b128 v[28:31], v4 offset:9216
  v_exp_f32 v147, v147
  v_exp_f32 v148, v148
  v_exp_f32 v149, v149
  v_mfma_f32_32x32x16_bf16 v[96:111], v[44:47], v[60:63], v[96:111]
  ds_read_b128 v[44:47], v4 offset:11264
  v_exp_f32 v150, v150
  v_exp_f32 v151, v151
  v_cvt_pk_bf16_f32 v56, v144, v145
  v_cvt_pk_bf16_f32 v57, v146, v147
  v_mfma_f32_32x32x16_bf16 v[160:175], v[36:39], v[20:23], v[160:175]
  ds_read_b128 v[40:43], v4 offset:10240
  v_cvt_pk_bf16_f32 v58, v148, v149
  v_cvt_pk_bf16_f32 v59, v150, v151
  v_exp_f32 v152, v152
  v_exp_f32 v153, v153
  v_mfma_f32_32x32x16_bf16 v[80:95], v[48:51], v[56:59], v[80:95]
  s_waitcnt lgkmcnt(2)
  v_exp_f32 v154, v154
  v_exp_f32 v155, v155
  v_exp_f32 v156, v156
  v_exp_f32 v157, v157
  v_exp_f32 v158, v158
  v_exp_f32 v159, v159
  v_cvt_pk_bf16_f32 v60, v152, v153
  v_cvt_pk_bf16_f32 v61, v154, v155
  v_cvt_pk_bf16_f32 v62, v156, v157
  v_cvt_pk_bf16_f32 v63, v158, v159
  v_mfma_f32_32x32x16_bf16 v[144:159], v[24:27], v[8:11], v[112:127]
  s_add_u32 s21, s21, 32768
  v_exp_f32 v160, v160
  v_exp_f32 v161, v161
  v_exp_f32 v162, v162
  v_smfmac_f32_16x16x64_bf16 v[68:71], v[64:67], v[56:63], v76
  s_waitcnt lgkmcnt(0)
  v_exp_f32 v163, v163
  v_exp_f32 v164, v164
  v_exp_f32 v165, v165
  v_mfma_f32_32x32x16_bf16 v[80:95], v[52:55], v[60:63], v[80:95]
  s_and_b32 s21, s21, 131071
  v_exp_f32 v166, v166
  v_exp_f32 v167, v167
  v_cvt_pk_bf16_f32 v56, v160, v161
  v_cvt_pk_bf16_f32 v57, v162, v163
  v_mfma_f32_32x32x16_bf16 v[144:159], v[28:31], v[12:15], v[144:159]
  s_add_u32 s20, s20, 1
  v_cvt_pk_bf16_f32 v58, v164, v165
  v_cvt_pk_bf16_f32 v59, v166, v167
  v_exp_f32 v168, v168
  v_exp_f32 v169, v169
  v_mfma_f32_32x32x16_bf16 v[96:111], v[48:51], v[56:59], v[96:111]
  v_exp_f32 v170, v170
  v_exp_f32 v171, v171
  v_exp_f32 v172, v172
  v_exp_f32 v173, v173
  v_exp_f32 v174, v174
  v_exp_f32 v175, v175
  v_cvt_pk_bf16_f32 v60, v168, v169
  v_cvt_pk_bf16_f32 v61, v170, v171
  v_cvt_pk_bf16_f32 v62, v172, v173
  v_cvt_pk_bf16_f32 v63, v174, v175
  v_mfma_f32_32x32x16_bf16 v[160:175], v[24:27], v[16:19], v[128:143]
  ds_read_b128 v[32:35], v4 offset:12288
  v_exp_f32 v144, v144
  v_exp_f32 v145, v145
  v_exp_f32 v146, v146
  v_smfmac_f32_16x16x64_bf16 v[72:75], v[64:67], v[56:63], v76
  ds_read_b128 v[36:39], v4 offset:13312
  v_exp_f32 v147, v147
  v_exp_f32 v148, v148
  v_exp_f32 v149, v149
  v_mfma_f32_32x32x16_bf16 v[96:111], v[52:55], v[60:63], v[96:111]
  ds_read_b128 v[52:55], v4 offset:15360
  v_exp_f32 v150, v150
  v_exp_f32 v151, v151
  v_cvt_pk_bf16_f32 v56, v144, v145
  v_cvt_pk_bf16_f32 v57, v146, v147
  v_mfma_f32_32x32x16_bf16 v[160:175], v[28:31], v[20:23], v[160:175]
  ds_read_b128 v[48:51], v4 offset:14336
  v_cvt_pk_bf16_f32 v58, v148, v149
  v_cvt_pk_bf16_f32 v59, v150, v151
  v_exp_f32 v152, v152
  v_exp_f32 v153, v153
  v_mfma_f32_32x32x16_bf16 v[80:95], v[40:43], v[56:59], v[80:95]
  s_waitcnt lgkmcnt(2)
  v_exp_f32 v154, v154
  v_exp_f32 v155, v155
  v_exp_f32 v156, v156
  v_exp_f32 v157, v157
  v_exp_f32 v158, v158
  v_exp_f32 v159, v159
  v_cvt_pk_bf16_f32 v60, v152, v153
  v_cvt_pk_bf16_f32 v61, v154, v155
  v_cvt_pk_bf16_f32 v62, v156, v157
  v_cvt_pk_bf16_f32 v63, v158, v159
  v_mfma_f32_32x32x16_bf16 v[144:159], v[32:35], v[8:11], v[112:127]
  v_exp_f32 v160, v160
  v_exp_f32 v161, v161
  v_exp_f32 v162, v162
  v_smfmac_f32_16x16x64_bf16 v[68:71], v[64:67], v[56:63], v76
  s_waitcnt lgkmcnt(0)
  v_exp_f32 v163, v163
  v_exp_f32 v164, v164
  v_exp_f32 v165, v165
  v_mfma_f32_32x32x16_bf16 v[80:95], v[44:47], v[60:63], v[80:95]
  v_exp_f32 v166, v166
  v_exp_f32 v167, v167
  v_cvt_pk_bf16_f32 v56, v160, v161
  v_cvt_pk_bf16_f32 v57, v162, v163
  v_mfma_f32_32x32x16_bf16 v[144:159], v[36:39], v[12:15], v[144:159]
  s_barrier
  v_add_u32 v4, s21, v5
  v_cvt_pk_bf16_f32 v58, v164, v165
  v_cvt_pk_bf16_f32 v59, v166, v167
  v_exp_f32 v168, v168
  v_exp_f32 v169, v169
  v_mfma_f32_32x32x16_bf16 v[96:111], v[40:43], v[56:59], v[96:111]
  v_exp_f32 v170, v170
  v_exp_f32 v171, v171
  v_exp_f32 v172, v172
  v_exp_f32 v173, v173
  v_exp_f32 v174, v174
  v_exp_f32 v175, v175
  v_cvt_pk_bf16_f32 v60, v168, v169
  v_cvt_pk_bf16_f32 v61, v170, v171
  v_cvt_pk_bf16_f32 v62, v172, v173
  v_cvt_pk_bf16_f32 v63, v174, v175
  v_mfma_f32_32x32x16_bf16 v[160:175], v[32:35], v[16:19], v[128:143]
  ds_read_b128 v[24:27], v4 offset:0
  v_exp_f32 v144, v144
  v_exp_f32 v145, v145
  v_exp_f32 v146, v146
  v_smfmac_f32_16x16x64_bf16 v[72:75], v[64:67], v[56:63], v76
  ds_read_b128 v[28:31], v4 offset:1024
  v_exp_f32 v147, v147
  v_exp_f32 v148, v148
  v_exp_f32 v149, v149
  v_mfma_f32_32x32x16_bf16 v[96:111], v[44:47], v[60:63], v[96:111]
  ds_read_b128 v[44:47], v4 offset:3072
  v_exp_f32 v150, v150
  v_exp_f32 v151, v151
  v_cvt_pk_bf16_f32 v56, v144, v145
  v_cvt_pk_bf16_f32 v57, v146, v147
  v_mfma_f32_32x32x16_bf16 v[160:175], v[36:39], v[20:23], v[160:175]
  ds_read_b128 v[40:43], v4 offset:2048
  v_cvt_pk_bf16_f32 v58, v148, v149
  v_cvt_pk_bf16_f32 v59, v150, v151
  v_exp_f32 v152, v152
  v_exp_f32 v153, v153
  v_mfma_f32_32x32x16_bf16 v[80:95], v[48:51], v[56:59], v[80:95]
  s_waitcnt lgkmcnt(2)
  v_exp_f32 v154, v154
  v_exp_f32 v155, v155
  v_exp_f32 v156, v156
  v_exp_f32 v157, v157
  v_exp_f32 v158, v158
  v_exp_f32 v159, v159
  v_cvt_pk_bf16_f32 v60, v152, v153
  v_cvt_pk_bf16_f32 v61, v154, v155
  v_cvt_pk_bf16_f32 v62, v156, v157
  v_cvt_pk_bf16_f32 v63, v158, v159
  v_mfma_f32_32x32x16_bf16 v[144:159], v[24:27], v[8:11], v[112:127]
  s_cmp_lg_u32 s20, 16
  v_exp_f32 v160, v160
  v_exp_f32 v161, v161
  v_exp_f32 v162, v162
  v_smfmac_f32_16x16x64_bf16 v[68:71], v[64:67], v[56:63], v76
  s_waitcnt lgkmcnt(0)
  v_exp_f32 v163, v163
  v_exp_f32 v164, v164
  v_exp_f32 v165, v165
  v_mfma_f32_32x32x16_bf16 v[80:95], v[52:55], v[60:63], v[80:95]
  v_exp_f32 v166, v166
  v_exp_f32 v167, v167
  v_cvt_pk_bf16_f32 v56, v160, v161
  v_cvt_pk_bf16_f32 v57, v162, v163
  v_mfma_f32_32x32x16_bf16 v[144:159], v[28:31], v[12:15], v[144:159]
  v_cvt_pk_bf16_f32 v58, v164, v165
  v_cvt_pk_bf16_f32 v59, v166, v167
  v_exp_f32 v168, v168
  v_exp_f32 v169, v169
  v_mfma_f32_32x32x16_bf16 v[96:111], v[48:51], v[56:59], v[96:111]
  v_exp_f32 v170, v170
  v_exp_f32 v171, v171
  v_exp_f32 v172, v172
  v_exp_f32 v173, v173
  v_exp_f32 v174, v174
  v_exp_f32 v175, v175
  v_cvt_pk_bf16_f32 v60, v168, v169
  v_cvt_pk_bf16_f32 v61, v170, v171
  v_cvt_pk_bf16_f32 v62, v172, v173
  v_cvt_pk_bf16_f32 v63, v174, v175
  s_cbranch_scc1 at_loop
  s_nop 0
  v_smfmac_f32_16x16x64_bf16 v[72:75], v[64:67], v[56:63], v76
  v_mfma_f32_32x32x16_bf16 v[96:111], v[52:55], v[60:63], v[96:111]
  v_add_f32 v68, v68, v69
  s_nop 5
  v_add_f32 v72, v72, v73
  v_add_f32 v1, v68, v72
  v_pk_mul_f32 v[6:7], v[80:81], 0
  v_pk_fma_f32 v[6:7], v[82:83], 0, v[6:7]
  v_pk_fma_f32 v[6:7], v[84:85], 0, v[6:7]
  v_pk_fma_f32 v[6:7], v[86:87], 0, v[6:7]
  v_pk_fma_f32 v[6:7], v[88:89], 0, v[6:7]
  v_pk_fma_f32 v[6:7], v[90:91], 0, v[6:7]
  v_pk_fma_f32 v[6:7], v[92:93], 0, v[6:7]
  v_pk_fma_f32 v[6:7], v[94:95], 0, v[6:7]
  v_pk_fma_f32 v[6:7], v[96:97], 0, v[6:7]
  v_pk_fma_f32 v[6:7], v[98:99], 0, v[6:7]
  v_pk_fma_f32 v[6:7], v[100:101], 0, v[6:7]
  v_pk_fma_f32 v[6:7], v[102:103], 0, v[6:7]
  v_pk_fma_f32 v[6:7], v[104:105], 0, v[6:7]
  v_pk_fma_f32 v[6:7], v[106:107], 0, v[6:7]
  v_pk_fma_f32 v[6:7], v[108:109], 0, v[6:7]
  v_pk_fma_f32 v[6:7], v[110:111], 0, v[6:7]
  v_add_f32 v1, v1, v6
  v_add_f32 v1, v1, v7
  s_mov_b32 s23, 1904214016
  v_cmp_ngt_f32 vcc, s23, v1
  s_cbranch_vccnz at_slow
at_fin:
  v_rcp_f32 v6, v68
  v_rcp_f32 v7, v72
  v_and_b32 v3, 15, v0
  v_lshlrev_b32 v3, 4, v3
  v_lshrrev_b32 v1, 5, v0
  v_lshl_add_u32 v3, v1, 8, v3
  v_bfe_u32 v1, v0, 4, 1
  v_lshl_add_u32 v3, v1, 10, v3
  s_lshl_b32 s24, s26, 5
  s_add_u32 s24, s24, s28
  s_lshl_b32 s24, s24, 13
  s_lshl_b32 s25, s32, 12
  s_add_u32 s24, s24, s25
  s_add_u32 s24, s24, s6
  s_add_u32 s24, s24, 14680064
  v_pk_mul_f32 v[80:81], v[80:81], v[6:7] op_sel:[0,0] op_sel_hi:[1,0]
  v_pk_mul_f32 v[82:83], v[82:83], v[6:7] op_sel:[0,0] op_sel_hi:[1,0]
  v_pk_mul_f32 v[84:85], v[84:85], v[6:7] op_sel:[0,0] op_sel_hi:[1,0]
  v_pk_mul_f32 v[86:87], v[86:87], v[6:7] op_sel:[0,0] op_sel_hi:[1,0]
  v_pk_mul_f32 v[88:89], v[88:89], v[6:7] op_sel:[0,0] op_sel_hi:[1,0]
  v_pk_mul_f32 v[90:91], v[90:91], v[6:7] op_sel:[0,0] op_sel_hi:[1,0]
  v_pk_mul_f32 v[92:93], v[92:93], v[6:7] op_sel:[0,0] op_sel_hi:[1,0]
  v_pk_mul_f32 v[94:95], v[94:95], v[6:7] op_sel:[0,0] op_sel_hi:[1,0]
  v_cvt_pk_bf16_f32 v144, v80, v81
  v_cvt_pk_bf16_f32 v145, v82, v83
  v_cvt_pk_bf16_f32 v146, v88, v89
  v_cvt_pk_bf16_f32 v147, v90, v91
  buffer_store_dwordx4 v[144:147], v3, s[16:19], s24 offen offset:0 sc1
  v_cvt_pk_bf16_f32 v148, v84, v85
  v_cvt_pk_bf16_f32 v149, v86, v87
  v_cvt_pk_bf16_f32 v150, v92, v93
  v_cvt_pk_bf16_f32 v151, v94, v95
  buffer_store_dwordx4 v[148:151], v3, s[16:19], s24 offen offset:512 sc1
  v_pk_mul_f32 v[96:97], v[96:97], v[6:7] op_sel:[0,1] op_sel_hi:[1,1]
  v_pk_mul_f32 v[98:99], v[98:99], v[6:7] op_sel:[0,1] op_sel_hi:[1,1]
  v_pk_mul_f32 v[100:101], v[100:101], v[6:7] op_sel:[0,1] op_sel_hi:[1,1]
  v_pk_mul_f32 v[102:103], v[102:103], v[6:7] op_sel:[0,1] op_sel_hi:[1,1]
  v_pk_mul_f32 v[104:105], v[104:105], v[6:7] op_sel:[0,1] op_sel_hi:[1,1]
  v_pk_mul_f32 v[106:107], v[106:107], v[6:7] op_sel:[0,1] op_sel_hi:[1,1]
  v_pk_mul_f32 v[108:109], v[108:109], v[6:7] op_sel:[0,1] op_sel_hi:[1,1]
  v_pk_mul_f32 v[110:111], v[110:111], v[6:7] op_sel:[0,1] op_sel_hi:[1,1]
  v_cvt_pk_bf16_f32 v152, v96, v97
  v_cvt_pk_bf16_f32 v153, v98, v99
  v_cvt_pk_bf16_f32 v154, v104, v105
  v_cvt_pk_bf16_f32 v155, v106, v107
  buffer_store_dwordx4 v[152:155], v3, s[16:19], s24 offen offset:2048 sc1
  v_cvt_pk_bf16_f32 v156, v100, v101
  v_cvt_pk_bf16_f32 v157, v102, v103
  v_cvt_pk_bf16_f32 v158, v108, v109
  v_cvt_pk_bf16_f32 v159, v110, v111
  buffer_store_dwordx4 v[156:159], v3, s[16:19], s24 offen offset:2560 sc1
  s_waitcnt vmcnt(0)
  s_barrier
  v_lshlrev_b32 v8, 4, v0
  v_and_b32 v1, 15, v0
  v_lshrrev_b32 v2, 4, v0
  v_add_u32 v9, 65536, v8
  s_lshl_b32 s34, s3, 11
  s_lshl_b32 s36, s26, 18
  s_add_u32 s36, s36, s34
  s_add_u32 s36, s36, s6
  s_add_u32 s40, s36, 14680064
  s_lshl_b32 s37, s27, 14
  s_add_u32 s36, s36, s37
  s_add_u32 s37, s36, 19922944
  s_add_u32 s38, s37, 8192
  buffer_load_dwordx4 v[16:19], v8, s[16:19], s37 offen offset:0 sc1
  buffer_load_dwordx4 v[20:23], v8, s[16:19], s37 offen offset:1024 sc1
  buffer_load_dwordx4 v[24:27], v8, s[16:19], s38 offen offset:0 sc1
  buffer_load_dwordx4 v[28:31], v8, s[16:19], s38 offen offset:1024 sc1
  s_waitcnt vmcnt(3)
  v_lshlrev_b32 v176, 16, v16
  v_and_b32 v177, 0xffff0000, v16
  v_lshlrev_b32 v178, 16, v17
  v_and_b32 v179, 0xffff0000, v17
  v_lshlrev_b32 v180, 16, v18
  v_and_b32 v181, 0xffff0000, v18
  v_lshlrev_b32 v182, 16, v19
  v_and_b32 v183, 0xffff0000, v19
  s_waitcnt vmcnt(2)
  v_lshlrev_b32 v192, 16, v20
  v_and_b32 v193, 0xffff0000, v20
  v_lshlrev_b32 v194, 16, v21
  v_and_b32 v195, 0xffff0000, v21
  v_lshlrev_b32 v196, 16, v22
  v_and_b32 v197, 0xffff0000, v22
  v_lshlrev_b32 v198, 16, v23
  v_and_b32 v199, 0xffff0000, v23
  s_waitcnt vmcnt(1)
  v_lshlrev_b32 v184, 16, v24
  v_and_b32 v185, 0xffff0000, v24
  v_lshlrev_b32 v186, 16, v25
  v_and_b32 v187, 0xffff0000, v25
  v_lshlrev_b32 v188, 16, v26
  v_and_b32 v189, 0xffff0000, v26
  v_lshlrev_b32 v190, 16, v27
  v_and_b32 v191, 0xffff0000, v27
  s_waitcnt vmcnt(0)
  v_lshlrev_b32 v200, 16, v28
  v_and_b32 v201, 0xffff0000, v28
  v_lshlrev_b32 v202, 16, v29
  v_and_b32 v203, 0xffff0000, v29
  v_lshlrev_b32 v204, 16, v30
  v_and_b32 v205, 0xffff0000, v30
  v_lshlrev_b32 v206, 16, v31
  v_and_b32 v207, 0xffff0000, v31
  s_barrier
  ds_read_b128 v[144:147], v8 offset:0
  ds_read_b128 v[148:151], v8 offset:1024
  ds_read_b128 v[152:155], v8 offset:2048
  ds_read_b128 v[156:159], v8 offset:3072
  buffer_load_dwordx4 v[16:19], v8, s[16:19], s40 offen offset:0 sc1
  buffer_load_dwordx4 v[20:23], v8, s[16:19], s40 offen offset:1024 sc1
  s_add_u32 s40, s40, 8192
  buffer_load_dwordx4 v[24:27], v8, s[16:19], s40 offen offset:0 sc1
  buffer_load_dwordx4 v[28:31], v8, s[16:19], s40 offen offset:1024 sc1
  s_add_u32 s40, s40, 8192
  buffer_load_dwordx4 v[32:35], v8, s[16:19], s40 offen offset:0 sc1
  buffer_load_dwordx4 v[36:39], v8, s[16:19], s40 offen offset:1024 sc1
  s_add_u32 s40, s40, 8192
  buffer_load_dwordx4 v[40:43], v8, s[16:19], s40 offen offset:0 sc1
  buffer_load_dwordx4 v[44:47], v8, s[16:19], s40 offen offset:1024 sc1
  s_add_u32 s40, s40, 8192
  buffer_load_dwordx4 v[48:51], v8, s[16:19], s40 offen offset:0 sc1
  buffer_load_dwordx4 v[52:55], v8, s[16:19], s40 offen offset:1024 sc1
  s_add_u32 s40, s40, 8192
  buffer_load_dwordx4 v[56:59], v8, s[16:19], s40 offen offset:0 sc1
  buffer_load_dwordx4 v[60:63], v8, s[16:19], s40 offen offset:1024 sc1
  s_add_u32 s40, s40, 8192
  s_waitcnt vmcnt(10) lgkmcnt(0)
  v_mfma_f32_16x16x32_bf16 v[176:179], v[144:147], v[16:19], v[176:179]
  ds_read_b128 v[160:163], v8 offset:4096
  v_mfma_f32_16x16x32_bf16 v[192:195], v[144:147], v[20:23], v[192:195]
  ds_read_b128 v[164:167], v8 offset:5120
  v_mfma_f32_16x16x32_bf16 v[180:183], v[148:151], v[16:19], v[180:183]
  ds_read_b128 v[168:171], v8 offset:6144
  v_mfma_f32_16x16x32_bf16 v[196:199], v[148:151], v[20:23], v[196:199]
  ds_read_b128 v[172:175], v8 offset:7168
  v_mfma_f32_16x16x32_bf16 v[184:187], v[152:155], v[16:19], v[184:187]
  buffer_load_dwordx4 v[64:67], v8, s[16:19], s40 offen offset:0 sc1
  v_mfma_f32_16x16x32_bf16 v[200:203], v[152:155], v[20:23], v[200:203]
  buffer_load_dwordx4 v[68:71], v8, s[16:19], s40 offen offset:1024 sc1
  v_mfma_f32_16x16x32_bf16 v[188:191], v[156:159], v[16:19], v[188:191]
  s_add_u32 s40, s40, 8192
  v_mfma_f32_16x16x32_bf16 v[204:207], v[156:159], v[20:23], v[204:207]
  s_waitcnt vmcnt(10) lgkmcnt(0)
  v_mfma_f32_16x16x32_bf16 v[176:179], v[160:163], v[24:27], v[176:179]
  ds_read_b128 v[144:147], v8 offset:8192
  v_mfma_f32_16x16x32_bf16 v[192:195], v[160:163], v[28:31], v[192:195]
  ds_read_b128 v[148:151], v8 offset:9216
  v_mfma_f32_16x16x32_bf16 v[180:183], v[164:167], v[24:27], v[180:183]
  ds_read_b128 v[152:155], v8 offset:10240
  v_mfma_f32_16x16x32_bf16 v[196:199], v[164:167], v[28:31], v[196:199]
  ds_read_b128 v[156:159], v8 offset:11264
  v_mfma_f32_16x16x32_bf16 v[184:187], v[168:171], v[24:27], v[184:187]
  buffer_load_dwordx4 v[72:75], v8, s[16:19], s40 offen offset:0 sc1
  v_mfma_f32_16x16x32_bf16 v[200:203], v[168:171], v[28:31], v[200:203]
  buffer_load_dwordx4 v[76:79], v8, s[16:19], s40 offen offset:1024 sc1
  v_mfma_f32_16x16x32_bf16 v[188:191], v[172:175], v[24:27], v[188:191]
  s_add_u32 s40, s40, 8192
  v_mfma_f32_16x16x32_bf16 v[204:207], v[172:175], v[28:31], v[204:207]
  s_waitcnt vmcnt(10) lgkmcnt(0)
  v_mfma_f32_16x16x32_bf16 v[176:179], v[144:147], v[32:35], v[176:179]
  ds_read_b128 v[160:163], v8 offset:12288
  v_mfma_f32_16x16x32_bf16 v[192:195], v[144:147], v[36:39], v[192:195]
  ds_read_b128 v[164:167], v8 offset:13312
  v_mfma_f32_16x16x32_bf16 v[180:183], v[148:151], v[32:35], v[180:183]
  ds_read_b128 v[168:171], v8 offset:14336
  v_mfma_f32_16x16x32_bf16 v[196:199], v[148:151], v[36:39], v[196:199]
  ds_read_b128 v[172:175], v8 offset:15360
  v_mfma_f32_16x16x32_bf16 v[184:187], v[152:155], v[32:35], v[184:187]
  buffer_load_dwordx4 v[80:83], v8, s[16:19], s40 offen offset:0 sc1
  v_mfma_f32_16x16x32_bf16 v[200:203], v[152:155], v[36:39], v[200:203]
  buffer_load_dwordx4 v[84:87], v8, s[16:19], s40 offen offset:1024 sc1
  v_mfma_f32_16x16x32_bf16 v[188:191], v[156:159], v[32:35], v[188:191]
  s_add_u32 s40, s40, 8192
  v_mfma_f32_16x16x32_bf16 v[204:207], v[156:159], v[36:39], v[204:207]
  s_waitcnt vmcnt(10) lgkmcnt(0)
  v_mfma_f32_16x16x32_bf16 v[176:179], v[160:163], v[40:43], v[176:179]
  ds_read_b128 v[144:147], v8 offset:16384
  v_mfma_f32_16x16x32_bf16 v[192:195], v[160:163], v[44:47], v[192:195]
  ds_read_b128 v[148:151], v8 offset:17408
  v_mfma_f32_16x16x32_bf16 v[180:183], v[164:167], v[40:43], v[180:183]
  ds_read_b128 v[152:155], v8 offset:18432
  v_mfma_f32_16x16x32_bf16 v[196:199], v[164:167], v[44:47], v[196:199]
  ds_read_b128 v[156:159], v8 offset:19456
  v_mfma_f32_16x16x32_bf16 v[184:187], v[168:171], v[40:43], v[184:187]
  buffer_load_dwordx4 v[88:91], v8, s[16:19], s40 offen offset:0 sc1
  v_mfma_f32_16x16x32_bf16 v[200:203], v[168:171], v[44:47], v[200:203]
  buffer_load_dwordx4 v[92:95], v8, s[16:19], s40 offen offset:1024 sc1
  v_mfma_f32_16x16x32_bf16 v[188:191], v[172:175], v[40:43], v[188:191]
  s_add_u32 s40, s40, 8192
  v_mfma_f32_16x16x32_bf16 v[204:207], v[172:175], v[44:47], v[204:207]
  s_waitcnt vmcnt(10) lgkmcnt(0)
  v_mfma_f32_16x16x32_bf16 v[176:179], v[144:147], v[48:51], v[176:179]
  ds_read_b128 v[160:163], v8 offset:20480
  v_mfma_f32_16x16x32_bf16 v[192:195], v[144:147], v[52:55], v[192:195]
  ds_read_b128 v[164:167], v8 offset:21504
  v_mfma_f32_16x16x32_bf16 v[180:183], v[148:151], v[48:51], v[180:183]
  ds_read_b128 v[168:171], v8 offset:22528
  v_mfma_f32_16x16x32_bf16 v[196:199], v[148:151], v[52:55], v[196:199]
  ds_read_b128 v[172:175], v8 offset:23552
  v_mfma_f32_16x16x32_bf16 v[184:187], v[152:155], v[48:51], v[184:187]
  buffer_load_dwordx4 v[96:99], v8, s[16:19], s40 offen offset:0 sc1
  v_mfma_f32_16x16x32_bf16 v[200:203], v[152:155], v[52:55], v[200:203]
  buffer_load_dwordx4 v[100:103], v8, s[16:19], s40 offen offset:1024 sc1
  v_mfma_f32_16x16x32_bf16 v[188:191], v[156:159], v[48:51], v[188:191]
  s_add_u32 s40, s40, 8192
  v_mfma_f32_16x16x32_bf16 v[204:207], v[156:159], v[52:55], v[204:207]
  s_waitcnt vmcnt(10) lgkmcnt(0)
  v_mfma_f32_16x16x32_bf16 v[176:179], v[160:163], v[56:59], v[176:179]
  ds_read_b128 v[144:147], v8 offset:24576
  v_mfma_f32_16x16x32_bf16 v[192:195], v[160:163], v[60:63], v[192:195]
  ds_read_b128 v[148:151], v8 offset:25600
  v_mfma_f32_16x16x32_bf16 v[180:183], v[164:167], v[56:59], v[180:183]
  ds_read_b128 v[152:155], v8 offset:26624
  v_mfma_f32_16x16x32_bf16 v[196:199], v[164:167], v[60:63], v[196:199]
  ds_read_b128 v[156:159], v8 offset:27648
  v_mfma_f32_16x16x32_bf16 v[184:187], v[168:171], v[56:59], v[184:187]
  buffer_load_dwordx4 v[104:107], v8, s[16:19], s40 offen offset:0 sc1
  v_mfma_f32_16x16x32_bf16 v[200:203], v[168:171], v[60:63], v[200:203]
  buffer_load_dwordx4 v[108:111], v8, s[16:19], s40 offen offset:1024 sc1
  v_mfma_f32_16x16x32_bf16 v[188:191], v[172:175], v[56:59], v[188:191]
  s_add_u32 s40, s40, 8192
  v_mfma_f32_16x16x32_bf16 v[204:207], v[172:175], v[60:63], v[204:207]
  s_waitcnt vmcnt(10) lgkmcnt(0)
  v_mfma_f32_16x16x32_bf16 v[176:179], v[144:147], v[64:67], v[176:179]
  ds_read_b128 v[160:163], v8 offset:28672
  v_mfma_f32_16x16x32_bf16 v[192:195], v[144:147], v[68:71], v[192:195]
  ds_read_b128 v[164:167], v8 offset:29696
  v_mfma_f32_16x16x32_bf16 v[180:183], v[148:151], v[64:67], v[180:183]
  ds_read_b128 v[168:171], v8 offset:30720
  v_mfma_f32_16x16x32_bf16 v[196:199], v[148:151], v[68:71], v[196:199]
  ds_read_b128 v[172:175], v8 offset:31744
  v_mfma_f32_16x16x32_bf16 v[184:187], v[152:155], v[64:67], v[184:187]
  buffer_load_dwordx4 v[112:115], v8, s[16:19], s40 offen offset:0 sc1
  v_mfma_f32_16x16x32_bf16 v[200:203], v[152:155], v[68:71], v[200:203]
  buffer_load_dwordx4 v[116:119], v8, s[16:19], s40 offen offset:1024 sc1
  v_mfma_f32_16x16x32_bf16 v[188:191], v[156:159], v[64:67], v[188:191]
  s_add_u32 s40, s40, 8192
  v_mfma_f32_16x16x32_bf16 v[204:207], v[156:159], v[68:71], v[204:207]
  s_waitcnt vmcnt(10) lgkmcnt(0)
  v_mfma_f32_16x16x32_bf16 v[176:179], v[160:163], v[72:75], v[176:179]
  ds_read_b128 v[144:147], v8 offset:32768
  v_mfma_f32_16x16x32_bf16 v[192:195], v[160:163], v[76:79], v[192:195]
  ds_read_b128 v[148:151], v8 offset:33792
  v_mfma_f32_16x16x32_bf16 v[180:183], v[164:167], v[72:75], v[180:183]
  ds_read_b128 v[152:155], v8 offset:34816
  v_mfma_f32_16x16x32_bf16 v[196:199], v[164:167], v[76:79], v[196:199]
  ds_read_b128 v[156:159], v8 offset:35840
  v_mfma_f32_16x16x32_bf16 v[184:187], v[168:171], v[72:75], v[184:187]
  buffer_load_dwordx4 v[120:123], v8, s[16:19], s40 offen offset:0 sc1
  v_mfma_f32_16x16x32_bf16 v[200:203], v[168:171], v[76:79], v[200:203]
  buffer_load_dwordx4 v[124:127], v8, s[16:19], s40 offen offset:1024 sc1
  v_mfma_f32_16x16x32_bf16 v[188:191], v[172:175], v[72:75], v[188:191]
  s_add_u32 s40, s40, 8192
  v_mfma_f32_16x16x32_bf16 v[204:207], v[172:175], v[76:79], v[204:207]
  s_waitcnt vmcnt(10) lgkmcnt(0)
  v_mfma_f32_16x16x32_bf16 v[176:179], v[144:147], v[80:83], v[176:179]
  ds_read_b128 v[160:163], v8 offset:36864
  v_mfma_f32_16x16x32_bf16 v[192:195], v[144:147], v[84:87], v[192:195]
  ds_read_b128 v[164:167], v8 offset:37888
  v_mfma_f32_16x16x32_bf16 v[180:183], v[148:151], v[80:83], v[180:183]
  ds_read_b128 v[168:171], v8 offset:38912
  v_mfma_f32_16x16x32_bf16 v[196:199], v[148:151], v[84:87], v[196:199]
  ds_read_b128 v[172:175], v8 offset:39936
  v_mfma_f32_16x16x32_bf16 v[184:187], v[152:155], v[80:83], v[184:187]
  buffer_load_dwordx4 v[128:131], v8, s[16:19], s40 offen offset:0 sc1
  v_mfma_f32_16x16x32_bf16 v[200:203], v[152:155], v[84:87], v[200:203]
  buffer_load_dwordx4 v[132:135], v8, s[16:19], s40 offen offset:1024 sc1
  v_mfma_f32_16x16x32_bf16 v[188:191], v[156:159], v[80:83], v[188:191]
  s_add_u32 s40, s40, 8192
  v_mfma_f32_16x16x32_bf16 v[204:207], v[156:159], v[84:87], v[204:207]
  s_waitcnt vmcnt(10) lgkmcnt(0)
  v_mfma_f32_16x16x32_bf16 v[176:179], v[160:163], v[88:91], v[176:179]
  ds_read_b128 v[144:147], v8 offset:40960
  v_mfma_f32_16x16x32_bf16 v[192:195], v[160:163], v[92:95], v[192:195]
  ds_read_b128 v[148:151], v8 offset:41984
  v_mfma_f32_16x16x32_bf16 v[180:183], v[164:167], v[88:91], v[180:183]
  ds_read_b128 v[152:155], v8 offset:43008
  v_mfma_f32_16x16x32_bf16 v[196:199], v[164:167], v[92:95], v[196:199]
  ds_read_b128 v[156:159], v8 offset:44032
  v_mfma_f32_16x16x32_bf16 v[184:187], v[168:171], v[88:91], v[184:187]
  buffer_load_dwordx4 v[136:139], v8, s[16:19], s40 offen offset:0 sc1
  v_mfma_f32_16x16x32_bf16 v[200:203], v[168:171], v[92:95], v[200:203]
  buffer_load_dwordx4 v[140:143], v8, s[16:19], s40 offen offset:1024 sc1
  v_mfma_f32_16x16x32_bf16 v[188:191], v[172:175], v[88:91], v[188:191]
  s_add_u32 s40, s40, 8192
  v_mfma_f32_16x16x32_bf16 v[204:207], v[172:175], v[92:95], v[204:207]
  s_waitcnt vmcnt(10) lgkmcnt(0)
  v_mfma_f32_16x16x32_bf16 v[176:179], v[144:147], v[96:99], v[176:179]
  ds_read_b128 v[160:163], v8 offset:45056
  v_mfma_f32_16x16x32_bf16 v[192:195], v[144:147], v[100:103], v[192:195]
  ds_read_b128 v[164:167], v8 offset:46080
  v_mfma_f32_16x16x32_bf16 v[180:183], v[148:151], v[96:99], v[180:183]
  ds_read_b128 v[168:171], v8 offset:47104
  v_mfma_f32_16x16x32_bf16 v[196:199], v[148:151], v[100:103], v[196:199]
  ds_read_b128 v[172:175], v8 offset:48128
  v_mfma_f32_16x16x32_bf16 v[184:187], v[152:155], v[96:99], v[184:187]
  buffer_load_dwordx4 v[16:19], v8, s[16:19], s40 offen offset:0 sc1
  v_mfma_f32_16x16x32_bf16 v[200:203], v[152:155], v[100:103], v[200:203]
  buffer_load_dwordx4 v[20:23], v8, s[16:19], s40 offen offset:1024 sc1
  v_mfma_f32_16x16x32_bf16 v[188:191], v[156:159], v[96:99], v[188:191]
  s_add_u32 s40, s40, 8192
  v_mfma_f32_16x16x32_bf16 v[204:207], v[156:159], v[100:103], v[204:207]
  s_waitcnt vmcnt(10) lgkmcnt(0)
  v_mfma_f32_16x16x32_bf16 v[176:179], v[160:163], v[104:107], v[176:179]
  ds_read_b128 v[144:147], v8 offset:49152
  v_mfma_f32_16x16x32_bf16 v[192:195], v[160:163], v[108:111], v[192:195]
  ds_read_b128 v[148:151], v8 offset:50176
  v_mfma_f32_16x16x32_bf16 v[180:183], v[164:167], v[104:107], v[180:183]
  ds_read_b128 v[152:155], v8 offset:51200
  v_mfma_f32_16x16x32_bf16 v[196:199], v[164:167], v[108:111], v[196:199]
  ds_read_b128 v[156:159], v8 offset:52224
  v_mfma_f32_16x16x32_bf16 v[184:187], v[168:171], v[104:107], v[184:187]
  buffer_load_dwordx4 v[24:27], v8, s[16:19], s40 offen offset:0 sc1
  v_mfma_f32_16x16x32_bf16 v[200:203], v[168:171], v[108:111], v[200:203]
  buffer_load_dwordx4 v[28:31], v8, s[16:19], s40 offen offset:1024 sc1
  v_mfma_f32_16x16x32_bf16 v[188:191], v[172:175], v[104:107], v[188:191]
  s_add_u32 s40, s40, 8192
  v_mfma_f32_16x16x32_bf16 v[204:207], v[172:175], v[108:111], v[204:207]
  s_waitcnt vmcnt(10) lgkmcnt(0)
  v_mfma_f32_16x16x32_bf16 v[176:179], v[144:147], v[112:115], v[176:179]
  ds_read_b128 v[160:163], v8 offset:53248
  v_mfma_f32_16x16x32_bf16 v[192:195], v[144:147], v[116:119], v[192:195]
  ds_read_b128 v[164:167], v8 offset:54272
  v_mfma_f32_16x16x32_bf16 v[180:183], v[148:151], v[112:115], v[180:183]
  ds_read_b128 v[168:171], v8 offset:55296
  v_mfma_f32_16x16x32_bf16 v[196:199], v[148:151], v[116:119], v[196:199]
  ds_read_b128 v[172:175], v8 offset:56320
  v_mfma_f32_16x16x32_bf16 v[184:187], v[152:155], v[112:115], v[184:187]
  buffer_load_dwordx4 v[32:35], v8, s[16:19], s40 offen offset:0 sc1
  v_mfma_f32_16x16x32_bf16 v[200:203], v[152:155], v[116:119], v[200:203]
  buffer_load_dwordx4 v[36:39], v8, s[16:19], s40 offen offset:1024 sc1
  v_mfma_f32_16x16x32_bf16 v[188:191], v[156:159], v[112:115], v[188:191]
  s_add_u32 s40, s40, 8192
  v_mfma_f32_16x16x32_bf16 v[204:207], v[156:159], v[116:119], v[204:207]
  s_waitcnt vmcnt(10) lgkmcnt(0)
  v_mfma_f32_16x16x32_bf16 v[176:179], v[160:163], v[120:123], v[176:179]
  ds_read_b128 v[144:147], v8 offset:57344
  v_mfma_f32_16x16x32_bf16 v[192:195], v[160:163], v[124:127], v[192:195]
  ds_read_b128 v[148:151], v8 offset:58368
  v_mfma_f32_16x16x32_bf16 v[180:183], v[164:167], v[120:123], v[180:183]
  ds_read_b128 v[152:155], v8 offset:59392
  v_mfma_f32_16x16x32_bf16 v[196:199], v[164:167], v[124:127], v[196:199]
  ds_read_b128 v[156:159], v8 offset:60416
  v_mfma_f32_16x16x32_bf16 v[184:187], v[168:171], v[120:123], v[184:187]
  buffer_load_dwordx4 v[40:43], v8, s[16:19], s40 offen offset:0 sc1
  v_mfma_f32_16x16x32_bf16 v[200:203], v[168:171], v[124:127], v[200:203]
  buffer_load_dwordx4 v[44:47], v8, s[16:19], s40 offen offset:1024 sc1
  v_mfma_f32_16x16x32_bf16 v[188:191], v[172:175], v[120:123], v[188:191]
  s_add_u32 s40, s40, 8192
  v_mfma_f32_16x16x32_bf16 v[204:207], v[172:175], v[124:127], v[204:207]
  s_waitcnt vmcnt(10) lgkmcnt(0)
  v_mfma_f32_16x16x32_bf16 v[176:179], v[144:147], v[128:131], v[176:179]
  ds_read_b128 v[160:163], v8 offset:61440
  v_mfma_f32_16x16x32_bf16 v[192:195], v[144:147], v[132:135], v[192:195]
  ds_read_b128 v[164:167], v8 offset:62464
  v_mfma_f32_16x16x32_bf16 v[180:183], v[148:151], v[128:131], v[180:183]
  ds_read_b128 v[168:171], v8 offset:63488
  v_mfma_f32_16x16x32_bf16 v[196:199], v[148:151], v[132:135], v[196:199]
  ds_read_b128 v[172:175], v8 offset:64512
  v_mfma_f32_16x16x32_bf16 v[184:187], v[152:155], v[128:131], v[184:187]
  buffer_load_dwordx4 v[48:51], v8, s[16:19], s40 offen offset:0 sc1
  v_mfma_f32_16x16x32_bf16 v[200:203], v[152:155], v[132:135], v[200:203]
  buffer_load_dwordx4 v[52:55], v8, s[16:19], s40 offen offset:1024 sc1
  v_mfma_f32_16x16x32_bf16 v[188:191], v[156:159], v[128:131], v[188:191]
  s_add_u32 s40, s40, 8192
  v_mfma_f32_16x16x32_bf16 v[204:207], v[156:159], v[132:135], v[204:207]
  s_waitcnt vmcnt(10) lgkmcnt(0)
  v_mfma_f32_16x16x32_bf16 v[176:179], v[160:163], v[136:139], v[176:179]
  ds_read_b128 v[144:147], v9 offset:0
  v_mfma_f32_16x16x32_bf16 v[192:195], v[160:163], v[140:143], v[192:195]
  ds_read_b128 v[148:151], v9 offset:1024
  v_mfma_f32_16x16x32_bf16 v[180:183], v[164:167], v[136:139], v[180:183]
  ds_read_b128 v[152:155], v9 offset:2048
  v_mfma_f32_16x16x32_bf16 v[196:199], v[164:167], v[140:143], v[196:199]
  ds_read_b128 v[156:159], v9 offset:3072
  v_mfma_f32_16x16x32_bf16 v[184:187], v[168:171], v[136:139], v[184:187]
  buffer_load_dwordx4 v[56:59], v8, s[16:19], s40 offen offset:0 sc1
  v_mfma_f32_16x16x32_bf16 v[200:203], v[168:171], v[140:143], v[200:203]
  buffer_load_dwordx4 v[60:63], v8, s[16:19], s40 offen offset:1024 sc1
  v_mfma_f32_16x16x32_bf16 v[188:191], v[172:175], v[136:139], v[188:191]
  s_add_u32 s40, s40, 8192
  v_mfma_f32_16x16x32_bf16 v[204:207], v[172:175], v[140:143], v[204:207]
  s_waitcnt vmcnt(10) lgkmcnt(0)
  v_mfma_f32_16x16x32_bf16 v[176:179], v[144:147], v[16:19], v[176:179]
  ds_read_b128 v[160:163], v9 offset:4096
  v_mfma_f32_16x16x32_bf16 v[192:195], v[144:147], v[20:23], v[192:195]
  ds_read_b128 v[164:167], v9 offset:5120
  v_mfma_f32_16x16x32_bf16 v[180:183], v[148:151], v[16:19], v[180:183]
  ds_read_b128 v[168:171], v9 offset:6144
  v_mfma_f32_16x16x32_bf16 v[196:199], v[148:151], v[20:23], v[196:199]
  ds_read_b128 v[172:175], v9 offset:7168
  v_mfma_f32_16x16x32_bf16 v[184:187], v[152:155], v[16:19], v[184:187]
  buffer_load_dwordx4 v[64:67], v8, s[16:19], s40 offen offset:0 sc1
  v_mfma_f32_16x16x32_bf16 v[200:203], v[152:155], v[20:23], v[200:203]
  buffer_load_dwordx4 v[68:71], v8, s[16:19], s40 offen offset:1024 sc1
  v_mfma_f32_16x16x32_bf16 v[188:191], v[156:159], v[16:19], v[188:191]
  s_add_u32 s40, s40, 8192
  v_mfma_f32_16x16x32_bf16 v[204:207], v[156:159], v[20:23], v[204:207]
  s_waitcnt vmcnt(10) lgkmcnt(0)
  v_mfma_f32_16x16x32_bf16 v[176:179], v[160:163], v[24:27], v[176:179]
  ds_read_b128 v[144:147], v9 offset:8192
  v_mfma_f32_16x16x32_bf16 v[192:195], v[160:163], v[28:31], v[192:195]
  ds_read_b128 v[148:151], v9 offset:9216
  v_mfma_f32_16x16x32_bf16 v[180:183], v[164:167], v[24:27], v[180:183]
  ds_read_b128 v[152:155], v9 offset:10240
  v_mfma_f32_16x16x32_bf16 v[196:199], v[164:167], v[28:31], v[196:199]
  ds_read_b128 v[156:159], v9 offset:11264
  v_mfma_f32_16x16x32_bf16 v[184:187], v[168:171], v[24:27], v[184:187]
  buffer_load_dwordx4 v[72:75], v8, s[16:19], s40 offen offset:0 sc1
  v_mfma_f32_16x16x32_bf16 v[200:203], v[168:171], v[28:31], v[200:203]
  buffer_load_dwordx4 v[76:79], v8, s[16:19], s40 offen offset:1024 sc1
  v_mfma_f32_16x16x32_bf16 v[188:191], v[172:175], v[24:27], v[188:191]
  s_add_u32 s40, s40, 8192
  v_mfma_f32_16x16x32_bf16 v[204:207], v[172:175], v[28:31], v[204:207]
  s_waitcnt vmcnt(10) lgkmcnt(0)
  v_mfma_f32_16x16x32_bf16 v[176:179], v[144:147], v[32:35], v[176:179]
  ds_read_b128 v[160:163], v9 offset:12288
  v_mfma_f32_16x16x32_bf16 v[192:195], v[144:147], v[36:39], v[192:195]
  ds_read_b128 v[164:167], v9 offset:13312
  v_mfma_f32_16x16x32_bf16 v[180:183], v[148:151], v[32:35], v[180:183]
  ds_read_b128 v[168:171], v9 offset:14336
  v_mfma_f32_16x16x32_bf16 v[196:199], v[148:151], v[36:39], v[196:199]
  ds_read_b128 v[172:175], v9 offset:15360
  v_mfma_f32_16x16x32_bf16 v[184:187], v[152:155], v[32:35], v[184:187]
  buffer_load_dwordx4 v[80:83], v8, s[16:19], s40 offen offset:0 sc1
  v_mfma_f32_16x16x32_bf16 v[200:203], v[152:155], v[36:39], v[200:203]
  buffer_load_dwordx4 v[84:87], v8, s[16:19], s40 offen offset:1024 sc1
  v_mfma_f32_16x16x32_bf16 v[188:191], v[156:159], v[32:35], v[188:191]
  s_add_u32 s40, s40, 8192
  v_mfma_f32_16x16x32_bf16 v[204:207], v[156:159], v[36:39], v[204:207]
  s_waitcnt vmcnt(10) lgkmcnt(0)
  v_mfma_f32_16x16x32_bf16 v[176:179], v[160:163], v[40:43], v[176:179]
  ds_read_b128 v[144:147], v9 offset:16384
  v_mfma_f32_16x16x32_bf16 v[192:195], v[160:163], v[44:47], v[192:195]
  ds_read_b128 v[148:151], v9 offset:17408
  v_mfma_f32_16x16x32_bf16 v[180:183], v[164:167], v[40:43], v[180:183]
  ds_read_b128 v[152:155], v9 offset:18432
  v_mfma_f32_16x16x32_bf16 v[196:199], v[164:167], v[44:47], v[196:199]
  ds_read_b128 v[156:159], v9 offset:19456
  v_mfma_f32_16x16x32_bf16 v[184:187], v[168:171], v[40:43], v[184:187]
  buffer_load_dwordx4 v[88:91], v8, s[16:19], s40 offen offset:0 sc1
  v_mfma_f32_16x16x32_bf16 v[200:203], v[168:171], v[44:47], v[200:203]
  buffer_load_dwordx4 v[92:95], v8, s[16:19], s40 offen offset:1024 sc1
  v_mfma_f32_16x16x32_bf16 v[188:191], v[172:175], v[40:43], v[188:191]
  s_add_u32 s40, s40, 8192
  v_mfma_f32_16x16x32_bf16 v[204:207], v[172:175], v[44:47], v[204:207]
  s_waitcnt vmcnt(10) lgkmcnt(0)
  v_mfma_f32_16x16x32_bf16 v[176:179], v[144:147], v[48:51], v[176:179]
  ds_read_b128 v[160:163], v9 offset:20480
  v_mfma_f32_16x16x32_bf16 v[192:195], v[144:147], v[52:55], v[192:195]
  ds_read_b128 v[164:167], v9 offset:21504
  v_mfma_f32_16x16x32_bf16 v[180:183], v[148:151], v[48:51], v[180:183]
  ds_read_b128 v[168:171], v9 offset:22528
  v_mfma_f32_16x16x32_bf16 v[196:199], v[148:151], v[52:55], v[196:199]
  ds_read_b128 v[172:175], v9 offset:23552
  v_mfma_f32_16x16x32_bf16 v[184:187], v[152:155], v[48:51], v[184:187]
  buffer_load_dwordx4 v[96:99], v8, s[16:19], s40 offen offset:0 sc1
  v_mfma_f32_16x16x32_bf16 v[200:203], v[152:155], v[52:55], v[200:203]
  buffer_load_dwordx4 v[100:103], v8, s[16:19], s40 offen offset:1024 sc1
  v_mfma_f32_16x16x32_bf16 v[188:191], v[156:159], v[48:51], v[188:191]
  s_add_u32 s40, s40, 8192
  v_mfma_f32_16x16x32_bf16 v[204:207], v[156:159], v[52:55], v[204:207]
  s_waitcnt vmcnt(10) lgkmcnt(0)
  v_mfma_f32_16x16x32_bf16 v[176:179], v[160:163], v[56:59], v[176:179]
  ds_read_b128 v[144:147], v9 offset:24576
  v_mfma_f32_16x16x32_bf16 v[192:195], v[160:163], v[60:63], v[192:195]
  ds_read_b128 v[148:151], v9 offset:25600
  v_mfma_f32_16x16x32_bf16 v[180:183], v[164:167], v[56:59], v[180:183]
  ds_read_b128 v[152:155], v9 offset:26624
  v_mfma_f32_16x16x32_bf16 v[196:199], v[164:167], v[60:63], v[196:199]
  ds_read_b128 v[156:159], v9 offset:27648
  v_mfma_f32_16x16x32_bf16 v[184:187], v[168:171], v[56:59], v[184:187]
  buffer_load_dwordx4 v[104:107], v8, s[16:19], s40 offen offset:0 sc1
  v_mfma_f32_16x16x32_bf16 v[200:203], v[168:171], v[60:63], v[200:203]
  buffer_load_dwordx4 v[108:111], v8, s[16:19], s40 offen offset:1024 sc1
  v_mfma_f32_16x16x32_bf16 v[188:191], v[172:175], v[56:59], v[188:191]
  s_add_u32 s40, s40, 8192
  v_mfma_f32_16x16x32_bf16 v[204:207], v[172:175], v[60:63], v[204:207]
  s_waitcnt vmcnt(10) lgkmcnt(0)
  v_mfma_f32_16x16x32_bf16 v[176:179], v[144:147], v[64:67], v[176:179]
  ds_read_b128 v[160:163], v9 offset:28672
  v_mfma_f32_16x16x32_bf16 v[192:195], v[144:147], v[68:71], v[192:195]
  ds_read_b128 v[164:167], v9 offset:29696
  v_mfma_f32_16x16x32_bf16 v[180:183], v[148:151], v[64:67], v[180:183]
  ds_read_b128 v[168:171], v9 offset:30720
  v_mfma_f32_16x16x32_bf16 v[196:199], v[148:151], v[68:71], v[196:199]
  ds_read_b128 v[172:175], v9 offset:31744
  v_mfma_f32_16x16x32_bf16 v[184:187], v[152:155], v[64:67], v[184:187]
  buffer_load_dwordx4 v[112:115], v8, s[16:19], s40 offen offset:0 sc1
  v_mfma_f32_16x16x32_bf16 v[200:203], v[152:155], v[68:71], v[200:203]
  buffer_load_dwordx4 v[116:119], v8, s[16:19], s40 offen offset:1024 sc1
  v_mfma_f32_16x16x32_bf16 v[188:191], v[156:159], v[64:67], v[188:191]
  s_add_u32 s40, s40, 8192
  v_mfma_f32_16x16x32_bf16 v[204:207], v[156:159], v[68:71], v[204:207]
  s_waitcnt vmcnt(10) lgkmcnt(0)
  v_mfma_f32_16x16x32_bf16 v[176:179], v[160:163], v[72:75], v[176:179]
  ds_read_b128 v[144:147], v9 offset:32768
  v_mfma_f32_16x16x32_bf16 v[192:195], v[160:163], v[76:79], v[192:195]
  ds_read_b128 v[148:151], v9 offset:33792
  v_mfma_f32_16x16x32_bf16 v[180:183], v[164:167], v[72:75], v[180:183]
  ds_read_b128 v[152:155], v9 offset:34816
  v_mfma_f32_16x16x32_bf16 v[196:199], v[164:167], v[76:79], v[196:199]
  ds_read_b128 v[156:159], v9 offset:35840
  v_mfma_f32_16x16x32_bf16 v[184:187], v[168:171], v[72:75], v[184:187]
  buffer_load_dwordx4 v[120:123], v8, s[16:19], s40 offen offset:0 sc1
  v_mfma_f32_16x16x32_bf16 v[200:203], v[168:171], v[76:79], v[200:203]
  buffer_load_dwordx4 v[124:127], v8, s[16:19], s40 offen offset:1024 sc1
  v_mfma_f32_16x16x32_bf16 v[188:191], v[172:175], v[72:75], v[188:191]
  s_add_u32 s40, s40, 8192
  v_mfma_f32_16x16x32_bf16 v[204:207], v[172:175], v[76:79], v[204:207]
  s_waitcnt vmcnt(10) lgkmcnt(0)
  v_mfma_f32_16x16x32_bf16 v[176:179], v[144:147], v[80:83], v[176:179]
  ds_read_b128 v[160:163], v9 offset:36864
  v_mfma_f32_16x16x32_bf16 v[192:195], v[144:147], v[84:87], v[192:195]
  ds_read_b128 v[164:167], v9 offset:37888
  v_mfma_f32_16x16x32_bf16 v[180:183], v[148:151], v[80:83], v[180:183]
  ds_read_b128 v[168:171], v9 offset:38912
  v_mfma_f32_16x16x32_bf16 v[196:199], v[148:151], v[84:87], v[196:199]
  ds_read_b128 v[172:175], v9 offset:39936
  v_mfma_f32_16x16x32_bf16 v[184:187], v[152:155], v[80:83], v[184:187]
  buffer_load_dwordx4 v[128:131], v8, s[16:19], s40 offen offset:0 sc1
  v_mfma_f32_16x16x32_bf16 v[200:203], v[152:155], v[84:87], v[200:203]
  buffer_load_dwordx4 v[132:135], v8, s[16:19], s40 offen offset:1024 sc1
  v_mfma_f32_16x16x32_bf16 v[188:191], v[156:159], v[80:83], v[188:191]
  s_add_u32 s40, s40, 8192
  v_mfma_f32_16x16x32_bf16 v[204:207], v[156:159], v[84:87], v[204:207]
  s_waitcnt vmcnt(10) lgkmcnt(0)
  v_mfma_f32_16x16x32_bf16 v[176:179], v[160:163], v[88:91], v[176:179]
  ds_read_b128 v[144:147], v9 offset:40960
  v_mfma_f32_16x16x32_bf16 v[192:195], v[160:163], v[92:95], v[192:195]
  ds_read_b128 v[148:151], v9 offset:41984
  v_mfma_f32_16x16x32_bf16 v[180:183], v[164:167], v[88:91], v[180:183]
  ds_read_b128 v[152:155], v9 offset:43008
  v_mfma_f32_16x16x32_bf16 v[196:199], v[164:167], v[92:95], v[196:199]
  ds_read_b128 v[156:159], v9 offset:44032
  v_mfma_f32_16x16x32_bf16 v[184:187], v[168:171], v[88:91], v[184:187]
  buffer_load_dwordx4 v[136:139], v8, s[16:19], s40 offen offset:0 sc1
  v_mfma_f32_16x16x32_bf16 v[200:203], v[168:171], v[92:95], v[200:203]
  buffer_load_dwordx4 v[140:143], v8, s[16:19], s40 offen offset:1024 sc1
  v_mfma_f32_16x16x32_bf16 v[188:191], v[172:175], v[88:91], v[188:191]
  s_add_u32 s40, s40, 8192
  v_mfma_f32_16x16x32_bf16 v[204:207], v[172:175], v[92:95], v[204:207]
  s_waitcnt vmcnt(10) lgkmcnt(0)
  v_mfma_f32_16x16x32_bf16 v[176:179], v[144:147], v[96:99], v[176:179]
  ds_read_b128 v[160:163], v9 offset:45056
  v_mfma_f32_16x16x32_bf16 v[192:195], v[144:147], v[100:103], v[192:195]
  ds_read_b128 v[164:167], v9 offset:46080
  v_mfma_f32_16x16x32_bf16 v[180:183], v[148:151], v[96:99], v[180:183]
  ds_read_b128 v[168:171], v9 offset:47104
  v_mfma_f32_16x16x32_bf16 v[196:199], v[148:151], v[100:103], v[196:199]
  ds_read_b128 v[172:175], v9 offset:48128
  v_mfma_f32_16x16x32_bf16 v[184:187], v[152:155], v[96:99], v[184:187]
  v_mfma_f32_16x16x32_bf16 v[200:203], v[152:155], v[100:103], v[200:203]
  v_mfma_f32_16x16x32_bf16 v[188:191], v[156:159], v[96:99], v[188:191]
  v_mfma_f32_16x16x32_bf16 v[204:207], v[156:159], v[100:103], v[204:207]
  s_waitcnt vmcnt(8) lgkmcnt(0)
  v_mfma_f32_16x16x32_bf16 v[176:179], v[160:163], v[104:107], v[176:179]
  ds_read_b128 v[144:147], v9 offset:49152
  v_mfma_f32_16x16x32_bf16 v[192:195], v[160:163], v[108:111], v[192:195]
  ds_read_b128 v[148:151], v9 offset:50176
  v_mfma_f32_16x16x32_bf16 v[180:183], v[164:167], v[104:107], v[180:183]
  ds_read_b128 v[152:155], v9 offset:51200
  v_mfma_f32_16x16x32_bf16 v[196:199], v[164:167], v[108:111], v[196:199]
  ds_read_b128 v[156:159], v9 offset:52224
  v_mfma_f32_16x16x32_bf16 v[184:187], v[168:171], v[104:107], v[184:187]
  v_mfma_f32_16x16x32_bf16 v[200:203], v[168:171], v[108:111], v[200:203]
  v_mfma_f32_16x16x32_bf16 v[188:191], v[172:175], v[104:107], v[188:191]
  v_mfma_f32_16x16x32_bf16 v[204:207], v[172:175], v[108:111], v[204:207]
  s_waitcnt vmcnt(6) lgkmcnt(0)
  v_mfma_f32_16x16x32_bf16 v[176:179], v[144:147], v[112:115], v[176:179]
  ds_read_b128 v[160:163], v9 offset:53248
  v_mfma_f32_16x16x32_bf16 v[192:195], v[144:147], v[116:119], v[192:195]
  ds_read_b128 v[164:167], v9 offset:54272
  v_mfma_f32_16x16x32_bf16 v[180:183], v[148:151], v[112:115], v[180:183]
  ds_read_b128 v[168:171], v9 offset:55296
  v_mfma_f32_16x16x32_bf16 v[196:199], v[148:151], v[116:119], v[196:199]
  ds_read_b128 v[172:175], v9 offset:56320
  v_mfma_f32_16x16x32_bf16 v[184:187], v[152:155], v[112:115], v[184:187]
  v_mfma_f32_16x16x32_bf16 v[200:203], v[152:155], v[116:119], v[200:203]
  v_mfma_f32_16x16x32_bf16 v[188:191], v[156:159], v[112:115], v[188:191]
  v_mfma_f32_16x16x32_bf16 v[204:207], v[156:159], v[116:119], v[204:207]
  s_waitcnt vmcnt(4) lgkmcnt(0)
  v_mfma_f32_16x16x32_bf16 v[176:179], v[160:163], v[120:123], v[176:179]
  ds_read_b128 v[144:147], v9 offset:57344
  v_mfma_f32_16x16x32_bf16 v[192:195], v[160:163], v[124:127], v[192:195]
  ds_read_b128 v[148:151], v9 offset:58368
  v_mfma_f32_16x16x32_bf16 v[180:183], v[164:167], v[120:123], v[180:183]
  ds_read_b128 v[152:155], v9 offset:59392
  v_mfma_f32_16x16x32_bf16 v[196:199], v[164:167], v[124:127], v[196:199]
  ds_read_b128 v[156:159], v9 offset:60416
  v_mfma_f32_16x16x32_bf16 v[184:187], v[168:171], v[120:123], v[184:187]
  v_mfma_f32_16x16x32_bf16 v[200:203], v[168:171], v[124:127], v[200:203]
  v_mfma_f32_16x16x32_bf16 v[188:191], v[172:175], v[120:123], v[188:191]
  v_mfma_f32_16x16x32_bf16 v[204:207], v[172:175], v[124:127], v[204:207]
  s_waitcnt vmcnt(2) lgkmcnt(0)
  v_mfma_f32_16x16x32_bf16 v[176:179], v[144:147], v[128:131], v[176:179]
  ds_read_b128 v[160:163], v9 offset:61440
  v_mfma_f32_16x16x32_bf16 v[192:195], v[144:147], v[132:135], v[192:195]
  ds_read_b128 v[164:167], v9 offset:62464
  v_mfma_f32_16x16x32_bf16 v[180:183], v[148:151], v[128:131], v[180:183]
  ds_read_b128 v[168:171], v9 offset:63488
  v_mfma_f32_16x16x32_bf16 v[196:199], v[148:151], v[132:135], v[196:199]
  ds_read_b128 v[172:175], v9 offset:64512
  v_mfma_f32_16x16x32_bf16 v[184:187], v[152:155], v[128:131], v[184:187]
  v_mfma_f32_16x16x32_bf16 v[200:203], v[152:155], v[132:135], v[200:203]
  v_mfma_f32_16x16x32_bf16 v[188:191], v[156:159], v[128:131], v[188:191]
  v_mfma_f32_16x16x32_bf16 v[204:207], v[156:159], v[132:135], v[204:207]
  s_waitcnt vmcnt(0) lgkmcnt(0)
  s_barrier
  v_mfma_f32_16x16x32_bf16 v[176:179], v[160:163], v[136:139], v[176:179]
  v_mfma_f32_16x16x32_bf16 v[192:195], v[160:163], v[140:143], v[192:195]
  v_mfma_f32_16x16x32_bf16 v[180:183], v[164:167], v[136:139], v[180:183]
  v_mfma_f32_16x16x32_bf16 v[196:199], v[164:167], v[140:143], v[196:199]
  v_mfma_f32_16x16x32_bf16 v[184:187], v[168:171], v[136:139], v[184:187]
  v_mfma_f32_16x16x32_bf16 v[200:203], v[168:171], v[140:143], v[200:203]
  v_mfma_f32_16x16x32_bf16 v[188:191], v[172:175], v[136:139], v[188:191]
  v_mfma_f32_16x16x32_bf16 v[204:207], v[172:175], v[140:143], v[204:207]
  s_nop 0
  v_cvt_pk_bf16_f32 v16, v176, v177
  v_cvt_pk_bf16_f32 v17, v178, v179
  v_cvt_pk_bf16_f32 v18, v180, v181
  v_cvt_pk_bf16_f32 v19, v182, v183
  v_cvt_pk_bf16_f32 v20, v192, v193
  v_cvt_pk_bf16_f32 v21, v194, v195
  v_cvt_pk_bf16_f32 v22, v196, v197
  v_cvt_pk_bf16_f32 v23, v198, v199
  v_cvt_pk_bf16_f32 v24, v184, v185
  v_cvt_pk_bf16_f32 v25, v186, v187
  v_cvt_pk_bf16_f32 v26, v188, v189
  v_cvt_pk_bf16_f32 v27, v190, v191
  v_cvt_pk_bf16_f32 v28, v200, v201
  v_cvt_pk_bf16_f32 v29, v202, v203
  v_cvt_pk_bf16_f32 v30, v204, v205
  v_cvt_pk_bf16_f32 v31, v206, v207
  s_add_u32 s36, s36, 25165824
  s_add_u32 s38, s36, 8192
  buffer_store_dwordx4 v[16:19], v8, s[16:19], s36 offen offset:0 sc1
  buffer_store_dwordx4 v[20:23], v8, s[16:19], s36 offen offset:1024 sc1
  buffer_store_dwordx4 v[24:27], v8, s[16:19], s38 offen offset:0 sc1
  buffer_store_dwordx4 v[28:31], v8, s[16:19], s38 offen offset:1024 sc1
  s_lshl_b32 s38, s3, 11
  v_add_u32 v3, s38, v8
  ds_write_b128 v3, v[16:19] offset:0
  ds_write_b128 v3, v[20:23] offset:1024
  ds_write_b128 v3, v[24:27] offset:22528
  ds_write_b128 v3, v[28:31] offset:23552
  v_mov_b32 v3, 0x3f803f80
  v_mov_b32 v32, 0
  v_mov_b32 v33, 0
  v_mov_b32 v34, 0
  v_mov_b32 v35, 0
  v_mov_b32 v36, 0
  v_mov_b32 v37, 0
  v_mov_b32 v38, 0
  v_mov_b32 v39, 0
  v_dot2c_f32_bf16 v32, v16, v3
  v_dot2c_f32_bf16 v36, v16, v16
  v_dot2c_f32_bf16 v33, v20, v3
  v_dot2c_f32_bf16 v37, v20, v20
  v_dot2c_f32_bf16 v34, v24, v3
  v_dot2c_f32_bf16 v38, v24, v24
  v_dot2c_f32_bf16 v35, v28, v3
  v_dot2c_f32_bf16 v39, v28, v28
  v_dot2c_f32_bf16 v32, v17, v3
  v_dot2c_f32_bf16 v36, v17, v17
  v_dot2c_f32_bf16 v33, v21, v3
  v_dot2c_f32_bf16 v37, v21, v21
  v_dot2c_f32_bf16 v34, v25, v3
  v_dot2c_f32_bf16 v38, v25, v25
  v_dot2c_f32_bf16 v35, v29, v3
  v_dot2c_f32_bf16 v39, v29, v29
  v_dot2c_f32_bf16 v32, v18, v3
  v_dot2c_f32_bf16 v36, v18, v18
  v_dot2c_f32_bf16 v33, v22, v3
  v_dot2c_f32_bf16 v37, v22, v22
  v_dot2c_f32_bf16 v34, v26, v3
  v_dot2c_f32_bf16 v38, v26, v26
  v_dot2c_f32_bf16 v35, v30, v3
  v_dot2c_f32_bf16 v39, v30, v30
  v_dot2c_f32_bf16 v32, v19, v3
  v_dot2c_f32_bf16 v36, v19, v19
  v_dot2c_f32_bf16 v33, v23, v3
  v_dot2c_f32_bf16 v37, v23, v23
  v_dot2c_f32_bf16 v34, v27, v3
  v_dot2c_f32_bf16 v38, v27, v27
  v_dot2c_f32_bf16 v35, v31, v3
  v_dot2c_f32_bf16 v39, v31, v31
  v_permlane32_swap_b32 v32, v33
  s_nop 0
  v_permlane32_swap_b32 v34, v35
  v_permlane32_swap_b32 v36, v37
  v_permlane32_swap_b32 v38, v39
  v_add_f32 v32, v32, v33
  v_add_f32 v34, v34, v35
  v_add_f32 v36, v36, v37
  v_add_f32 v38, v38, v39
  v_permlane16_swap_b32 v32, v34
  s_nop 0
  v_permlane16_swap_b32 v36, v38
  v_add_f32 v32, v32, v34
  v_add_f32 v33, v36, v38
  v_and_b32 v13, 1, v2
  v_lshlrev_b32 v13, 10, v13
  v_lshrrev_b32 v14, 1, v2
  v_lshl_add_u32 v13, v14, 7, v13
  v_lshl_add_u32 v13, v1, 3, v13
  s_lshl_b32 s37, s26, 15
  s_lshl_b32 s38, s27, 11
  s_add_u32 s37, s37, s38
  s_lshl_b32 s38, s3, 8
  s_add_u32 s37, s37, s38
  s_add_u32 s37, s37, s10
  s_add_u32 s37, s37, 47710208
  buffer_store_dwordx2 v[32:33], v13, s[16:19], s37 offen sc1
  s_waitcnt vmcnt(0) lgkmcnt(0)
  s_barrier
  v_lshlrev_b32 v8, 4, v0
  v_and_b32 v1, 15, v0
  v_lshrrev_b32 v2, 4, v0
  s_lshl_b32 s34, s32, 12
  s_lshl_b32 s35, s33, 11
  s_add_u32 s34, s34, s35
  v_add_u32 v4, s34, v8
  v_xor_b32 v5, 2048, v4
  s_lshl_b32 s34, s33, 11
  s_add_u32 s34, s34, 8192
  v_add_u32 v6, s34, v8
  v_add_u32 v7, 20480, v8
  v_mov_b32 v112, 0
  v_mov_b32 v113, 0
  v_mov_b32 v114, 0
  v_mov_b32 v115, 0
  v_mov_b32 v116, 0
  v_mov_b32 v117, 0
  v_mov_b32 v118, 0
  v_mov_b32 v119, 0
  v_mov_b32 v120, 0
  v_mov_b32 v121, 0
  v_mov_b32 v122, 0
  v_mov_b32 v123, 0
  v_mov_b32 v124, 0
  v_mov_b32 v125, 0
  v_mov_b32 v126, 0
  v_mov_b32 v127, 0
  v_mov_b32 v128, 0
  v_mov_b32 v129, 0
  v_mov_b32 v130, 0
  v_mov_b32 v131, 0
  v_mov_b32 v132, 0
  v_mov_b32 v133, 0
  v_mov_b32 v134, 0
  v_mov_b32 v135, 0
  v_mov_b32 v136, 0
  v_mov_b32 v137, 0
  v_mov_b32 v138, 0
  v_mov_b32 v139, 0
  v_mov_b32 v140, 0
  v_mov_b32 v141, 0
  v_mov_b32 v142, 0
  v_mov_b32 v143, 0
  v_mov_b32 v144, 0
  v_mov_b32 v145, 0
  v_mov_b32 v146, 0
  v_mov_b32 v147, 0
  v_mov_b32 v148, 0
  v_mov_b32 v149, 0
  v_mov_b32 v150, 0
  v_mov_b32 v151, 0
  v_mov_b32 v152, 0
  v_mov_b32 v153, 0
  v_mov_b32 v154, 0
  v_mov_b32 v155, 0
  v_mov_b32 v156, 0
  v_mov_b32 v157, 0
  v_mov_b32 v158, 0
  v_mov_b32 v159, 0
  v_mov_b32 v160, 0
  v_mov_b32 v161, 0
  v_mov_b32 v162, 0
  v_mov_b32 v163, 0
  v_mov_b32 v164, 0
  v_mov_b32 v165, 0
  v_mov_b32 v166, 0
  v_mov_b32 v167, 0
  v_mov_b32 v168, 0
  v_mov_b32 v169, 0
  v_mov_b32 v170, 0
  v_mov_b32 v171, 0
  v_mov_b32 v172, 0
  v_mov_b32 v173, 0
  v_mov_b32 v174, 0
  v_mov_b32 v175, 0
  v_mov_b32 v176, 0
  v_mov_b32 v177, 0
  v_mov_b32 v178, 0
  v_mov_b32 v179, 0
  v_mov_b32 v180, 0
  v_mov_b32 v181, 0
  v_mov_b32 v182, 0
  v_mov_b32 v183, 0
  v_mov_b32 v184, 0
  v_mov_b32 v185, 0
  v_mov_b32 v186, 0
  v_mov_b32 v187, 0
  v_mov_b32 v188, 0
  v_mov_b32 v189, 0
  v_mov_b32 v190, 0
  v_mov_b32 v191, 0
  v_mov_b32 v192, 0
  v_mov_b32 v193, 0
  v_mov_b32 v194, 0
  v_mov_b32 v195, 0
  v_mov_b32 v196, 0
  v_mov_b32 v197, 0
  v_mov_b32 v198, 0
  v_mov_b32 v199, 0
  v_mov_b32 v200, 0
  v_mov_b32 v201, 0
  v_mov_b32 v202, 0
  v_mov_b32 v203, 0
  v_mov_b32 v204, 0
  v_mov_b32 v205, 0
  v_mov_b32 v206, 0
  v_mov_b32 v207, 0
  v_mov_b32 v208, 0
  v_mov_b32 v209, 0
  v_mov_b32 v210, 0
  v_mov_b32 v211, 0
  v_mov_b32 v212, 0
  v_mov_b32 v213, 0
  v_mov_b32 v214, 0
  v_mov_b32 v215, 0
  v_mov_b32 v216, 0
  v_mov_b32 v217, 0
  v_mov_b32 v218, 0
  v_mov_b32 v219, 0
  v_mov_b32 v220, 0
  v_mov_b32 v221, 0
  v_mov_b32 v222, 0
  v_mov_b32 v223, 0
  s_mov_b32 s44, 135274560
  s_mov_b32 s45, 0
  s_mov_b32 s43, 4294832128
  s_mov_b32 s41, 0
  s_bitcmp1_b64 s[44:45], s41
  s_cselect_b32 s42, s43, 22528
  s_add_u32 s41, s41, 1
  ds_read_b128 v[16:19], v4 offset:0
  ds_read_b128 v[20:23], v4 offset:1024
  ds_read_b128 v[24:27], v5 offset:0
  ds_read_b128 v[28:31], v5 offset:1024
  ds_read_b128 v[32:35], v6 offset:0
  ds_read_b128 v[36:39], v6 offset:1024
  ds_read_b128 v[40:43], v6 offset:4096
  ds_read_b128 v[44:47], v6 offset:5120
  ds_read_b128 v[48:51], v6 offset:8192
  ds_read_b128 v[52:55], v6 offset:9216
  ds_read_b128 v[56:59], v7 offset:0
  ds_read_b128 v[60:63], v7 offset:1024
  v_add_u32 v4, s42, v4
  v_add_u32 v5, s42, v5
  v_add_u32 v6, s42, v6
  v_add_u32 v7, s42, v7
  s_waitcnt lgkmcnt(0)
.p2align 6
w1_cloop:
  v_mfma_f32_16x16x32_bf16 v[112:115], v[32:35], v[16:19], v[112:115]
  ds_read_b128 v[64:67], v4 offset:0
  v_mfma_f32_16x16x32_bf16 v[144:147], v[32:35], v[20:23], v[144:147]
  ds_read_b128 v[68:71], v4 offset:1024
  v_mfma_f32_16x16x32_bf16 v[176:179], v[32:35], v[24:27], v[176:179]
  ds_read_b128 v[72:75], v5 offset:0
  v_mfma_f32_16x16x32_bf16 v[200:203], v[32:35], v[28:31], v[200:203]
  ds_read_b128 v[76:79], v5 offset:1024
  v_mfma_f32_16x16x32_bf16 v[116:119], v[36:39], v[16:19], v[116:119]
  ds_read_b128 v[80:83], v6 offset:0
  v_mfma_f32_16x16x32_bf16 v[148:151], v[36:39], v[20:23], v[148:151]
  ds_read_b128 v[84:87], v6 offset:1024
  v_mfma_f32_16x16x32_bf16 v[180:183], v[36:39], v[24:27], v[180:183]
  ds_read_b128 v[88:91], v6 offset:4096
  v_mfma_f32_16x16x32_bf16 v[204:207], v[36:39], v[28:31], v[204:207]
  ds_read_b128 v[92:95], v6 offset:5120
  v_mfma_f32_16x16x32_bf16 v[120:123], v[40:43], v[16:19], v[120:123]
  ds_read_b128 v[96:99], v6 offset:8192
  v_mfma_f32_16x16x32_bf16 v[152:155], v[40:43], v[20:23], v[152:155]
  ds_read_b128 v[100:103], v6 offset:9216
  v_mfma_f32_16x16x32_bf16 v[184:187], v[40:43], v[24:27], v[184:187]
  ds_read_b128 v[104:107], v7 offset:0
  v_mfma_f32_16x16x32_bf16 v[208:211], v[40:43], v[28:31], v[208:211]
  ds_read_b128 v[108:111], v7 offset:1024
  v_mfma_f32_16x16x32_bf16 v[124:127], v[44:47], v[16:19], v[124:127]
  s_bitcmp1_b64 s[44:45], s41
  v_mfma_f32_16x16x32_bf16 v[156:159], v[44:47], v[20:23], v[156:159]
  s_cselect_b32 s42, s43, 22528
  v_mfma_f32_16x16x32_bf16 v[188:191], v[44:47], v[24:27], v[188:191]
  s_add_u32 s41, s41, 1
  v_mfma_f32_16x16x32_bf16 v[212:215], v[44:47], v[28:31], v[212:215]
  v_add_u32 v4, s42, v4
  v_mfma_f32_16x16x32_bf16 v[128:131], v[48:51], v[16:19], v[128:131]
  v_add_u32 v5, s42, v5
  v_mfma_f32_16x16x32_bf16 v[160:163], v[48:51], v[20:23], v[160:163]
  v_add_u32 v6, s42, v6
  v_mfma_f32_16x16x32_bf16 v[192:195], v[48:51], v[24:27], v[192:195]
  v_add_u32 v7, s42, v7
  v_mfma_f32_16x16x32_bf16 v[216:219], v[48:51], v[28:31], v[216:219]
  v_mfma_f32_16x16x32_bf16 v[132:135], v[52:55], v[16:19], v[132:135]
  v_mfma_f32_16x16x32_bf16 v[164:167], v[52:55], v[20:23], v[164:167]
  v_mfma_f32_16x16x32_bf16 v[196:199], v[52:55], v[24:27], v[196:199]
  v_mfma_f32_16x16x32_bf16 v[220:223], v[52:55], v[28:31], v[220:223]
  v_mfma_f32_16x16x32_bf16 v[136:139], v[56:59], v[16:19], v[136:139]
  v_mfma_f32_16x16x32_bf16 v[168:171], v[56:59], v[20:23], v[168:171]
  v_mfma_f32_16x16x32_bf16 v[140:143], v[60:63], v[16:19], v[140:143]
  s_waitcnt lgkmcnt(0)
  s_barrier
  v_mfma_f32_16x16x32_bf16 v[172:175], v[60:63], v[20:23], v[172:175]
  v_mfma_f32_16x16x32_bf16 v[112:115], v[80:83], v[64:67], v[112:115]
  ds_read_b128 v[16:19], v4 offset:0
  v_mfma_f32_16x16x32_bf16 v[144:147], v[80:83], v[68:71], v[144:147]
  ds_read_b128 v[20:23], v4 offset:1024
  v_mfma_f32_16x16x32_bf16 v[176:179], v[80:83], v[72:75], v[176:179]
  ds_read_b128 v[24:27], v5 offset:0
  v_mfma_f32_16x16x32_bf16 v[200:203], v[80:83], v[76:79], v[200:203]
  ds_read_b128 v[28:31], v5 offset:1024
  v_mfma_f32_16x16x32_bf16 v[116:119], v[84:87], v[64:67], v[116:119]
  ds_read_b128 v[32:35], v6 offset:0
  v_mfma_f32_16x16x32_bf16 v[148:151], v[84:87], v[68:71], v[148:151]
  ds_read_b128 v[36:39], v6 offset:1024
  v_mfma_f32_16x16x32_bf16 v[180:183], v[84:87], v[72:75], v[180:183]
  ds_read_b128 v[40:43], v6 offset:4096
  v_mfma_f32_16x16x32_bf16 v[204:207], v[84:87], v[76:79], v[204:207]
  ds_read_b128 v[44:47], v6 offset:5120
  v_mfma_f32_16x16x32_bf16 v[120:123], v[88:91], v[64:67], v[120:123]
  ds_read_b128 v[48:51], v6 offset:8192
  v_mfma_f32_16x16x32_bf16 v[152:155], v[88:91], v[68:71], v[152:155]
  ds_read_b128 v[52:55], v6 offset:9216
  v_mfma_f32_16x16x32_bf16 v[184:187], v[88:91], v[72:75], v[184:187]
  ds_read_b128 v[56:59], v7 offset:0
  v_mfma_f32_16x16x32_bf16 v[208:211], v[88:91], v[76:79], v[208:211]
  ds_read_b128 v[60:63], v7 offset:1024
  v_mfma_f32_16x16x32_bf16 v[124:127], v[92:95], v[64:67], v[124:127]
  s_bitcmp1_b64 s[44:45], s41
  v_mfma_f32_16x16x32_bf16 v[156:159], v[92:95], v[68:71], v[156:159]
  s_cselect_b32 s42, s43, 22528
  v_mfma_f32_16x16x32_bf16 v[188:191], v[92:95], v[72:75], v[188:191]
  s_add_u32 s41, s41, 1
  v_mfma_f32_16x16x32_bf16 v[212:215], v[92:95], v[76:79], v[212:215]
  v_add_u32 v4, s42, v4
  v_mfma_f32_16x16x32_bf16 v[128:131], v[96:99], v[64:67], v[128:131]
  v_add_u32 v5, s42, v5
  v_mfma_f32_16x16x32_bf16 v[160:163], v[96:99], v[68:71], v[160:163]
  v_add_u32 v6, s42, v6
  v_mfma_f32_16x16x32_bf16 v[192:195], v[96:99], v[72:75], v[192:195]
  v_add_u32 v7, s42, v7
  v_mfma_f32_16x16x32_bf16 v[216:219], v[96:99], v[76:79], v[216:219]
  v_mfma_f32_16x16x32_bf16 v[132:135], v[100:103], v[64:67], v[132:135]
  v_mfma_f32_16x16x32_bf16 v[164:167], v[100:103], v[68:71], v[164:167]
  v_mfma_f32_16x16x32_bf16 v[196:199], v[100:103], v[72:75], v[196:199]
  v_mfma_f32_16x16x32_bf16 v[220:223], v[100:103], v[76:79], v[220:223]
  v_mfma_f32_16x16x32_bf16 v[136:139], v[104:107], v[64:67], v[136:139]
  s_cmp_lt_u32 s41, 33
  v_mfma_f32_16x16x32_bf16 v[168:171], v[104:107], v[68:71], v[168:171]
  v_mfma_f32_16x16x32_bf16 v[140:143], v[108:111], v[64:67], v[140:143]
  s_waitcnt lgkmcnt(0)
  v_mfma_f32_16x16x32_bf16 v[172:175], v[108:111], v[68:71], v[172:175]
  s_cbranch_scc1 w1_cloop
  s_lshl_b32 s34, s32, 8
  s_add_u32 s34, s34, 161792
  v_lshlrev_b32 v3, 2, v1
  s_lshl_b32 s35, s33, 7
  s_add_u32 s35, s35, s34
  v_add_u32 v3, s35, v3
  v_xor_b32 v14, 128, v3
  ds_read_b32 v16, v3 offset:0
  ds_read_b32 v17, v3 offset:512
  ds_read_b32 v18, v3 offset:64
  ds_read_b32 v19, v3 offset:576
  ds_read_b32 v20, v14 offset:0
  ds_read_b32 v21, v14 offset:512
  ds_read_b32 v22, v14 offset:64
  ds_read_b32 v23, v14 offset:576
  v_lshlrev_b32 v13, 4, v2
  v_add_u32 v13, 162816, v13
  s_lshl_b32 s35, s33, 7
  v_add_u32 v15, s35, v13
  ds_read_b128 v[24:27], v15 offset:0
  ds_read_b128 v[28:31], v15 offset:64
  ds_read_b128 v[32:35], v15 offset:256
  ds_read_b128 v[36:39], v15 offset:320
  ds_read_b128 v[40:43], v15 offset:512
  ds_read_b128 v[44:47], v15 offset:576
  ds_read_b128 v[48:51], v13 offset:768
  ds_read_b128 v[52:55], v13 offset:832
  s_mul_i32 s36, s26, 112
  s_mul_i32 s37, s27, 7
  s_add_u32 s36, s36, s37
  s_add_u32 s37, s36, s33
  s_add_u32 s38, s36, 6
  s_lshl_b32 s37, s37, 13
  s_lshl_b32 s38, s38, 13
  s_lshl_b32 s36, s32, 12
  s_add_u32 s36, s36, s6
  s_add_u32 s36, s36, 30408704
  s_add_u32 s37, s37, s36
  s_add_u32 s38, s38, s36
  s_lshl_b32 s35, s33, 11
  v_add_u32 v3, s35, v8
  v_xor_b32 v14, 2048, v3
  s_lshl_b32 s34, s32, 12
  v_add_u32 v11, s34, v3
  s_lshl_b32 s35, s33, 13
  s_add_u32 s34, s34, s35
  v_add_u32 v9, s34, v3
  v_add_u32 v10, s34, v14
  s_waitcnt lgkmcnt(0)
  v_pk_fma_f32 v[112:113], v[24:25], v[16:17], v[112:113] op_sel:[0,0,0] op_sel_hi:[1,0,1]
  v_pk_fma_f32 v[114:115], v[26:27], v[16:17], v[114:115] op_sel:[0,0,0] op_sel_hi:[1,0,1]
  v_pk_mul_f32 v[112:113], v[112:113], v[16:17] op_sel:[0,1] op_sel_hi:[1,1]
  v_pk_mul_f32 v[114:115], v[114:115], v[16:17] op_sel:[0,1] op_sel_hi:[1,1]
  v_cvt_pk_bf16_f32 v56, v112, v113
  v_cvt_pk_bf16_f32 v57, v114, v115
  v_pk_fma_f32 v[116:117], v[28:29], v[16:17], v[116:117] op_sel:[0,0,0] op_sel_hi:[1,0,1]
  v_pk_fma_f32 v[118:119], v[30:31], v[16:17], v[118:119] op_sel:[0,0,0] op_sel_hi:[1,0,1]
  v_pk_mul_f32 v[116:117], v[116:117], v[16:17] op_sel:[0,1] op_sel_hi:[1,1]
  v_pk_mul_f32 v[118:119], v[118:119], v[16:17] op_sel:[0,1] op_sel_hi:[1,1]
  v_cvt_pk_bf16_f32 v58, v116, v117
  v_cvt_pk_bf16_f32 v59, v118, v119
  v_pk_max_i16 v56, v56, 0
  v_pk_max_i16 v57, v57, 0
  v_pk_max_i16 v58, v58, 0
  v_pk_max_i16 v59, v59, 0
  buffer_store_dwordx4 v[56:59], v3, s[16:19], s37 offen offset:0 sc1
  ds_write_b128 v9, v[56:59] offset:0
  v_pk_fma_f32 v[144:145], v[24:25], v[18:19], v[144:145] op_sel:[0,0,0] op_sel_hi:[1,0,1]
  v_pk_fma_f32 v[146:147], v[26:27], v[18:19], v[146:147] op_sel:[0,0,0] op_sel_hi:[1,0,1]
  v_pk_mul_f32 v[144:145], v[144:145], v[18:19] op_sel:[0,1] op_sel_hi:[1,1]
  v_pk_mul_f32 v[146:147], v[146:147], v[18:19] op_sel:[0,1] op_sel_hi:[1,1]
  v_cvt_pk_bf16_f32 v60, v144, v145
  v_cvt_pk_bf16_f32 v61, v146, v147
  v_pk_fma_f32 v[148:149], v[28:29], v[18:19], v[148:149] op_sel:[0,0,0] op_sel_hi:[1,0,1]
  v_pk_fma_f32 v[150:151], v[30:31], v[18:19], v[150:151] op_sel:[0,0,0] op_sel_hi:[1,0,1]
  v_pk_mul_f32 v[148:149], v[148:149], v[18:19] op_sel:[0,1] op_sel_hi:[1,1]
  v_pk_mul_f32 v[150:151], v[150:151], v[18:19] op_sel:[0,1] op_sel_hi:[1,1]
  v_cvt_pk_bf16_f32 v62, v148, v149
  v_cvt_pk_bf16_f32 v63, v150, v151
  v_pk_max_i16 v60, v60, 0
  v_pk_max_i16 v61, v61, 0
  v_pk_max_i16 v62, v62, 0
  v_pk_max_i16 v63, v63, 0
  buffer_store_dwordx4 v[60:63], v3, s[16:19], s37 offen offset:1024 sc1
  ds_write_b128 v9, v[60:63] offset:1024
  v_pk_fma_f32 v[176:177], v[24:25], v[20:21], v[176:177] op_sel:[0,0,0] op_sel_hi:[1,0,1]
  v_pk_fma_f32 v[178:179], v[26:27], v[20:21], v[178:179] op_sel:[0,0,0] op_sel_hi:[1,0,1]
  v_pk_mul_f32 v[176:177], v[176:177], v[20:21] op_sel:[0,1] op_sel_hi:[1,1]
  v_pk_mul_f32 v[178:179], v[178:179], v[20:21] op_sel:[0,1] op_sel_hi:[1,1]
  v_cvt_pk_bf16_f32 v64, v176, v177
  v_cvt_pk_bf16_f32 v65, v178, v179
  v_pk_fma_f32 v[180:181], v[28:29], v[20:21], v[180:181] op_sel:[0,0,0] op_sel_hi:[1,0,1]
  v_pk_fma_f32 v[182:183], v[30:31], v[20:21], v[182:183] op_sel:[0,0,0] op_sel_hi:[1,0,1]
  v_pk_mul_f32 v[180:181], v[180:181], v[20:21] op_sel:[0,1] op_sel_hi:[1,1]
  v_pk_mul_f32 v[182:183], v[182:183], v[20:21] op_sel:[0,1] op_sel_hi:[1,1]
  v_cvt_pk_bf16_f32 v66, v180, v181
  v_cvt_pk_bf16_f32 v67, v182, v183
  v_pk_max_i16 v64, v64, 0
  v_pk_max_i16 v65, v65, 0
  v_pk_max_i16 v66, v66, 0
  v_pk_max_i16 v67, v67, 0
  buffer_store_dwordx4 v[64:67], v14, s[16:19], s37 offen offset:0 sc1
  ds_write_b128 v10, v[64:67] offset:0
  v_pk_fma_f32 v[200:201], v[24:25], v[22:23], v[200:201] op_sel:[0,0,0] op_sel_hi:[1,0,1]
  v_pk_fma_f32 v[202:203], v[26:27], v[22:23], v[202:203] op_sel:[0,0,0] op_sel_hi:[1,0,1]
  v_pk_mul_f32 v[200:201], v[200:201], v[22:23] op_sel:[0,1] op_sel_hi:[1,1]
  v_pk_mul_f32 v[202:203], v[202:203], v[22:23] op_sel:[0,1] op_sel_hi:[1,1]
  v_cvt_pk_bf16_f32 v68, v200, v201
  v_cvt_pk_bf16_f32 v69, v202, v203
  v_pk_fma_f32 v[204:205], v[28:29], v[22:23], v[204:205] op_sel:[0,0,0] op_sel_hi:[1,0,1]
  v_pk_fma_f32 v[206:207], v[30:31], v[22:23], v[206:207] op_sel:[0,0,0] op_sel_hi:[1,0,1]
  v_pk_mul_f32 v[204:205], v[204:205], v[22:23] op_sel:[0,1] op_sel_hi:[1,1]
  v_pk_mul_f32 v[206:207], v[206:207], v[22:23] op_sel:[0,1] op_sel_hi:[1,1]
  v_cvt_pk_bf16_f32 v70, v204, v205
  v_cvt_pk_bf16_f32 v71, v206, v207
  v_pk_max_i16 v68, v68, 0
  v_pk_max_i16 v69, v69, 0
  v_pk_max_i16 v70, v70, 0
  v_pk_max_i16 v71, v71, 0
  buffer_store_dwordx4 v[68:71], v14, s[16:19], s37 offen offset:1024 sc1
  ds_write_b128 v10, v[68:71] offset:1024
  s_add_u32 s37, s37, 16384
  v_pk_fma_f32 v[120:121], v[32:33], v[16:17], v[120:121] op_sel:[0,0,0] op_sel_hi:[1,0,1]
  v_pk_fma_f32 v[122:123], v[34:35], v[16:17], v[122:123] op_sel:[0,0,0] op_sel_hi:[1,0,1]
  v_pk_mul_f32 v[120:121], v[120:121], v[16:17] op_sel:[0,1] op_sel_hi:[1,1]
  v_pk_mul_f32 v[122:123], v[122:123], v[16:17] op_sel:[0,1] op_sel_hi:[1,1]
  v_cvt_pk_bf16_f32 v56, v120, v121
  v_cvt_pk_bf16_f32 v57, v122, v123
  v_pk_fma_f32 v[124:125], v[36:37], v[16:17], v[124:125] op_sel:[0,0,0] op_sel_hi:[1,0,1]
  v_pk_fma_f32 v[126:127], v[38:39], v[16:17], v[126:127] op_sel:[0,0,0] op_sel_hi:[1,0,1]
  v_pk_mul_f32 v[124:125], v[124:125], v[16:17] op_sel:[0,1] op_sel_hi:[1,1]
  v_pk_mul_f32 v[126:127], v[126:127], v[16:17] op_sel:[0,1] op_sel_hi:[1,1]
  v_cvt_pk_bf16_f32 v58, v124, v125
  v_cvt_pk_bf16_f32 v59, v126, v127
  v_pk_max_i16 v56, v56, 0
  v_pk_max_i16 v57, v57, 0
  v_pk_max_i16 v58, v58, 0
  v_pk_max_i16 v59, v59, 0
  buffer_store_dwordx4 v[56:59], v3, s[16:19], s37 offen offset:0 sc1
  ds_write_b128 v9, v[56:59] offset:16384
  v_pk_fma_f32 v[152:153], v[32:33], v[18:19], v[152:153] op_sel:[0,0,0] op_sel_hi:[1,0,1]
  v_pk_fma_f32 v[154:155], v[34:35], v[18:19], v[154:155] op_sel:[0,0,0] op_sel_hi:[1,0,1]
  v_pk_mul_f32 v[152:153], v[152:153], v[18:19] op_sel:[0,1] op_sel_hi:[1,1]
  v_pk_mul_f32 v[154:155], v[154:155], v[18:19] op_sel:[0,1] op_sel_hi:[1,1]
  v_cvt_pk_bf16_f32 v60, v152, v153
  v_cvt_pk_bf16_f32 v61, v154, v155
  v_pk_fma_f32 v[156:157], v[36:37], v[18:19], v[156:157] op_sel:[0,0,0] op_sel_hi:[1,0,1]
  v_pk_fma_f32 v[158:159], v[38:39], v[18:19], v[158:159] op_sel:[0,0,0] op_sel_hi:[1,0,1]
  v_pk_mul_f32 v[156:157], v[156:157], v[18:19] op_sel:[0,1] op_sel_hi:[1,1]
  v_pk_mul_f32 v[158:159], v[158:159], v[18:19] op_sel:[0,1] op_sel_hi:[1,1]
  v_cvt_pk_bf16_f32 v62, v156, v157
  v_cvt_pk_bf16_f32 v63, v158, v159
  v_pk_max_i16 v60, v60, 0
  v_pk_max_i16 v61, v61, 0
  v_pk_max_i16 v62, v62, 0
  v_pk_max_i16 v63, v63, 0
  buffer_store_dwordx4 v[60:63], v3, s[16:19], s37 offen offset:1024 sc1
  ds_write_b128 v9, v[60:63] offset:17408
  v_pk_fma_f32 v[184:185], v[32:33], v[20:21], v[184:185] op_sel:[0,0,0] op_sel_hi:[1,0,1]
  v_pk_fma_f32 v[186:187], v[34:35], v[20:21], v[186:187] op_sel:[0,0,0] op_sel_hi:[1,0,1]
  v_pk_mul_f32 v[184:185], v[184:185], v[20:21] op_sel:[0,1] op_sel_hi:[1,1]
  v_pk_mul_f32 v[186:187], v[186:187], v[20:21] op_sel:[0,1] op_sel_hi:[1,1]
  v_cvt_pk_bf16_f32 v64, v184, v185
  v_cvt_pk_bf16_f32 v65, v186, v187
  v_pk_fma_f32 v[188:189], v[36:37], v[20:21], v[188:189] op_sel:[0,0,0] op_sel_hi:[1,0,1]
  v_pk_fma_f32 v[190:191], v[38:39], v[20:21], v[190:191] op_sel:[0,0,0] op_sel_hi:[1,0,1]
  v_pk_mul_f32 v[188:189], v[188:189], v[20:21] op_sel:[0,1] op_sel_hi:[1,1]
  v_pk_mul_f32 v[190:191], v[190:191], v[20:21] op_sel:[0,1] op_sel_hi:[1,1]
  v_cvt_pk_bf16_f32 v66, v188, v189
  v_cvt_pk_bf16_f32 v67, v190, v191
  v_pk_max_i16 v64, v64, 0
  v_pk_max_i16 v65, v65, 0
  v_pk_max_i16 v66, v66, 0
  v_pk_max_i16 v67, v67, 0
  buffer_store_dwordx4 v[64:67], v14, s[16:19], s37 offen offset:0 sc1
  ds_write_b128 v10, v[64:67] offset:16384
  v_pk_fma_f32 v[208:209], v[32:33], v[22:23], v[208:209] op_sel:[0,0,0] op_sel_hi:[1,0,1]
  v_pk_fma_f32 v[210:211], v[34:35], v[22:23], v[210:211] op_sel:[0,0,0] op_sel_hi:[1,0,1]
  v_pk_mul_f32 v[208:209], v[208:209], v[22:23] op_sel:[0,1] op_sel_hi:[1,1]
  v_pk_mul_f32 v[210:211], v[210:211], v[22:23] op_sel:[0,1] op_sel_hi:[1,1]
  v_cvt_pk_bf16_f32 v68, v208, v209
  v_cvt_pk_bf16_f32 v69, v210, v211
  v_pk_fma_f32 v[212:213], v[36:37], v[22:23], v[212:213] op_sel:[0,0,0] op_sel_hi:[1,0,1]
  v_pk_fma_f32 v[214:215], v[38:39], v[22:23], v[214:215] op_sel:[0,0,0] op_sel_hi:[1,0,1]
  v_pk_mul_f32 v[212:213], v[212:213], v[22:23] op_sel:[0,1] op_sel_hi:[1,1]
  v_pk_mul_f32 v[214:215], v[214:215], v[22:23] op_sel:[0,1] op_sel_hi:[1,1]
  v_cvt_pk_bf16_f32 v70, v212, v213
  v_cvt_pk_bf16_f32 v71, v214, v215
  v_pk_max_i16 v68, v68, 0
  v_pk_max_i16 v69, v69, 0
  v_pk_max_i16 v70, v70, 0
  v_pk_max_i16 v71, v71, 0
  buffer_store_dwordx4 v[68:71], v14, s[16:19], s37 offen offset:1024 sc1
  ds_write_b128 v10, v[68:71] offset:17408
  s_add_u32 s37, s37, 16384
  v_pk_fma_f32 v[128:129], v[40:41], v[16:17], v[128:129] op_sel:[0,0,0] op_sel_hi:[1,0,1]
  v_pk_fma_f32 v[130:131], v[42:43], v[16:17], v[130:131] op_sel:[0,0,0] op_sel_hi:[1,0,1]
  v_pk_mul_f32 v[128:129], v[128:129], v[16:17] op_sel:[0,1] op_sel_hi:[1,1]
  v_pk_mul_f32 v[130:131], v[130:131], v[16:17] op_sel:[0,1] op_sel_hi:[1,1]
  v_cvt_pk_bf16_f32 v56, v128, v129
  v_cvt_pk_bf16_f32 v57, v130, v131
  v_pk_fma_f32 v[132:133], v[44:45], v[16:17], v[132:133] op_sel:[0,0,0] op_sel_hi:[1,0,1]
  v_pk_fma_f32 v[134:135], v[46:47], v[16:17], v[134:135] op_sel:[0,0,0] op_sel_hi:[1,0,1]
  v_pk_mul_f32 v[132:133], v[132:133], v[16:17] op_sel:[0,1] op_sel_hi:[1,1]
  v_pk_mul_f32 v[134:135], v[134:135], v[16:17] op_sel:[0,1] op_sel_hi:[1,1]
  v_cvt_pk_bf16_f32 v58, v132, v133
  v_cvt_pk_bf16_f32 v59, v134, v135
  v_pk_max_i16 v56, v56, 0
  v_pk_max_i16 v57, v57, 0
  v_pk_max_i16 v58, v58, 0
  v_pk_max_i16 v59, v59, 0
  buffer_store_dwordx4 v[56:59], v3, s[16:19], s37 offen offset:0 sc1
  ds_write_b128 v9, v[56:59] offset:32768
  v_pk_fma_f32 v[160:161], v[40:41], v[18:19], v[160:161] op_sel:[0,0,0] op_sel_hi:[1,0,1]
  v_pk_fma_f32 v[162:163], v[42:43], v[18:19], v[162:163] op_sel:[0,0,0] op_sel_hi:[1,0,1]
  v_pk_mul_f32 v[160:161], v[160:161], v[18:19] op_sel:[0,1] op_sel_hi:[1,1]
  v_pk_mul_f32 v[162:163], v[162:163], v[18:19] op_sel:[0,1] op_sel_hi:[1,1]
  v_cvt_pk_bf16_f32 v60, v160, v161
  v_cvt_pk_bf16_f32 v61, v162, v163
  v_pk_fma_f32 v[164:165], v[44:45], v[18:19], v[164:165] op_sel:[0,0,0] op_sel_hi:[1,0,1]
  v_pk_fma_f32 v[166:167], v[46:47], v[18:19], v[166:167] op_sel:[0,0,0] op_sel_hi:[1,0,1]
  v_pk_mul_f32 v[164:165], v[164:165], v[18:19] op_sel:[0,1] op_sel_hi:[1,1]
  v_pk_mul_f32 v[166:167], v[166:167], v[18:19] op_sel:[0,1] op_sel_hi:[1,1]
  v_cvt_pk_bf16_f32 v62, v164, v165
  v_cvt_pk_bf16_f32 v63, v166, v167
  v_pk_max_i16 v60, v60, 0
  v_pk_max_i16 v61, v61, 0
  v_pk_max_i16 v62, v62, 0
  v_pk_max_i16 v63, v63, 0
  buffer_store_dwordx4 v[60:63], v3, s[16:19], s37 offen offset:1024 sc1
  ds_write_b128 v9, v[60:63] offset:33792
  v_pk_fma_f32 v[192:193], v[40:41], v[20:21], v[192:193] op_sel:[0,0,0] op_sel_hi:[1,0,1]
  v_pk_fma_f32 v[194:195], v[42:43], v[20:21], v[194:195] op_sel:[0,0,0] op_sel_hi:[1,0,1]
  v_pk_mul_f32 v[192:193], v[192:193], v[20:21] op_sel:[0,1] op_sel_hi:[1,1]
  v_pk_mul_f32 v[194:195], v[194:195], v[20:21] op_sel:[0,1] op_sel_hi:[1,1]
  v_cvt_pk_bf16_f32 v64, v192, v193
  v_cvt_pk_bf16_f32 v65, v194, v195
  v_pk_fma_f32 v[196:197], v[44:45], v[20:21], v[196:197] op_sel:[0,0,0] op_sel_hi:[1,0,1]
  v_pk_fma_f32 v[198:199], v[46:47], v[20:21], v[198:199] op_sel:[0,0,0] op_sel_hi:[1,0,1]
  v_pk_mul_f32 v[196:197], v[196:197], v[20:21] op_sel:[0,1] op_sel_hi:[1,1]
  v_pk_mul_f32 v[198:199], v[198:199], v[20:21] op_sel:[0,1] op_sel_hi:[1,1]
  v_cvt_pk_bf16_f32 v66, v196, v197
  v_cvt_pk_bf16_f32 v67, v198, v199
  v_pk_max_i16 v64, v64, 0
  v_pk_max_i16 v65, v65, 0
  v_pk_max_i16 v66, v66, 0
  v_pk_max_i16 v67, v67, 0
  buffer_store_dwordx4 v[64:67], v14, s[16:19], s37 offen offset:0 sc1
  ds_write_b128 v10, v[64:67] offset:32768
  v_pk_fma_f32 v[216:217], v[40:41], v[22:23], v[216:217] op_sel:[0,0,0] op_sel_hi:[1,0,1]
  v_pk_fma_f32 v[218:219], v[42:43], v[22:23], v[218:219] op_sel:[0,0,0] op_sel_hi:[1,0,1]
  v_pk_mul_f32 v[216:217], v[216:217], v[22:23] op_sel:[0,1] op_sel_hi:[1,1]
  v_pk_mul_f32 v[218:219], v[218:219], v[22:23] op_sel:[0,1] op_sel_hi:[1,1]
  v_cvt_pk_bf16_f32 v68, v216, v217
  v_cvt_pk_bf16_f32 v69, v218, v219
  v_pk_fma_f32 v[220:221], v[44:45], v[22:23], v[220:221] op_sel:[0,0,0] op_sel_hi:[1,0,1]
  v_pk_fma_f32 v[222:223], v[46:47], v[22:23], v[222:223] op_sel:[0,0,0] op_sel_hi:[1,0,1]
  v_pk_mul_f32 v[220:221], v[220:221], v[22:23] op_sel:[0,1] op_sel_hi:[1,1]
  v_pk_mul_f32 v[222:223], v[222:223], v[22:23] op_sel:[0,1] op_sel_hi:[1,1]
  v_cvt_pk_bf16_f32 v70, v220, v221
  v_cvt_pk_bf16_f32 v71, v222, v223
  v_pk_max_i16 v68, v68, 0
  v_pk_max_i16 v69, v69, 0
  v_pk_max_i16 v70, v70, 0
  v_pk_max_i16 v71, v71, 0
  buffer_store_dwordx4 v[68:71], v14, s[16:19], s37 offen offset:1024 sc1
  ds_write_b128 v10, v[68:71] offset:33792
  v_pk_fma_f32 v[136:137], v[48:49], v[16:17], v[136:137] op_sel:[0,0,0] op_sel_hi:[1,0,1]
  v_pk_fma_f32 v[138:139], v[50:51], v[16:17], v[138:139] op_sel:[0,0,0] op_sel_hi:[1,0,1]
  v_pk_mul_f32 v[136:137], v[136:137], v[16:17] op_sel:[0,1] op_sel_hi:[1,1]
  v_pk_mul_f32 v[138:139], v[138:139], v[16:17] op_sel:[0,1] op_sel_hi:[1,1]
  v_cvt_pk_bf16_f32 v56, v136, v137
  v_cvt_pk_bf16_f32 v57, v138, v139
  v_pk_fma_f32 v[140:141], v[52:53], v[16:17], v[140:141] op_sel:[0,0,0] op_sel_hi:[1,0,1]
  v_pk_fma_f32 v[142:143], v[54:55], v[16:17], v[142:143] op_sel:[0,0,0] op_sel_hi:[1,0,1]
  v_pk_mul_f32 v[140:141], v[140:141], v[16:17] op_sel:[0,1] op_sel_hi:[1,1]
  v_pk_mul_f32 v[142:143], v[142:143], v[16:17] op_sel:[0,1] op_sel_hi:[1,1]
  v_cvt_pk_bf16_f32 v58, v140, v141
  v_cvt_pk_bf16_f32 v59, v142, v143
  v_pk_max_i16 v56, v56, 0
  v_pk_max_i16 v57, v57, 0
  v_pk_max_i16 v58, v58, 0
  v_pk_max_i16 v59, v59, 0
  buffer_store_dwordx4 v[56:59], v3, s[16:19], s38 offen offset:0 sc1
  ds_write_b128 v11, v[56:59] offset:49152
  v_pk_fma_f32 v[168:169], v[48:49], v[18:19], v[168:169] op_sel:[0,0,0] op_sel_hi:[1,0,1]
  v_pk_fma_f32 v[170:171], v[50:51], v[18:19], v[170:171] op_sel:[0,0,0] op_sel_hi:[1,0,1]
  v_pk_mul_f32 v[168:169], v[168:169], v[18:19] op_sel:[0,1] op_sel_hi:[1,1]
  v_pk_mul_f32 v[170:171], v[170:171], v[18:19] op_sel:[0,1] op_sel_hi:[1,1]
  v_cvt_pk_bf16_f32 v60, v168, v169
  v_cvt_pk_bf16_f32 v61, v170, v171
  v_pk_fma_f32 v[172:173], v[52:53], v[18:19], v[172:173] op_sel:[0,0,0] op_sel_hi:[1,0,1]
  v_pk_fma_f32 v[174:175], v[54:55], v[18:19], v[174:175] op_sel:[0,0,0] op_sel_hi:[1,0,1]
  v_pk_mul_f32 v[172:173], v[172:173], v[18:19] op_sel:[0,1] op_sel_hi:[1,1]
  v_pk_mul_f32 v[174:175], v[174:175], v[18:19] op_sel:[0,1] op_sel_hi:[1,1]
  v_cvt_pk_bf16_f32 v62, v172, v173
  v_cvt_pk_bf16_f32 v63, v174, v175
  v_pk_max_i16 v60, v60, 0
  v_pk_max_i16 v61, v61, 0
  v_pk_max_i16 v62, v62, 0
  v_pk_max_i16 v63, v63, 0
  buffer_store_dwordx4 v[60:63], v3, s[16:19], s38 offen offset:1024 sc1
  ds_write_b128 v11, v[60:63] offset:50176
  v_lshlrev_b32 v8, 4, v0
  v_and_b32 v1, 15, v0
  v_lshrrev_b32 v2, 4, v0
  v_add_u32 v9, 90112, v8
  s_lshl_b32 s34, s3, 11
  v_add_u32 v10, s34, v8
  s_mul_i32 s35, s26, 917504
  s_add_u32 s35, s35, s34
  s_add_u32 s35, s35, s6
  s_add_u32 s35, s35, 30408704
  s_and_b32 s48, s27, 7
  s_lshr_b32 s49, s27, 3
  s_mul_i32 s49, s49, 56
  s_mul_i32 s41, s48, 7
  s_add_u32 s41, s41, s49
  s_add_u32 s42, s41, 7
  s_cmp_le_u32 s48, 5
  s_cselect_b32 s40, 0, 10
  s_cselect_b32 s44, 46, 0
  s_add_u32 s40, s40, s49
  s_add_u32 s43, s40, 46
  s_mul_i32 s40, s40, 8192
  s_add_u32 s40, s40, s35
  s_mul_i32 s41, s41, 8192
  s_add_u32 s41, s41, s35
  s_mul_i32 s42, s42, 8192
  s_add_u32 s42, s42, s35
  s_mul_i32 s43, s43, 8192
  s_add_u32 s43, s43, s35
  s_mul_i32 s44, s44, 8192
  s_add_u32 s44, s44, s35
  s_cmp_eq_u32 s40, s41
  s_cselect_b32 s40, s42, s40
  s_lshl_b32 s36, s26, 18
  s_add_u32 s36, s36, s34
  s_add_u32 s36, s36, s6
  s_lshl_b32 s37, s27, 14
  s_add_u32 s36, s36, s37
  s_cmp_eq_u32 s10, 0
  s_cselect_b32 s38, 0, 8388608
  s_add_u32 s38, s38, 138412032
  s_lshl_b32 s39, s26, 19
  s_add_u32 s38, s38, s39
  s_lshl_b32 s39, s3, 13
  s_add_u32 s38, s38, s39
  s_lshl_b32 s39, s27, 15
  s_add_u32 s39, s39, s38
  s_xor_b32 s38, s39, 262144
  s_waitcnt lgkmcnt(0)
  s_barrier
  ds_read_b128 v[16:19], v10 offset:0
  ds_read_b128 v[20:23], v10 offset:1024
  ds_read_b128 v[80:83], v9 offset:0
  ds_read_b128 v[84:87], v9 offset:1024
  ds_read_b128 v[88:91], v9 offset:2048
  ds_read_b128 v[92:95], v9 offset:3072
  ds_read_b128 v[96:99], v9 offset:4096
  ds_read_b128 v[100:103], v9 offset:5120
  ds_read_b128 v[104:107], v9 offset:6144
  ds_read_b128 v[108:111], v9 offset:7168
  ds_read_b128 v[24:27], v10 offset:8192
  ds_read_b128 v[28:31], v10 offset:9216
  ds_read_b128 v[32:35], v10 offset:16384
  ds_read_b128 v[36:39], v10 offset:17408
  ds_read_b128 v[40:43], v10 offset:24576
  ds_read_b128 v[44:47], v10 offset:25600
  ds_read_b128 v[48:51], v10 offset:32768
  ds_read_b128 v[52:55], v10 offset:33792
  ds_read_b128 v[56:59], v10 offset:40960
  ds_read_b128 v[60:63], v10 offset:41984
  ds_read_b128 v[64:67], v10 offset:49152
  ds_read_b128 v[68:71], v10 offset:50176
  s_waitcnt lgkmcnt(0)
  v_mfma_f32_16x16x32_bf16 v[144:147], v[80:83], v[16:19], 0
  ds_read_b128 v[112:115], v9 offset:8192
  v_mfma_f32_16x16x32_bf16 v[160:163], v[80:83], v[20:23], 0
  ds_read_b128 v[116:119], v9 offset:9216
  v_mfma_f32_16x16x32_bf16 v[148:151], v[84:87], v[16:19], 0
  ds_read_b128 v[120:123], v9 offset:10240
  v_mfma_f32_16x16x32_bf16 v[164:167], v[84:87], v[20:23], 0
  ds_read_b128 v[124:127], v9 offset:11264
  v_mfma_f32_16x16x32_bf16 v[152:155], v[88:91], v[16:19], 0
  ds_read_b128 v[128:131], v9 offset:12288
  v_mfma_f32_16x16x32_bf16 v[168:171], v[88:91], v[20:23], 0
  ds_read_b128 v[132:135], v9 offset:13312
  v_mfma_f32_16x16x32_bf16 v[156:159], v[92:95], v[16:19], 0
  ds_read_b128 v[136:139], v9 offset:14336
  v_mfma_f32_16x16x32_bf16 v[172:175], v[92:95], v[20:23], 0
  ds_read_b128 v[140:143], v9 offset:15360
  v_mfma_f32_16x16x32_bf16 v[176:179], v[96:99], v[16:19], 0
  v_mfma_f32_16x16x32_bf16 v[192:195], v[96:99], v[20:23], 0
  v_mfma_f32_16x16x32_bf16 v[180:183], v[100:103], v[16:19], 0
  v_mfma_f32_16x16x32_bf16 v[196:199], v[100:103], v[20:23], 0
  v_mfma_f32_16x16x32_bf16 v[184:187], v[104:107], v[16:19], 0
  v_mfma_f32_16x16x32_bf16 v[200:203], v[104:107], v[20:23], 0
  v_mfma_f32_16x16x32_bf16 v[188:191], v[108:111], v[16:19], 0
  v_mfma_f32_16x16x32_bf16 v[204:207], v[108:111], v[20:23], 0
  s_waitcnt lgkmcnt(0)
  v_mfma_f32_16x16x32_bf16 v[144:147], v[112:115], v[24:27], v[144:147]
  ds_read_b128 v[80:83], v9 offset:16384
  v_mfma_f32_16x16x32_bf16 v[160:163], v[112:115], v[28:31], v[160:163]
  ds_read_b128 v[84:87], v9 offset:17408
  v_mfma_f32_16x16x32_bf16 v[148:151], v[116:119], v[24:27], v[148:151]
  ds_read_b128 v[88:91], v9 offset:18432
  v_mfma_f32_16x16x32_bf16 v[164:167], v[116:119], v[28:31], v[164:167]
  ds_read_b128 v[92:95], v9 offset:19456
  v_mfma_f32_16x16x32_bf16 v[152:155], v[120:123], v[24:27], v[152:155]
  ds_read_b128 v[96:99], v9 offset:20480
  v_mfma_f32_16x16x32_bf16 v[168:171], v[120:123], v[28:31], v[168:171]
  ds_read_b128 v[100:103], v9 offset:21504
  v_mfma_f32_16x16x32_bf16 v[156:159], v[124:127], v[24:27], v[156:159]
  ds_read_b128 v[104:107], v9 offset:22528
  v_mfma_f32_16x16x32_bf16 v[172:175], v[124:127], v[28:31], v[172:175]
  ds_read_b128 v[108:111], v9 offset:23552
  v_mfma_f32_16x16x32_bf16 v[176:179], v[128:131], v[24:27], v[176:179]
  v_mfma_f32_16x16x32_bf16 v[192:195], v[128:131], v[28:31], v[192:195]
  v_mfma_f32_16x16x32_bf16 v[180:183], v[132:135], v[24:27], v[180:183]
  v_mfma_f32_16x16x32_bf16 v[196:199], v[132:135], v[28:31], v[196:199]
  v_mfma_f32_16x16x32_bf16 v[184:187], v[136:139], v[24:27], v[184:187]
  v_mfma_f32_16x16x32_bf16 v[200:203], v[136:139], v[28:31], v[200:203]
  v_mfma_f32_16x16x32_bf16 v[188:191], v[140:143], v[24:27], v[188:191]
  v_mfma_f32_16x16x32_bf16 v[204:207], v[140:143], v[28:31], v[204:207]
  s_waitcnt lgkmcnt(0)
  v_mfma_f32_16x16x32_bf16 v[144:147], v[80:83], v[32:35], v[144:147]
  ds_read_b128 v[112:115], v9 offset:24576
  v_mfma_f32_16x16x32_bf16 v[160:163], v[80:83], v[36:39], v[160:163]
  ds_read_b128 v[116:119], v9 offset:25600
  v_mfma_f32_16x16x32_bf16 v[148:151], v[84:87], v[32:35], v[148:151]
  ds_read_b128 v[120:123], v9 offset:26624
  v_mfma_f32_16x16x32_bf16 v[164:167], v[84:87], v[36:39], v[164:167]
  ds_read_b128 v[124:127], v9 offset:27648
  v_mfma_f32_16x16x32_bf16 v[152:155], v[88:91], v[32:35], v[152:155]
  ds_read_b128 v[128:131], v9 offset:28672
  v_mfma_f32_16x16x32_bf16 v[168:171], v[88:91], v[36:39], v[168:171]
  ds_read_b128 v[132:135], v9 offset:29696
  v_mfma_f32_16x16x32_bf16 v[156:159], v[92:95], v[32:35], v[156:159]
  ds_read_b128 v[136:139], v9 offset:30720
  v_mfma_f32_16x16x32_bf16 v[172:175], v[92:95], v[36:39], v[172:175]
  ds_read_b128 v[140:143], v9 offset:31744
  v_mfma_f32_16x16x32_bf16 v[176:179], v[96:99], v[32:35], v[176:179]
  v_mfma_f32_16x16x32_bf16 v[192:195], v[96:99], v[36:39], v[192:195]
  v_mfma_f32_16x16x32_bf16 v[180:183], v[100:103], v[32:35], v[180:183]
  v_mfma_f32_16x16x32_bf16 v[196:199], v[100:103], v[36:39], v[196:199]
  v_mfma_f32_16x16x32_bf16 v[184:187], v[104:107], v[32:35], v[184:187]
  v_mfma_f32_16x16x32_bf16 v[200:203], v[104:107], v[36:39], v[200:203]
  v_mfma_f32_16x16x32_bf16 v[188:191], v[108:111], v[32:35], v[188:191]
  v_mfma_f32_16x16x32_bf16 v[204:207], v[108:111], v[36:39], v[204:207]
  s_waitcnt lgkmcnt(0)
  s_waitcnt vmcnt(0)
  s_barrier
  v_mfma_f32_16x16x32_bf16 v[144:147], v[112:115], v[40:43], v[144:147]
  ds_read_b128 v[80:83], v9 offset:32768
  v_mfma_f32_16x16x32_bf16 v[160:163], v[112:115], v[44:47], v[160:163]
  ds_read_b128 v[84:87], v9 offset:33792
  v_mfma_f32_16x16x32_bf16 v[148:151], v[116:119], v[40:43], v[148:151]
  ds_read_b128 v[88:91], v9 offset:34816
  v_mfma_f32_16x16x32_bf16 v[164:167], v[116:119], v[44:47], v[164:167]
  ds_read_b128 v[92:95], v9 offset:35840
  v_mfma_f32_16x16x32_bf16 v[152:155], v[120:123], v[40:43], v[152:155]
  ds_read_b128 v[96:99], v9 offset:36864
  v_mfma_f32_16x16x32_bf16 v[168:171], v[120:123], v[44:47], v[168:171]
  ds_read_b128 v[100:103], v9 offset:37888
  v_mfma_f32_16x16x32_bf16 v[156:159], v[124:127], v[40:43], v[156:159]
  ds_read_b128 v[104:107], v9 offset:38912
  v_mfma_f32_16x16x32_bf16 v[172:175], v[124:127], v[44:47], v[172:175]
  ds_read_b128 v[108:111], v9 offset:39936
  v_mfma_f32_16x16x32_bf16 v[176:179], v[128:131], v[40:43], v[176:179]
  v_mfma_f32_16x16x32_bf16 v[192:195], v[128:131], v[44:47], v[192:195]
  v_mfma_f32_16x16x32_bf16 v[180:183], v[132:135], v[40:43], v[180:183]
  v_mfma_f32_16x16x32_bf16 v[196:199], v[132:135], v[44:47], v[196:199]
  v_mfma_f32_16x16x32_bf16 v[184:187], v[136:139], v[40:43], v[184:187]
  v_mfma_f32_16x16x32_bf16 v[200:203], v[136:139], v[44:47], v[200:203]
  v_mfma_f32_16x16x32_bf16 v[188:191], v[140:143], v[40:43], v[188:191]
  v_mfma_f32_16x16x32_bf16 v[204:207], v[140:143], v[44:47], v[204:207]
  s_waitcnt lgkmcnt(0)
  v_mfma_f32_16x16x32_bf16 v[144:147], v[80:83], v[48:51], v[144:147]
  ds_read_b128 v[112:115], v9 offset:40960
  v_mfma_f32_16x16x32_bf16 v[160:163], v[80:83], v[52:55], v[160:163]
  ds_read_b128 v[116:119], v9 offset:41984
  v_mfma_f32_16x16x32_bf16 v[148:151], v[84:87], v[48:51], v[148:151]
  ds_read_b128 v[120:123], v9 offset:43008
  v_mfma_f32_16x16x32_bf16 v[164:167], v[84:87], v[52:55], v[164:167]
  ds_read_b128 v[124:127], v9 offset:44032
  v_mfma_f32_16x16x32_bf16 v[152:155], v[88:91], v[48:51], v[152:155]
  ds_read_b128 v[128:131], v9 offset:45056
  v_mfma_f32_16x16x32_bf16 v[168:171], v[88:91], v[52:55], v[168:171]
  ds_read_b128 v[132:135], v9 offset:46080
  v_mfma_f32_16x16x32_bf16 v[156:159], v[92:95], v[48:51], v[156:159]
  ds_read_b128 v[136:139], v9 offset:47104
  v_mfma_f32_16x16x32_bf16 v[172:175], v[92:95], v[52:55], v[172:175]
  ds_read_b128 v[140:143], v9 offset:48128
  v_mfma_f32_16x16x32_bf16 v[176:179], v[96:99], v[48:51], v[176:179]
  v_mfma_f32_16x16x32_bf16 v[192:195], v[96:99], v[52:55], v[192:195]
  v_mfma_f32_16x16x32_bf16 v[180:183], v[100:103], v[48:51], v[180:183]
  v_mfma_f32_16x16x32_bf16 v[196:199], v[100:103], v[52:55], v[196:199]
  v_mfma_f32_16x16x32_bf16 v[184:187], v[104:107], v[48:51], v[184:187]
  v_mfma_f32_16x16x32_bf16 v[200:203], v[104:107], v[52:55], v[200:203]
  v_mfma_f32_16x16x32_bf16 v[188:191], v[108:111], v[48:51], v[188:191]
  v_mfma_f32_16x16x32_bf16 v[204:207], v[108:111], v[52:55], v[204:207]
  s_waitcnt lgkmcnt(0)
  v_mfma_f32_16x16x32_bf16 v[144:147], v[112:115], v[56:59], v[144:147]
  ds_read_b128 v[80:83], v9 offset:49152
  v_mfma_f32_16x16x32_bf16 v[160:163], v[112:115], v[60:63], v[160:163]
  ds_read_b128 v[84:87], v9 offset:50176
  v_mfma_f32_16x16x32_bf16 v[148:151], v[116:119], v[56:59], v[148:151]
  ds_read_b128 v[88:91], v9 offset:51200
  v_mfma_f32_16x16x32_bf16 v[164:167], v[116:119], v[60:63], v[164:167]
  ds_read_b128 v[92:95], v9 offset:52224
  v_mfma_f32_16x16x32_bf16 v[152:155], v[120:123], v[56:59], v[152:155]
  ds_read_b128 v[96:99], v9 offset:53248
  v_mfma_f32_16x16x32_bf16 v[168:171], v[120:123], v[60:63], v[168:171]
  ds_read_b128 v[100:103], v9 offset:54272
  v_mfma_f32_16x16x32_bf16 v[156:159], v[124:127], v[56:59], v[156:159]
  ds_read_b128 v[104:107], v9 offset:55296
  v_mfma_f32_16x16x32_bf16 v[172:175], v[124:127], v[60:63], v[172:175]
  ds_read_b128 v[108:111], v9 offset:56320
  v_mfma_f32_16x16x32_bf16 v[176:179], v[128:131], v[56:59], v[176:179]
  v_mfma_f32_16x16x32_bf16 v[192:195], v[128:131], v[60:63], v[192:195]
  v_mfma_f32_16x16x32_bf16 v[180:183], v[132:135], v[56:59], v[180:183]
  v_mfma_f32_16x16x32_bf16 v[196:199], v[132:135], v[60:63], v[196:199]
  v_mfma_f32_16x16x32_bf16 v[184:187], v[136:139], v[56:59], v[184:187]
  v_mfma_f32_16x16x32_bf16 v[200:203], v[136:139], v[60:63], v[200:203]
  v_mfma_f32_16x16x32_bf16 v[188:191], v[140:143], v[56:59], v[188:191]
  v_mfma_f32_16x16x32_bf16 v[204:207], v[140:143], v[60:63], v[204:207]
  s_add_u32 s37, s36, 25165824
  s_add_u32 s45, s37, 8192
  buffer_load_dwordx4 v[208:211], v8, s[16:19], s37 offen offset:0 sc1
  buffer_load_dwordx4 v[212:215], v8, s[16:19], s37 offen offset:1024 sc1
  buffer_load_dwordx4 v[216:219], v8, s[16:19], s45 offen offset:0 sc1
  buffer_load_dwordx4 v[220:223], v8, s[16:19], s45 offen offset:1024 sc1
  s_waitcnt lgkmcnt(0)
  s_barrier
  buffer_load_dwordx4 v[72:75], v8, s[16:19], s40 offen offset:0 sc1
  buffer_load_dwordx4 v[76:79], v8, s[16:19], s40 offen offset:1024 sc1
  s_add_u32 s40, s40, 8192
  s_cmp_eq_u32 s40, s41
  s_cselect_b32 s40, s42, s40
  s_cmp_eq_u32 s40, s43
  s_cselect_b32 s40, s44, s40
  buffer_load_dwordx4 v[16:19], v8, s[16:19], s40 offen offset:0 sc1
  buffer_load_dwordx4 v[20:23], v8, s[16:19], s40 offen offset:1024 sc1
  s_add_u32 s40, s40, 8192
  s_cmp_eq_u32 s40, s41
  s_cselect_b32 s40, s42, s40
  s_cmp_eq_u32 s40, s43
  s_cselect_b32 s40, s44, s40
  buffer_load_dwordx4 v[24:27], v8, s[16:19], s40 offen offset:0 sc1
  buffer_load_dwordx4 v[28:31], v8, s[16:19], s40 offen offset:1024 sc1
  s_add_u32 s40, s40, 8192
  s_cmp_eq_u32 s40, s41
  s_cselect_b32 s40, s42, s40
  s_cmp_eq_u32 s40, s43
  s_cselect_b32 s40, s44, s40
  buffer_load_dwordx4 v[32:35], v8, s[16:19], s40 offen offset:0 sc1
  buffer_load_dwordx4 v[36:39], v8, s[16:19], s40 offen offset:1024 sc1
  s_add_u32 s40, s40, 8192
  s_cmp_eq_u32 s40, s41
  s_cselect_b32 s40, s42, s40
  s_cmp_eq_u32 s40, s43
  s_cselect_b32 s40, s44, s40
  s_mov_b32 s45, 5
.p2align 6
w2_c1:
  s_waitcnt vmcnt(8) lgkmcnt(0)
  v_mfma_f32_16x16x32_bf16 v[144:147], v[80:83], v[64:67], v[144:147]
  ds_read_b128 v[112:115], v9 offset:57344
  v_mfma_f32_16x16x32_bf16 v[160:163], v[80:83], v[68:71], v[160:163]
  ds_read_b128 v[116:119], v9 offset:58368
  v_mfma_f32_16x16x32_bf16 v[148:151], v[84:87], v[64:67], v[148:151]
  ds_read_b128 v[120:123], v9 offset:59392
  v_mfma_f32_16x16x32_bf16 v[164:167], v[84:87], v[68:71], v[164:167]
  ds_read_b128 v[124:127], v9 offset:60416
  v_mfma_f32_16x16x32_bf16 v[152:155], v[88:91], v[64:67], v[152:155]
  ds_read_b128 v[128:131], v9 offset:61440
  v_mfma_f32_16x16x32_bf16 v[168:171], v[88:91], v[68:71], v[168:171]
  ds_read_b128 v[132:135], v9 offset:62464
  v_mfma_f32_16x16x32_bf16 v[156:159], v[92:95], v[64:67], v[156:159]
  ds_read_b128 v[136:139], v9 offset:63488
  v_mfma_f32_16x16x32_bf16 v[172:175], v[92:95], v[68:71], v[172:175]
  ds_read_b128 v[140:143], v9 offset:64512
  v_mfma_f32_16x16x32_bf16 v[176:179], v[96:99], v[64:67], v[176:179]
  buffer_load_dwordx4 v[40:43], v8, s[16:19], s40 offen offset:0 sc1
  v_mfma_f32_16x16x32_bf16 v[192:195], v[96:99], v[68:71], v[192:195]
  buffer_load_dwordx4 v[44:47], v8, s[16:19], s40 offen offset:1024 sc1
  v_mfma_f32_16x16x32_bf16 v[180:183], v[100:103], v[64:67], v[180:183]
  s_add_u32 s40, s40, 8192
  v_mfma_f32_16x16x32_bf16 v[196:199], v[100:103], v[68:71], v[196:199]
  s_cmp_eq_u32 s40, s41
  v_mfma_f32_16x16x32_bf16 v[184:187], v[104:107], v[64:67], v[184:187]
  s_cselect_b32 s40, s42, s40
  v_mfma_f32_16x16x32_bf16 v[200:203], v[104:107], v[68:71], v[200:203]
  s_cmp_eq_u32 s40, s43
  v_mfma_f32_16x16x32_bf16 v[188:191], v[108:111], v[64:67], v[188:191]
  s_cselect_b32 s40, s44, s40
  v_mfma_f32_16x16x32_bf16 v[204:207], v[108:111], v[68:71], v[204:207]
  s_waitcnt vmcnt(8) lgkmcnt(0)
  s_barrier
  v_mfma_f32_16x16x32_bf16 v[144:147], v[112:115], v[72:75], v[144:147]
  ds_read_b128 v[80:83], v9 offset:0
  v_mfma_f32_16x16x32_bf16 v[160:163], v[112:115], v[76:79], v[160:163]
  ds_read_b128 v[84:87], v9 offset:1024
  v_mfma_f32_16x16x32_bf16 v[148:151], v[116:119], v[72:75], v[148:151]
  ds_read_b128 v[88:91], v9 offset:2048
  v_mfma_f32_16x16x32_bf16 v[164:167], v[116:119], v[76:79], v[164:167]
  ds_read_b128 v[92:95], v9 offset:3072
  v_mfma_f32_16x16x32_bf16 v[152:155], v[120:123], v[72:75], v[152:155]
  ds_read_b128 v[96:99], v9 offset:4096
  v_mfma_f32_16x16x32_bf16 v[168:171], v[120:123], v[76:79], v[168:171]
  ds_read_b128 v[100:103], v9 offset:5120
  v_mfma_f32_16x16x32_bf16 v[156:159], v[124:127], v[72:75], v[156:159]
  ds_read_b128 v[104:107], v9 offset:6144
  v_mfma_f32_16x16x32_bf16 v[172:175], v[124:127], v[76:79], v[172:175]
  ds_read_b128 v[108:111], v9 offset:7168
  v_mfma_f32_16x16x32_bf16 v[176:179], v[128:131], v[72:75], v[176:179]
  buffer_load_dwordx4 v[48:51], v8, s[16:19], s40 offen offset:0 sc1
  v_mfma_f32_16x16x32_bf16 v[192:195], v[128:131], v[76:79], v[192:195]
  buffer_load_dwordx4 v[52:55], v8, s[16:19], s40 offen offset:1024 sc1
  v_mfma_f32_16x16x32_bf16 v[180:183], v[132:135], v[72:75], v[180:183]
  s_add_u32 s40, s40, 8192
  v_mfma_f32_16x16x32_bf16 v[196:199], v[132:135], v[76:79], v[196:199]
  s_cmp_eq_u32 s40, s41
  v_mfma_f32_16x16x32_bf16 v[184:187], v[136:139], v[72:75], v[184:187]
  s_cselect_b32 s40, s42, s40
  v_mfma_f32_16x16x32_bf16 v[200:203], v[136:139], v[76:79], v[200:203]
  s_cmp_eq_u32 s40, s43
  v_mfma_f32_16x16x32_bf16 v[188:191], v[140:143], v[72:75], v[188:191]
  s_cselect_b32 s40, s44, s40
  v_mfma_f32_16x16x32_bf16 v[204:207], v[140:143], v[76:79], v[204:207]
  s_waitcnt vmcnt(8) lgkmcnt(0)
  v_mfma_f32_16x16x32_bf16 v[144:147], v[80:83], v[16:19], v[144:147]
  ds_read_b128 v[112:115], v9 offset:8192
  v_mfma_f32_16x16x32_bf16 v[160:163], v[80:83], v[20:23], v[160:163]
  ds_read_b128 v[116:119], v9 offset:9216
  v_mfma_f32_16x16x32_bf16 v[148:151], v[84:87], v[16:19], v[148:151]
  ds_read_b128 v[120:123], v9 offset:10240
  v_mfma_f32_16x16x32_bf16 v[164:167], v[84:87], v[20:23], v[164:167]
  ds_read_b128 v[124:127], v9 offset:11264
  v_mfma_f32_16x16x32_bf16 v[152:155], v[88:91], v[16:19], v[152:155]
  ds_read_b128 v[128:131], v9 offset:12288
  v_mfma_f32_16x16x32_bf16 v[168:171], v[88:91], v[20:23], v[168:171]
  ds_read_b128 v[132:135], v9 offset:13312
  v_mfma_f32_16x16x32_bf16 v[156:159], v[92:95], v[16:19], v[156:159]
  ds_read_b128 v[136:139], v9 offset:14336
  v_mfma_f32_16x16x32_bf16 v[172:175], v[92:95], v[20:23], v[172:175]
  ds_read_b128 v[140:143], v9 offset:15360
  v_mfma_f32_16x16x32_bf16 v[176:179], v[96:99], v[16:19], v[176:179]
  buffer_load_dwordx4 v[56:59], v8, s[16:19], s40 offen offset:0 sc1
  v_mfma_f32_16x16x32_bf16 v[192:195], v[96:99], v[20:23], v[192:195]
  buffer_load_dwordx4 v[60:63], v8, s[16:19], s40 offen offset:1024 sc1
  v_mfma_f32_16x16x32_bf16 v[180:183], v[100:103], v[16:19], v[180:183]
  s_add_u32 s40, s40, 8192
  v_mfma_f32_16x16x32_bf16 v[196:199], v[100:103], v[20:23], v[196:199]
  s_cmp_eq_u32 s40, s41
  v_mfma_f32_16x16x32_bf16 v[184:187], v[104:107], v[16:19], v[184:187]
  s_cselect_b32 s40, s42, s40
  v_mfma_f32_16x16x32_bf16 v[200:203], v[104:107], v[20:23], v[200:203]
  s_cmp_eq_u32 s40, s43
  v_mfma_f32_16x16x32_bf16 v[188:191], v[108:111], v[16:19], v[188:191]
  s_cselect_b32 s40, s44, s40
  v_mfma_f32_16x16x32_bf16 v[204:207], v[108:111], v[20:23], v[204:207]
  s_waitcnt vmcnt(8) lgkmcnt(0)
  s_barrier
  v_mfma_f32_16x16x32_bf16 v[144:147], v[112:115], v[24:27], v[144:147]
  ds_read_b128 v[80:83], v9 offset:16384
  v_mfma_f32_16x16x32_bf16 v[160:163], v[112:115], v[28:31], v[160:163]
  ds_read_b128 v[84:87], v9 offset:17408
  v_mfma_f32_16x16x32_bf16 v[148:151], v[116:119], v[24:27], v[148:151]
  ds_read_b128 v[88:91], v9 offset:18432
  v_mfma_f32_16x16x32_bf16 v[164:167], v[116:119], v[28:31], v[164:167]
  ds_read_b128 v[92:95], v9 offset:19456
  v_mfma_f32_16x16x32_bf16 v[152:155], v[120:123], v[24:27], v[152:155]
  ds_read_b128 v[96:99], v9 offset:20480
  v_mfma_f32_16x16x32_bf16 v[168:171], v[120:123], v[28:31], v[168:171]
  ds_read_b128 v[100:103], v9 offset:21504
  v_mfma_f32_16x16x32_bf16 v[156:159], v[124:127], v[24:27], v[156:159]
  ds_read_b128 v[104:107], v9 offset:22528
  v_mfma_f32_16x16x32_bf16 v[172:175], v[124:127], v[28:31], v[172:175]
  ds_read_b128 v[108:111], v9 offset:23552
  v_mfma_f32_16x16x32_bf16 v[176:179], v[128:131], v[24:27], v[176:179]
  buffer_load_dwordx4 v[64:67], v8, s[16:19], s40 offen offset:0 sc1
  v_mfma_f32_16x16x32_bf16 v[192:195], v[128:131], v[28:31], v[192:195]
  buffer_load_dwordx4 v[68:71], v8, s[16:19], s40 offen offset:1024 sc1
  v_mfma_f32_16x16x32_bf16 v[180:183], v[132:135], v[24:27], v[180:183]
  s_add_u32 s40, s40, 8192
  v_mfma_f32_16x16x32_bf16 v[196:199], v[132:135], v[28:31], v[196:199]
  s_cmp_eq_u32 s40, s41
  v_mfma_f32_16x16x32_bf16 v[184:187], v[136:139], v[24:27], v[184:187]
  s_cselect_b32 s40, s42, s40
  v_mfma_f32_16x16x32_bf16 v[200:203], v[136:139], v[28:31], v[200:203]
  s_cmp_eq_u32 s40, s43
  v_mfma_f32_16x16x32_bf16 v[188:191], v[140:143], v[24:27], v[188:191]
  s_cselect_b32 s40, s44, s40
  v_mfma_f32_16x16x32_bf16 v[204:207], v[140:143], v[28:31], v[204:207]
  s_waitcnt vmcnt(8) lgkmcnt(0)
  v_mfma_f32_16x16x32_bf16 v[144:147], v[80:83], v[32:35], v[144:147]
  ds_read_b128 v[112:115], v9 offset:24576
  v_mfma_f32_16x16x32_bf16 v[160:163], v[80:83], v[36:39], v[160:163]
  ds_read_b128 v[116:119], v9 offset:25600
  v_mfma_f32_16x16x32_bf16 v[148:151], v[84:87], v[32:35], v[148:151]
  ds_read_b128 v[120:123], v9 offset:26624
  v_mfma_f32_16x16x32_bf16 v[164:167], v[84:87], v[36:39], v[164:167]
  ds_read_b128 v[124:127], v9 offset:27648
  v_mfma_f32_16x16x32_bf16 v[152:155], v[88:91], v[32:35], v[152:155]
  ds_read_b128 v[128:131], v9 offset:28672
  v_mfma_f32_16x16x32_bf16 v[168:171], v[88:91], v[36:39], v[168:171]
  ds_read_b128 v[132:135], v9 offset:29696
  v_mfma_f32_16x16x32_bf16 v[156:159], v[92:95], v[32:35], v[156:159]
  ds_read_b128 v[136:139], v9 offset:30720
  v_mfma_f32_16x16x32_bf16 v[172:175], v[92:95], v[36:39], v[172:175]
  ds_read_b128 v[140:143], v9 offset:31744
  v_mfma_f32_16x16x32_bf16 v[176:179], v[96:99], v[32:35], v[176:179]
  buffer_load_dwordx4 v[72:75], v8, s[16:19], s40 offen offset:0 sc1
  v_mfma_f32_16x16x32_bf16 v[192:195], v[96:99], v[36:39], v[192:195]
  buffer_load_dwordx4 v[76:79], v8, s[16:19], s40 offen offset:1024 sc1
  v_mfma_f32_16x16x32_bf16 v[180:183], v[100:103], v[32:35], v[180:183]
  s_add_u32 s40, s40, 8192
  v_mfma_f32_16x16x32_bf16 v[196:199], v[100:103], v[36:39], v[196:199]
  s_cmp_eq_u32 s40, s41
  v_mfma_f32_16x16x32_bf16 v[184:187], v[104:107], v[32:35], v[184:187]
  s_cselect_b32 s40, s42, s40
  v_mfma_f32_16x16x32_bf16 v[200:203], v[104:107], v[36:39], v[200:203]
  s_cmp_eq_u32 s40, s43
  v_mfma_f32_16x16x32_bf16 v[188:191], v[108:111], v[32:35], v[188:191]
  s_cselect_b32 s40, s44, s40
  v_mfma_f32_16x16x32_bf16 v[204:207], v[108:111], v[36:39], v[204:207]
  s_waitcnt vmcnt(8) lgkmcnt(0)
  s_barrier
  v_mfma_f32_16x16x32_bf16 v[144:147], v[112:115], v[40:43], v[144:147]
  ds_read_b128 v[80:83], v9 offset:32768
  v_mfma_f32_16x16x32_bf16 v[160:163], v[112:115], v[44:47], v[160:163]
  ds_read_b128 v[84:87], v9 offset:33792
  v_mfma_f32_16x16x32_bf16 v[148:151], v[116:119], v[40:43], v[148:151]
  ds_read_b128 v[88:91], v9 offset:34816
  v_mfma_f32_16x16x32_bf16 v[164:167], v[116:119], v[44:47], v[164:167]
  ds_read_b128 v[92:95], v9 offset:35840
  v_mfma_f32_16x16x32_bf16 v[152:155], v[120:123], v[40:43], v[152:155]
  ds_read_b128 v[96:99], v9 offset:36864
  v_mfma_f32_16x16x32_bf16 v[168:171], v[120:123], v[44:47], v[168:171]
  ds_read_b128 v[100:103], v9 offset:37888
  v_mfma_f32_16x16x32_bf16 v[156:159], v[124:127], v[40:43], v[156:159]
  ds_read_b128 v[104:107], v9 offset:38912
  v_mfma_f32_16x16x32_bf16 v[172:175], v[124:127], v[44:47], v[172:175]
  ds_read_b128 v[108:111], v9 offset:39936
  v_mfma_f32_16x16x32_bf16 v[176:179], v[128:131], v[40:43], v[176:179]
  buffer_load_dwordx4 v[16:19], v8, s[16:19], s40 offen offset:0 sc1
  v_mfma_f32_16x16x32_bf16 v[192:195], v[128:131], v[44:47], v[192:195]
  buffer_load_dwordx4 v[20:23], v8, s[16:19], s40 offen offset:1024 sc1
  v_mfma_f32_16x16x32_bf16 v[180:183], v[132:135], v[40:43], v[180:183]
  s_add_u32 s40, s40, 8192
  v_mfma_f32_16x16x32_bf16 v[196:199], v[132:135], v[44:47], v[196:199]
  s_cmp_eq_u32 s40, s41
  v_mfma_f32_16x16x32_bf16 v[184:187], v[136:139], v[40:43], v[184:187]
  s_cselect_b32 s40, s42, s40
  v_mfma_f32_16x16x32_bf16 v[200:203], v[136:139], v[44:47], v[200:203]
  s_cmp_eq_u32 s40, s43
  v_mfma_f32_16x16x32_bf16 v[188:191], v[140:143], v[40:43], v[188:191]
  s_cselect_b32 s40, s44, s40
  v_mfma_f32_16x16x32_bf16 v[204:207], v[140:143], v[44:47], v[204:207]
  s_waitcnt vmcnt(8) lgkmcnt(0)
  v_mfma_f32_16x16x32_bf16 v[144:147], v[80:83], v[48:51], v[144:147]
  ds_read_b128 v[112:115], v9 offset:40960
  v_mfma_f32_16x16x32_bf16 v[160:163], v[80:83], v[52:55], v[160:163]
  ds_read_b128 v[116:119], v9 offset:41984
  v_mfma_f32_16x16x32_bf16 v[148:151], v[84:87], v[48:51], v[148:151]
  ds_read_b128 v[120:123], v9 offset:43008
  v_mfma_f32_16x16x32_bf16 v[164:167], v[84:87], v[52:55], v[164:167]
  ds_read_b128 v[124:127], v9 offset:44032
  v_mfma_f32_16x16x32_bf16 v[152:155], v[88:91], v[48:51], v[152:155]
  ds_read_b128 v[128:131], v9 offset:45056
  v_mfma_f32_16x16x32_bf16 v[168:171], v[88:91], v[52:55], v[168:171]
  ds_read_b128 v[132:135], v9 offset:46080
  v_mfma_f32_16x16x32_bf16 v[156:159], v[92:95], v[48:51], v[156:159]
  ds_read_b128 v[136:139], v9 offset:47104
  v_mfma_f32_16x16x32_bf16 v[172:175], v[92:95], v[52:55], v[172:175]
  ds_read_b128 v[140:143], v9 offset:48128
  v_mfma_f32_16x16x32_bf16 v[176:179], v[96:99], v[48:51], v[176:179]
  buffer_load_dwordx4 v[24:27], v8, s[16:19], s40 offen offset:0 sc1
  v_mfma_f32_16x16x32_bf16 v[192:195], v[96:99], v[52:55], v[192:195]
  buffer_load_dwordx4 v[28:31], v8, s[16:19], s40 offen offset:1024 sc1
  v_mfma_f32_16x16x32_bf16 v[180:183], v[100:103], v[48:51], v[180:183]
  s_add_u32 s40, s40, 8192
  v_mfma_f32_16x16x32_bf16 v[196:199], v[100:103], v[52:55], v[196:199]
  s_cmp_eq_u32 s40, s41
  v_mfma_f32_16x16x32_bf16 v[184:187], v[104:107], v[48:51], v[184:187]
  s_cselect_b32 s40, s42, s40
  v_mfma_f32_16x16x32_bf16 v[200:203], v[104:107], v[52:55], v[200:203]
  s_cmp_eq_u32 s40, s43
  v_mfma_f32_16x16x32_bf16 v[188:191], v[108:111], v[48:51], v[188:191]
  s_cselect_b32 s40, s44, s40
  v_mfma_f32_16x16x32_bf16 v[204:207], v[108:111], v[52:55], v[204:207]
  s_waitcnt vmcnt(8) lgkmcnt(0)
  s_barrier
  v_mfma_f32_16x16x32_bf16 v[144:147], v[112:115], v[56:59], v[144:147]
  ds_read_b128 v[80:83], v9 offset:49152
  ds_read_b128 v[84:87], v9 offset:50176
  v_mfma_f32_16x16x32_bf16 v[160:163], v[112:115], v[60:63], v[160:163]
  ds_read_b128 v[88:91], v9 offset:51200
  v_mfma_f32_16x16x32_bf16 v[148:151], v[116:119], v[56:59], v[148:151]
  ds_read_b128 v[92:95], v9 offset:52224
  v_mfma_f32_16x16x32_bf16 v[164:167], v[116:119], v[60:63], v[164:167]
  ds_read_b128 v[96:99], v9 offset:53248
  v_mfma_f32_16x16x32_bf16 v[152:155], v[120:123], v[56:59], v[152:155]
  ds_read_b128 v[100:103], v9 offset:54272
  v_mfma_f32_16x16x32_bf16 v[168:171], v[120:123], v[60:63], v[168:171]
  ds_read_b128 v[104:107], v9 offset:55296
  v_mfma_f32_16x16x32_bf16 v[156:159], v[124:127], v[56:59], v[156:159]
  ds_read_b128 v[108:111], v9 offset:56320
  v_mfma_f32_16x16x32_bf16 v[172:175], v[124:127], v[60:63], v[172:175]
  buffer_load_dwordx4 v[32:35], v8, s[16:19], s40 offen offset:0 sc1
  v_mfma_f32_16x16x32_bf16 v[176:179], v[128:131], v[56:59], v[176:179]
  buffer_load_dwordx4 v[36:39], v8, s[16:19], s40 offen offset:1024 sc1
  v_mfma_f32_16x16x32_bf16 v[192:195], v[128:131], v[60:63], v[192:195]
  s_add_u32 s40, s40, 8192
  v_mfma_f32_16x16x32_bf16 v[180:183], v[132:135], v[56:59], v[180:183]
  s_cmp_eq_u32 s40, s41
  v_mfma_f32_16x16x32_bf16 v[196:199], v[132:135], v[60:63], v[196:199]
  s_cselect_b32 s40, s42, s40
  v_mfma_f32_16x16x32_bf16 v[184:187], v[136:139], v[56:59], v[184:187]
  s_cmp_eq_u32 s40, s43
  v_mfma_f32_16x16x32_bf16 v[200:203], v[136:139], v[60:63], v[200:203]
  s_cselect_b32 s40, s44, s40
  v_mfma_f32_16x16x32_bf16 v[188:191], v[140:143], v[56:59], v[188:191]
  s_sub_u32 s45, s45, 1
  v_mfma_f32_16x16x32_bf16 v[204:207], v[140:143], v[60:63], v[204:207]
  s_cmp_lg_u32 s45, 0
  s_cbranch_scc1 w2_c1
  s_waitcnt vmcnt(8) lgkmcnt(0)
  v_cvt_pk_bf16_f32 v224, v176, v177
  v_cvt_pk_bf16_f32 v225, v178, v179
  v_cvt_pk_bf16_f32 v226, v180, v181
  v_cvt_pk_bf16_f32 v227, v182, v183
  v_cvt_pk_bf16_f32 v228, v184, v185
  v_cvt_pk_bf16_f32 v229, v186, v187
  v_cvt_pk_bf16_f32 v230, v188, v189
  v_cvt_pk_bf16_f32 v231, v190, v191
  v_cvt_pk_bf16_f32 v232, v192, v193
  v_cvt_pk_bf16_f32 v233, v194, v195
  v_cvt_pk_bf16_f32 v234, v196, v197
  v_cvt_pk_bf16_f32 v235, v198, v199
  v_cvt_pk_bf16_f32 v236, v200, v201
  v_cvt_pk_bf16_f32 v237, v202, v203
  v_cvt_pk_bf16_f32 v238, v204, v205
  v_cvt_pk_bf16_f32 v239, v206, v207
  v_mfma_f32_16x16x32_bf16 v[144:147], v[80:83], v[64:67], v[144:147]
  ds_read_b128 v[112:115], v9 offset:57344
  ds_read_b128 v[116:119], v9 offset:58368
  v_mfma_f32_16x16x32_bf16 v[160:163], v[80:83], v[68:71], v[160:163]
  ds_read_b128 v[120:123], v9 offset:59392
  ds_read_b128 v[124:127], v9 offset:60416
  v_mfma_f32_16x16x32_bf16 v[148:151], v[84:87], v[64:67], v[148:151]
  buffer_store_dwordx4 v[224:227], v8, s[16:19], s38 offen offset:0 sc1
  buffer_store_dwordx4 v[228:231], v8, s[16:19], s38 offen offset:1024 sc1
  v_mfma_f32_16x16x32_bf16 v[164:167], v[84:87], v[68:71], v[164:167]
  buffer_store_dwordx4 v[232:235], v8, s[16:19], s38 offen offset:2048 sc1
  v_mfma_f32_16x16x32_bf16 v[152:155], v[88:91], v[64:67], v[152:155]
  buffer_store_dwordx4 v[236:239], v8, s[16:19], s38 offen offset:3072 sc1
  v_mfma_f32_16x16x32_bf16 v[168:171], v[88:91], v[68:71], v[168:171]
  buffer_load_dwordx4 v[40:43], v8, s[16:19], s40 offen offset:0 sc1
  v_mfma_f32_16x16x32_bf16 v[156:159], v[92:95], v[64:67], v[156:159]
  buffer_load_dwordx4 v[44:47], v8, s[16:19], s40 offen offset:1024 sc1
  v_mfma_f32_16x16x32_bf16 v[172:175], v[92:95], v[68:71], v[172:175]
  s_add_u32 s40, s40, 8192
  s_waitcnt vmcnt(12) lgkmcnt(0)
  s_barrier
  v_mfma_f32_16x16x32_bf16 v[144:147], v[112:115], v[72:75], v[144:147]
  ds_read_b128 v[80:83], v9 offset:0
  v_mfma_f32_16x16x32_bf16 v[160:163], v[112:115], v[76:79], v[160:163]
  ds_read_b128 v[84:87], v9 offset:1024
  v_mfma_f32_16x16x32_bf16 v[148:151], v[116:119], v[72:75], v[148:151]
  ds_read_b128 v[88:91], v9 offset:2048
  v_mfma_f32_16x16x32_bf16 v[164:167], v[116:119], v[76:79], v[164:167]
  ds_read_b128 v[92:95], v9 offset:3072
  v_mfma_f32_16x16x32_bf16 v[152:155], v[120:123], v[72:75], v[152:155]
  buffer_load_dwordx4 v[48:51], v8, s[16:19], s40 offen offset:0 sc1
  v_mfma_f32_16x16x32_bf16 v[168:171], v[120:123], v[76:79], v[168:171]
  buffer_load_dwordx4 v[52:55], v8, s[16:19], s40 offen offset:1024 sc1
  v_mfma_f32_16x16x32_bf16 v[156:159], v[124:127], v[72:75], v[156:159]
  s_add_u32 s40, s40, 8192
  v_mfma_f32_16x16x32_bf16 v[172:175], v[124:127], v[76:79], v[172:175]
  s_waitcnt vmcnt(12) lgkmcnt(0)
  v_mfma_f32_16x16x32_bf16 v[144:147], v[80:83], v[16:19], v[144:147]
  ds_read_b128 v[112:115], v9 offset:8192
  v_mfma_f32_16x16x32_bf16 v[160:163], v[80:83], v[20:23], v[160:163]
  ds_read_b128 v[116:119], v9 offset:9216
  v_mfma_f32_16x16x32_bf16 v[148:151], v[84:87], v[16:19], v[148:151]
  ds_read_b128 v[120:123], v9 offset:10240
  v_mfma_f32_16x16x32_bf16 v[164:167], v[84:87], v[20:23], v[164:167]
  ds_read_b128 v[124:127], v9 offset:11264
  v_mfma_f32_16x16x32_bf16 v[152:155], v[88:91], v[16:19], v[152:155]
  buffer_load_dwordx4 v[56:59], v8, s[16:19], s40 offen offset:0 sc1
  v_mfma_f32_16x16x32_bf16 v[168:171], v[88:91], v[20:23], v[168:171]
  buffer_load_dwordx4 v[60:63], v8, s[16:19], s40 offen offset:1024 sc1
  v_mfma_f32_16x16x32_bf16 v[156:159], v[92:95], v[16:19], v[156:159]
  s_add_u32 s40, s40, 8192
  v_mfma_f32_16x16x32_bf16 v[172:175], v[92:95], v[20:23], v[172:175]
  s_waitcnt vmcnt(12) lgkmcnt(0)
  s_barrier
  v_mfma_f32_16x16x32_bf16 v[144:147], v[112:115], v[24:27], v[144:147]
  ds_read_b128 v[80:83], v9 offset:16384
  v_mfma_f32_16x16x32_bf16 v[160:163], v[112:115], v[28:31], v[160:163]
  ds_read_b128 v[84:87], v9 offset:17408
  v_mfma_f32_16x16x32_bf16 v[148:151], v[116:119], v[24:27], v[148:151]
  ds_read_b128 v[88:91], v9 offset:18432
  v_mfma_f32_16x16x32_bf16 v[164:167], v[116:119], v[28:31], v[164:167]
  ds_read_b128 v[92:95], v9 offset:19456
  v_mfma_f32_16x16x32_bf16 v[152:155], v[120:123], v[24:27], v[152:155]
  buffer_load_dwordx4 v[64:67], v8, s[16:19], s40 offen offset:0 sc1
  v_mfma_f32_16x16x32_bf16 v[168:171], v[120:123], v[28:31], v[168:171]
  buffer_load_dwordx4 v[68:71], v8, s[16:19], s40 offen offset:1024 sc1
  v_mfma_f32_16x16x32_bf16 v[156:159], v[124:127], v[24:27], v[156:159]
  s_add_u32 s40, s40, 8192
  v_mfma_f32_16x16x32_bf16 v[172:175], v[124:127], v[28:31], v[172:175]
  s_waitcnt vmcnt(12) lgkmcnt(0)
  v_mfma_f32_16x16x32_bf16 v[144:147], v[80:83], v[32:35], v[144:147]
  ds_read_b128 v[112:115], v9 offset:24576
  v_mfma_f32_16x16x32_bf16 v[160:163], v[80:83], v[36:39], v[160:163]
  ds_read_b128 v[116:119], v9 offset:25600
  v_mfma_f32_16x16x32_bf16 v[148:151], v[84:87], v[32:35], v[148:151]
  ds_read_b128 v[120:123], v9 offset:26624
  v_mfma_f32_16x16x32_bf16 v[164:167], v[84:87], v[36:39], v[164:167]
  ds_read_b128 v[124:127], v9 offset:27648
  v_mfma_f32_16x16x32_bf16 v[152:155], v[88:91], v[32:35], v[152:155]
  buffer_load_dwordx4 v[72:75], v8, s[16:19], s40 offen offset:0 sc1
  v_mfma_f32_16x16x32_bf16 v[168:171], v[88:91], v[36:39], v[168:171]
  buffer_load_dwordx4 v[76:79], v8, s[16:19], s40 offen offset:1024 sc1
  v_mfma_f32_16x16x32_bf16 v[156:159], v[92:95], v[32:35], v[156:159]
  s_add_u32 s40, s40, 8192
  v_mfma_f32_16x16x32_bf16 v[172:175], v[92:95], v[36:39], v[172:175]
  s_waitcnt vmcnt(8) lgkmcnt(0)
  s_barrier
  v_mfma_f32_16x16x32_bf16 v[144:147], v[112:115], v[40:43], v[144:147]
  ds_read_b128 v[80:83], v9 offset:32768
  v_mfma_f32_16x16x32_bf16 v[160:163], v[112:115], v[44:47], v[160:163]
  ds_read_b128 v[84:87], v9 offset:33792
  v_mfma_f32_16x16x32_bf16 v[148:151], v[116:119], v[40:43], v[148:151]
  ds_read_b128 v[88:91], v9 offset:34816
  v_mfma_f32_16x16x32_bf16 v[164:167], v[116:119], v[44:47], v[164:167]
  ds_read_b128 v[92:95], v9 offset:35840
  v_mfma_f32_16x16x32_bf16 v[152:155], v[120:123], v[40:43], v[152:155]
  s_add_u32 s40, s44, 458752
  v_mfma_f32_16x16x32_bf16 v[168:171], v[120:123], v[44:47], v[168:171]
  buffer_load_dwordx4 v[16:19], v8, s[16:19], s40 offen offset:0 sc1
  v_mfma_f32_16x16x32_bf16 v[156:159], v[124:127], v[40:43], v[156:159]
  buffer_load_dwordx4 v[20:23], v8, s[16:19], s40 offen offset:1024 sc1
  v_mfma_f32_16x16x32_bf16 v[172:175], v[124:127], v[44:47], v[172:175]
  s_add_u32 s40, s40, 8192
  s_waitcnt vmcnt(8) lgkmcnt(0)
  v_mfma_f32_16x16x32_bf16 v[144:147], v[80:83], v[48:51], v[144:147]
  ds_read_b128 v[112:115], v9 offset:40960
  v_mfma_f32_16x16x32_bf16 v[160:163], v[80:83], v[52:55], v[160:163]
  ds_read_b128 v[116:119], v9 offset:41984
  v_mfma_f32_16x16x32_bf16 v[148:151], v[84:87], v[48:51], v[148:151]
  ds_read_b128 v[120:123], v9 offset:43008
  v_mfma_f32_16x16x32_bf16 v[164:167], v[84:87], v[52:55], v[164:167]
  ds_read_b128 v[124:127], v9 offset:44032
  v_mfma_f32_16x16x32_bf16 v[152:155], v[88:91], v[48:51], v[152:155]
  buffer_load_dwordx4 v[24:27], v8, s[16:19], s40 offen offset:0 sc1
  v_mfma_f32_16x16x32_bf16 v[168:171], v[88:91], v[52:55], v[168:171]
  buffer_load_dwordx4 v[28:31], v8, s[16:19], s40 offen offset:1024 sc1
  v_mfma_f32_16x16x32_bf16 v[156:159], v[92:95], v[48:51], v[156:159]
  s_add_u32 s40, s40, 8192
  v_mfma_f32_16x16x32_bf16 v[172:175], v[92:95], v[52:55], v[172:175]
  s_waitcnt vmcnt(8) lgkmcnt(0)
  s_barrier
  v_mfma_f32_16x16x32_bf16 v[144:147], v[112:115], v[56:59], v[144:147]
  ds_read_b128 v[80:83], v9 offset:49152
  v_mfma_f32_16x16x32_bf16 v[160:163], v[112:115], v[60:63], v[160:163]
  ds_read_b128 v[84:87], v9 offset:50176
  v_mfma_f32_16x16x32_bf16 v[148:151], v[116:119], v[56:59], v[148:151]
  ds_read_b128 v[88:91], v9 offset:51200
  v_mfma_f32_16x16x32_bf16 v[164:167], v[116:119], v[60:63], v[164:167]
  ds_read_b128 v[92:95], v9 offset:52224
  v_mfma_f32_16x16x32_bf16 v[152:155], v[120:123], v[56:59], v[152:155]
  buffer_load_dwordx4 v[32:35], v8, s[16:19], s40 offen offset:0 sc1
  v_mfma_f32_16x16x32_bf16 v[168:171], v[120:123], v[60:63], v[168:171]
  buffer_load_dwordx4 v[36:39], v8, s[16:19], s40 offen offset:1024 sc1
  v_mfma_f32_16x16x32_bf16 v[156:159], v[124:127], v[56:59], v[156:159]
  s_add_u32 s40, s40, 8192
  v_mfma_f32_16x16x32_bf16 v[172:175], v[124:127], v[60:63], v[172:175]
  s_waitcnt vmcnt(8) lgkmcnt(0)
  v_mfma_f32_16x16x32_bf16 v[144:147], v[80:83], v[64:67], v[144:147]
  ds_read_b128 v[112:115], v9 offset:57344
  v_mfma_f32_16x16x32_bf16 v[160:163], v[80:83], v[68:71], v[160:163]
  ds_read_b128 v[116:119], v9 offset:58368
  v_mfma_f32_16x16x32_bf16 v[148:151], v[84:87], v[64:67], v[148:151]
  ds_read_b128 v[120:123], v9 offset:59392
  v_mfma_f32_16x16x32_bf16 v[164:167], v[84:87], v[68:71], v[164:167]
  ds_read_b128 v[124:127], v9 offset:60416
  v_mfma_f32_16x16x32_bf16 v[152:155], v[88:91], v[64:67], v[152:155]
  buffer_load_dwordx4 v[40:43], v8, s[16:19], s40 offen offset:0 sc1
  v_mfma_f32_16x16x32_bf16 v[168:171], v[88:91], v[68:71], v[168:171]
  buffer_load_dwordx4 v[44:47], v8, s[16:19], s40 offen offset:1024 sc1
  v_mfma_f32_16x16x32_bf16 v[156:159], v[92:95], v[64:67], v[156:159]
  s_add_u32 s40, s40, 8192
  v_mfma_f32_16x16x32_bf16 v[172:175], v[92:95], v[68:71], v[172:175]
  s_waitcnt vmcnt(8) lgkmcnt(0)
  s_barrier
  v_mfma_f32_16x16x32_bf16 v[144:147], v[112:115], v[72:75], v[144:147]
  ds_read_b128 v[80:83], v9 offset:0
  v_mfma_f32_16x16x32_bf16 v[160:163], v[112:115], v[76:79], v[160:163]
  ds_read_b128 v[84:87], v9 offset:1024
  v_mfma_f32_16x16x32_bf16 v[148:151], v[116:119], v[72:75], v[148:151]
  ds_read_b128 v[88:91], v9 offset:2048
  v_mfma_f32_16x16x32_bf16 v[164:167], v[116:119], v[76:79], v[164:167]
  ds_read_b128 v[92:95], v9 offset:3072
  v_mfma_f32_16x16x32_bf16 v[152:155], v[120:123], v[72:75], v[152:155]
  buffer_load_dwordx4 v[48:51], v8, s[16:19], s40 offen offset:0 sc1
  v_mfma_f32_16x16x32_bf16 v[168:171], v[120:123], v[76:79], v[168:171]
  buffer_load_dwordx4 v[52:55], v8, s[16:19], s40 offen offset:1024 sc1
  v_mfma_f32_16x16x32_bf16 v[156:159], v[124:127], v[72:75], v[156:159]
  s_add_u32 s40, s40, 8192
  v_mfma_f32_16x16x32_bf16 v[172:175], v[124:127], v[76:79], v[172:175]
  s_waitcnt vmcnt(8) lgkmcnt(0)
  v_mfma_f32_16x16x32_bf16 v[144:147], v[80:83], v[16:19], v[144:147]
  ds_read_b128 v[112:115], v9 offset:8192
  v_mfma_f32_16x16x32_bf16 v[160:163], v[80:83], v[20:23], v[160:163]
  ds_read_b128 v[116:119], v9 offset:9216
  v_mfma_f32_16x16x32_bf16 v[148:151], v[84:87], v[16:19], v[148:151]
  ds_read_b128 v[120:123], v9 offset:10240
  v_mfma_f32_16x16x32_bf16 v[164:167], v[84:87], v[20:23], v[164:167]
  ds_read_b128 v[124:127], v9 offset:11264
  v_mfma_f32_16x16x32_bf16 v[152:155], v[88:91], v[16:19], v[152:155]
  buffer_load_dwordx4 v[56:59], v8, s[16:19], s40 offen offset:0 sc1
  v_mfma_f32_16x16x32_bf16 v[168:171], v[88:91], v[20:23], v[168:171]
  buffer_load_dwordx4 v[60:63], v8, s[16:19], s40 offen offset:1024 sc1
  v_mfma_f32_16x16x32_bf16 v[156:159], v[92:95], v[16:19], v[156:159]
  s_add_u32 s40, s40, 8192
  v_mfma_f32_16x16x32_bf16 v[172:175], v[92:95], v[20:23], v[172:175]
  s_waitcnt vmcnt(8) lgkmcnt(0)
  s_barrier
  v_mfma_f32_16x16x32_bf16 v[144:147], v[112:115], v[24:27], v[144:147]
  ds_read_b128 v[80:83], v9 offset:16384
  v_mfma_f32_16x16x32_bf16 v[160:163], v[112:115], v[28:31], v[160:163]
  ds_read_b128 v[84:87], v9 offset:17408
  v_mfma_f32_16x16x32_bf16 v[148:151], v[116:119], v[24:27], v[148:151]
  ds_read_b128 v[88:91], v9 offset:18432
  v_mfma_f32_16x16x32_bf16 v[164:167], v[116:119], v[28:31], v[164:167]
  ds_read_b128 v[92:95], v9 offset:19456
  v_mfma_f32_16x16x32_bf16 v[152:155], v[120:123], v[24:27], v[152:155]
  buffer_load_dwordx4 v[64:67], v8, s[16:19], s40 offen offset:0 sc1
  v_mfma_f32_16x16x32_bf16 v[168:171], v[120:123], v[28:31], v[168:171]
  buffer_load_dwordx4 v[68:71], v8, s[16:19], s40 offen offset:1024 sc1
  v_mfma_f32_16x16x32_bf16 v[156:159], v[124:127], v[24:27], v[156:159]
  s_add_u32 s40, s40, 8192
  v_mfma_f32_16x16x32_bf16 v[172:175], v[124:127], v[28:31], v[172:175]
  s_waitcnt vmcnt(8) lgkmcnt(0)
  v_mfma_f32_16x16x32_bf16 v[144:147], v[80:83], v[32:35], v[144:147]
  ds_read_b128 v[112:115], v9 offset:24576
  v_mfma_f32_16x16x32_bf16 v[160:163], v[80:83], v[36:39], v[160:163]
  ds_read_b128 v[116:119], v9 offset:25600
  v_mfma_f32_16x16x32_bf16 v[148:151], v[84:87], v[32:35], v[148:151]
  ds_read_b128 v[120:123], v9 offset:26624
  v_mfma_f32_16x16x32_bf16 v[164:167], v[84:87], v[36:39], v[164:167]
  ds_read_b128 v[124:127], v9 offset:27648
  v_mfma_f32_16x16x32_bf16 v[152:155], v[88:91], v[32:35], v[152:155]
  buffer_load_dwordx4 v[72:75], v8, s[16:19], s40 offen offset:0 sc1
  v_mfma_f32_16x16x32_bf16 v[168:171], v[88:91], v[36:39], v[168:171]
  buffer_load_dwordx4 v[76:79], v8, s[16:19], s40 offen offset:1024 sc1
  v_mfma_f32_16x16x32_bf16 v[156:159], v[92:95], v[32:35], v[156:159]
  s_add_u32 s40, s40, 8192
  v_mfma_f32_16x16x32_bf16 v[172:175], v[92:95], v[36:39], v[172:175]
  s_waitcnt vmcnt(8) lgkmcnt(0)
  s_barrier
  v_mfma_f32_16x16x32_bf16 v[144:147], v[112:115], v[40:43], v[144:147]
  ds_read_b128 v[80:83], v9 offset:32768
  v_mfma_f32_16x16x32_bf16 v[160:163], v[112:115], v[44:47], v[160:163]
  ds_read_b128 v[84:87], v9 offset:33792
  v_mfma_f32_16x16x32_bf16 v[148:151], v[116:119], v[40:43], v[148:151]
  ds_read_b128 v[88:91], v9 offset:34816
  v_mfma_f32_16x16x32_bf16 v[164:167], v[116:119], v[44:47], v[164:167]
  ds_read_b128 v[92:95], v9 offset:35840
  v_mfma_f32_16x16x32_bf16 v[152:155], v[120:123], v[40:43], v[152:155]
  buffer_load_dwordx4 v[16:19], v8, s[16:19], s40 offen offset:0 sc1
  v_mfma_f32_16x16x32_bf16 v[168:171], v[120:123], v[44:47], v[168:171]
  buffer_load_dwordx4 v[20:23], v8, s[16:19], s40 offen offset:1024 sc1
  v_mfma_f32_16x16x32_bf16 v[156:159], v[124:127], v[40:43], v[156:159]
  s_add_u32 s40, s40, 8192
  v_mfma_f32_16x16x32_bf16 v[172:175], v[124:127], v[44:47], v[172:175]
  s_waitcnt vmcnt(8) lgkmcnt(0)
  v_mfma_f32_16x16x32_bf16 v[144:147], v[80:83], v[48:51], v[144:147]
  ds_read_b128 v[112:115], v9 offset:40960
  v_mfma_f32_16x16x32_bf16 v[160:163], v[80:83], v[52:55], v[160:163]
  ds_read_b128 v[116:119], v9 offset:41984
  v_mfma_f32_16x16x32_bf16 v[148:151], v[84:87], v[48:51], v[148:151]
  ds_read_b128 v[120:123], v9 offset:43008
  v_mfma_f32_16x16x32_bf16 v[164:167], v[84:87], v[52:55], v[164:167]
  ds_read_b128 v[124:127], v9 offset:44032
  v_mfma_f32_16x16x32_bf16 v[152:155], v[88:91], v[48:51], v[152:155]
  buffer_load_dwordx4 v[24:27], v8, s[16:19], s40 offen offset:0 sc1
  v_mfma_f32_16x16x32_bf16 v[168:171], v[88:91], v[52:55], v[168:171]
  buffer_load_dwordx4 v[28:31], v8, s[16:19], s40 offen offset:1024 sc1
  v_mfma_f32_16x16x32_bf16 v[156:159], v[92:95], v[48:51], v[156:159]
  s_add_u32 s40, s40, 8192
  v_mfma_f32_16x16x32_bf16 v[172:175], v[92:95], v[52:55], v[172:175]
  s_waitcnt vmcnt(8) lgkmcnt(0)
  s_barrier
  v_mfma_f32_16x16x32_bf16 v[144:147], v[112:115], v[56:59], v[144:147]
  ds_read_b128 v[80:83], v9 offset:49152
  v_mfma_f32_16x16x32_bf16 v[160:163], v[112:115], v[60:63], v[160:163]
  ds_read_b128 v[84:87], v9 offset:50176
  v_mfma_f32_16x16x32_bf16 v[148:151], v[116:119], v[56:59], v[148:151]
  ds_read_b128 v[88:91], v9 offset:51200
  v_mfma_f32_16x16x32_bf16 v[164:167], v[116:119], v[60:63], v[164:167]
  ds_read_b128 v[92:95], v9 offset:52224
  v_mfma_f32_16x16x32_bf16 v[152:155], v[120:123], v[56:59], v[152:155]
  buffer_load_dwordx4 v[176:179], v8, s[16:19], s39 offen offset:0 sc1
  v_mfma_f32_16x16x32_bf16 v[168:171], v[120:123], v[60:63], v[168:171]
  buffer_load_dwordx4 v[180:183], v8, s[16:19], s39 offen offset:1024 sc1
  v_mfma_f32_16x16x32_bf16 v[156:159], v[124:127], v[56:59], v[156:159]
  buffer_load_dwordx4 v[184:187], v8, s[16:19], s39 offen offset:2048 sc1
  v_mfma_f32_16x16x32_bf16 v[172:175], v[124:127], v[60:63], v[172:175]
  buffer_load_dwordx4 v[188:191], v8, s[16:19], s39 offen offset:3072 sc1
  s_waitcnt vmcnt(10) lgkmcnt(0)
  v_mfma_f32_16x16x32_bf16 v[144:147], v[80:83], v[64:67], v[144:147]
  ds_read_b128 v[112:115], v9 offset:57344
  v_mfma_f32_16x16x32_bf16 v[160:163], v[80:83], v[68:71], v[160:163]
  ds_read_b128 v[116:119], v9 offset:58368
  v_mfma_f32_16x16x32_bf16 v[148:151], v[84:87], v[64:67], v[148:151]
  ds_read_b128 v[120:123], v9 offset:59392
  v_mfma_f32_16x16x32_bf16 v[164:167], v[84:87], v[68:71], v[164:167]
  ds_read_b128 v[124:127], v9 offset:60416
  v_mfma_f32_16x16x32_bf16 v[152:155], v[88:91], v[64:67], v[152:155]
  v_mfma_f32_16x16x32_bf16 v[168:171], v[88:91], v[68:71], v[168:171]
  v_mfma_f32_16x16x32_bf16 v[156:159], v[92:95], v[64:67], v[156:159]
  v_mfma_f32_16x16x32_bf16 v[172:175], v[92:95], v[68:71], v[172:175]
  s_waitcnt vmcnt(8) lgkmcnt(0)
  s_barrier
  v_mfma_f32_16x16x32_bf16 v[144:147], v[112:115], v[72:75], v[144:147]
  ds_read_b128 v[80:83], v9 offset:0
  v_mfma_f32_16x16x32_bf16 v[160:163], v[112:115], v[76:79], v[160:163]
  ds_read_b128 v[84:87], v9 offset:1024
  v_mfma_f32_16x16x32_bf16 v[148:151], v[116:119], v[72:75], v[148:151]
  ds_read_b128 v[88:91], v9 offset:2048
  v_mfma_f32_16x16x32_bf16 v[164:167], v[116:119], v[76:79], v[164:167]
  ds_read_b128 v[92:95], v9 offset:3072
  v_mfma_f32_16x16x32_bf16 v[152:155], v[120:123], v[72:75], v[152:155]
  v_mfma_f32_16x16x32_bf16 v[168:171], v[120:123], v[76:79], v[168:171]
  v_mfma_f32_16x16x32_bf16 v[156:159], v[124:127], v[72:75], v[156:159]
  v_mfma_f32_16x16x32_bf16 v[172:175], v[124:127], v[76:79], v[172:175]
  s_waitcnt vmcnt(6) lgkmcnt(0)
  v_mfma_f32_16x16x32_bf16 v[144:147], v[80:83], v[16:19], v[144:147]
  ds_read_b128 v[112:115], v9 offset:8192
  v_mfma_f32_16x16x32_bf16 v[160:163], v[80:83], v[20:23], v[160:163]
  ds_read_b128 v[116:119], v9 offset:9216
  v_mfma_f32_16x16x32_bf16 v[148:151], v[84:87], v[16:19], v[148:151]
  ds_read_b128 v[120:123], v9 offset:10240
  v_mfma_f32_16x16x32_bf16 v[164:167], v[84:87], v[20:23], v[164:167]
  ds_read_b128 v[124:127], v9 offset:11264
  v_mfma_f32_16x16x32_bf16 v[152:155], v[88:91], v[16:19], v[152:155]
  v_mfma_f32_16x16x32_bf16 v[168:171], v[88:91], v[20:23], v[168:171]
  v_mfma_f32_16x16x32_bf16 v[156:159], v[92:95], v[16:19], v[156:159]
  v_mfma_f32_16x16x32_bf16 v[172:175], v[92:95], v[20:23], v[172:175]
  s_waitcnt vmcnt(4) lgkmcnt(0)
  s_barrier
  v_mfma_f32_16x16x32_bf16 v[144:147], v[112:115], v[24:27], v[144:147]
  v_mfma_f32_16x16x32_bf16 v[160:163], v[112:115], v[28:31], v[160:163]
  v_mfma_f32_16x16x32_bf16 v[148:151], v[116:119], v[24:27], v[148:151]
  v_mfma_f32_16x16x32_bf16 v[164:167], v[116:119], v[28:31], v[164:167]
  v_mfma_f32_16x16x32_bf16 v[152:155], v[120:123], v[24:27], v[152:155]
  v_mfma_f32_16x16x32_bf16 v[168:171], v[120:123], v[28:31], v[168:171]
  v_mfma_f32_16x16x32_bf16 v[156:159], v[124:127], v[24:27], v[156:159]
  v_mfma_f32_16x16x32_bf16 v[172:175], v[124:127], v[28:31], v[172:175]
  s_waitcnt vmcnt(4)
  v_lshlrev_b32 v80, 16, v208
  v_and_b32 v81, 0xffff0000, v208
  v_lshlrev_b32 v82, 16, v209
  v_and_b32 v83, 0xffff0000, v209
  v_lshlrev_b32 v84, 16, v210
  v_and_b32 v85, 0xffff0000, v210
  v_lshlrev_b32 v86, 16, v211
  v_and_b32 v87, 0xffff0000, v211
  v_lshlrev_b32 v96, 16, v212
  v_and_b32 v97, 0xffff0000, v212
  v_lshlrev_b32 v98, 16, v213
  v_and_b32 v99, 0xffff0000, v213
  v_lshlrev_b32 v100, 16, v214
  v_and_b32 v101, 0xffff0000, v214
  v_lshlrev_b32 v102, 16, v215
  v_and_b32 v103, 0xffff0000, v215
  v_lshlrev_b32 v88, 16, v216
  v_and_b32 v89, 0xffff0000, v216
  v_lshlrev_b32 v90, 16, v217
  v_and_b32 v91, 0xffff0000, v217
  v_lshlrev_b32 v92, 16, v218
  v_and_b32 v93, 0xffff0000, v218
  v_lshlrev_b32 v94, 16, v219
  v_and_b32 v95, 0xffff0000, v219
  v_lshlrev_b32 v104, 16, v220
  v_and_b32 v105, 0xffff0000, v220
  v_lshlrev_b32 v106, 16, v221
  v_and_b32 v107, 0xffff0000, v221
  v_lshlrev_b32 v108, 16, v222
  v_and_b32 v109, 0xffff0000, v222
  v_lshlrev_b32 v110, 16, v223
  v_and_b32 v111, 0xffff0000, v223
  v_pk_add_f32 v[144:145], v[144:145], v[80:81]
  v_pk_add_f32 v[146:147], v[146:147], v[82:83]
  v_pk_add_f32 v[148:149], v[148:149], v[84:85]
  v_pk_add_f32 v[150:151], v[150:151], v[86:87]
  v_pk_add_f32 v[152:153], v[152:153], v[88:89]
  v_pk_add_f32 v[154:155], v[154:155], v[90:91]
  v_pk_add_f32 v[156:157], v[156:157], v[92:93]
  v_pk_add_f32 v[158:159], v[158:159], v[94:95]
  v_pk_add_f32 v[160:161], v[160:161], v[96:97]
  v_pk_add_f32 v[162:163], v[162:163], v[98:99]
  v_pk_add_f32 v[164:165], v[164:165], v[100:101]
  v_pk_add_f32 v[166:167], v[166:167], v[102:103]
  v_pk_add_f32 v[168:169], v[168:169], v[104:105]
  v_pk_add_f32 v[170:171], v[170:171], v[106:107]
  v_pk_add_f32 v[172:173], v[172:173], v[108:109]
  v_pk_add_f32 v[174:175], v[174:175], v[110:111]
  s_waitcnt vmcnt(0)
  v_lshlrev_b32 v80, 16, v176
  v_and_b32 v81, 0xffff0000, v176
  v_lshlrev_b32 v82, 16, v177
  v_and_b32 v83, 0xffff0000, v177
  v_lshlrev_b32 v84, 16, v178
  v_and_b32 v85, 0xffff0000, v178
  v_lshlrev_b32 v86, 16, v179
  v_and_b32 v87, 0xffff0000, v179
  v_lshlrev_b32 v88, 16, v180
  v_and_b32 v89, 0xffff0000, v180
  v_lshlrev_b32 v90, 16, v181
  v_and_b32 v91, 0xffff0000, v181
  v_lshlrev_b32 v92, 16, v182
  v_and_b32 v93, 0xffff0000, v182
  v_lshlrev_b32 v94, 16, v183
  v_and_b32 v95, 0xffff0000, v183
  v_lshlrev_b32 v96, 16, v184
  v_and_b32 v97, 0xffff0000, v184
  v_lshlrev_b32 v98, 16, v185
  v_and_b32 v99, 0xffff0000, v185
  v_lshlrev_b32 v100, 16, v186
  v_and_b32 v101, 0xffff0000, v186
  v_lshlrev_b32 v102, 16, v187
  v_and_b32 v103, 0xffff0000, v187
  v_lshlrev_b32 v104, 16, v188
  v_and_b32 v105, 0xffff0000, v188
  v_lshlrev_b32 v106, 16, v189
  v_and_b32 v107, 0xffff0000, v189
  v_lshlrev_b32 v108, 16, v190
  v_and_b32 v109, 0xffff0000, v190
  v_lshlrev_b32 v110, 16, v191
  v_and_b32 v111, 0xffff0000, v191
  v_pk_add_f32 v[144:145], v[144:145], v[80:81]
  v_pk_add_f32 v[146:147], v[146:147], v[82:83]
  v_pk_add_f32 v[148:149], v[148:149], v[84:85]
  v_pk_add_f32 v[150:151], v[150:151], v[86:87]
  v_pk_add_f32 v[152:153], v[152:153], v[88:89]
  v_pk_add_f32 v[154:155], v[154:155], v[90:91]
  v_pk_add_f32 v[156:157], v[156:157], v[92:93]
  v_pk_add_f32 v[158:159], v[158:159], v[94:95]
  v_pk_add_f32 v[160:161], v[160:161], v[96:97]
  v_pk_add_f32 v[162:163], v[162:163], v[98:99]
  v_pk_add_f32 v[164:165], v[164:165], v[100:101]
  v_pk_add_f32 v[166:167], v[166:167], v[102:103]
  v_pk_add_f32 v[168:169], v[168:169], v[104:105]
  v_pk_add_f32 v[170:171], v[170:171], v[106:107]
  v_pk_add_f32 v[172:173], v[172:173], v[108:109]
  v_pk_add_f32 v[174:175], v[174:175], v[110:111]
  v_cvt_pk_bf16_f32 v16, v144, v145
  v_cvt_pk_bf16_f32 v17, v146, v147
  v_cvt_pk_bf16_f32 v18, v148, v149
  v_cvt_pk_bf16_f32 v19, v150, v151
  v_cvt_pk_bf16_f32 v20, v160, v161
  v_cvt_pk_bf16_f32 v21, v162, v163
  v_cvt_pk_bf16_f32 v22, v164, v165
  v_cvt_pk_bf16_f32 v23, v166, v167
  v_cvt_pk_bf16_f32 v24, v152, v153
  v_cvt_pk_bf16_f32 v25, v154, v155
  v_cvt_pk_bf16_f32 v26, v156, v157
  v_cvt_pk_bf16_f32 v27, v158, v159
  v_cvt_pk_bf16_f32 v28, v168, v169
  v_cvt_pk_bf16_f32 v29, v170, v171
  v_cvt_pk_bf16_f32 v30, v172, v173
  v_cvt_pk_bf16_f32 v31, v174, v175
  s_cmp_lg_u32 s10, 0
  s_cbranch_scc1 w2_final
  s_add_u32 s36, s36, 68157440
  s_add_u32 s38, s36, 8192
  buffer_store_dwordx4 v[16:19], v8, s[16:19], s36 offen offset:0 sc1
  buffer_store_dwordx4 v[20:23], v8, s[16:19], s36 offen offset:1024 sc1
  buffer_store_dwordx4 v[24:27], v8, s[16:19], s38 offen offset:0 sc1
  buffer_store_dwordx4 v[28:31], v8, s[16:19], s38 offen offset:1024 sc1
  s_lshl_b32 s38, s3, 11
  v_add_u32 v3, s38, v8
  ds_write_b128 v3, v[16:19] offset:0
  ds_write_b128 v3, v[20:23] offset:1024
  ds_write_b128 v3, v[24:27] offset:20480
  ds_write_b128 v3, v[28:31] offset:21504
  v_mov_b32 v3, 0x3f803f80
  v_mov_b32 v32, 0
  v_mov_b32 v33, 0
  v_mov_b32 v34, 0
  v_mov_b32 v35, 0
  v_mov_b32 v36, 0
  v_mov_b32 v37, 0
  v_mov_b32 v38, 0
  v_mov_b32 v39, 0
  v_dot2c_f32_bf16 v32, v16, v3
  v_dot2c_f32_bf16 v36, v16, v16
  v_dot2c_f32_bf16 v33, v20, v3
  v_dot2c_f32_bf16 v37, v20, v20
  v_dot2c_f32_bf16 v34, v24, v3
  v_dot2c_f32_bf16 v38, v24, v24
  v_dot2c_f32_bf16 v35, v28, v3
  v_dot2c_f32_bf16 v39, v28, v28
  v_dot2c_f32_bf16 v32, v17, v3
  v_dot2c_f32_bf16 v36, v17, v17
  v_dot2c_f32_bf16 v33, v21, v3
  v_dot2c_f32_bf16 v37, v21, v21
  v_dot2c_f32_bf16 v34, v25, v3
  v_dot2c_f32_bf16 v38, v25, v25
  v_dot2c_f32_bf16 v35, v29, v3
  v_dot2c_f32_bf16 v39, v29, v29
  v_dot2c_f32_bf16 v32, v18, v3
  v_dot2c_f32_bf16 v36, v18, v18
  v_dot2c_f32_bf16 v33, v22, v3
  v_dot2c_f32_bf16 v37, v22, v22
  v_dot2c_f32_bf16 v34, v26, v3
  v_dot2c_f32_bf16 v38, v26, v26
  v_dot2c_f32_bf16 v35, v30, v3
  v_dot2c_f32_bf16 v39, v30, v30
  v_dot2c_f32_bf16 v32, v19, v3
  v_dot2c_f32_bf16 v36, v19, v19
  v_dot2c_f32_bf16 v33, v23, v3
  v_dot2c_f32_bf16 v37, v23, v23
  v_dot2c_f32_bf16 v34, v27, v3
  v_dot2c_f32_bf16 v38, v27, v27
  v_dot2c_f32_bf16 v35, v31, v3
  v_dot2c_f32_bf16 v39, v31, v31
  v_permlane32_swap_b32 v32, v33
  s_nop 0
  v_permlane32_swap_b32 v34, v35
  v_permlane32_swap_b32 v36, v37
  v_permlane32_swap_b32 v38, v39
  v_add_f32 v32, v32, v33
  v_add_f32 v34, v34, v35
  v_add_f32 v36, v36, v37
  v_add_f32 v38, v38, v39
  v_permlane16_swap_b32 v32, v34
  s_nop 0
  v_permlane16_swap_b32 v36, v38
  v_add_f32 v32, v32, v34
  v_add_f32 v33, v36, v38
  v_and_b32 v13, 1, v2
  v_lshlrev_b32 v13, 10, v13
  v_lshrrev_b32 v14, 1, v2
  v_lshl_add_u32 v13, v14, 7, v13
  v_lshl_add_u32 v13, v1, 3, v13
  s_lshl_b32 s37, s26, 15
  s_lshl_b32 s38, s27, 11
  s_add_u32 s37, s37, s38
  s_lshl_b32 s38, s3, 8
  s_add_u32 s37, s37, s38
  s_add_u32 s37, s37, s10
  s_add_u32 s37, s37, 95420416
  buffer_store_dwordx2 v[32:33], v13, s[16:19], s37 offen sc1
  s_mov_b32 s10, 48234496
  s_add_u32 s6, s6, 48234496
  s_mov_b32 s11, 97746944
  s_branch main_lay_c
w2_final:
  s_mov_b32 s20, s8
  s_mov_b32 s21, s9
  s_mov_b32 s22, 4194304
  s_mov_b32 s23, 0x20000
  v_and_b32 v3, 1, v2
  v_lshlrev_b32 v3, 5, v3
  v_lshrrev_b32 v13, 1, v2
  v_lshl_add_u32 v3, v13, 4, v3
  v_lshl_add_u32 v3, v1, 11, v3
  s_lshl_b32 s36, s26, 18
  s_lshl_b32 s37, s3, 16
  s_add_u32 s36, s36, s37
  s_lshl_b32 s37, s27, 7
  s_add_u32 s36, s36, s37
  s_add_u32 s37, s36, 32768
  v_permlane16_swap_b32 v16, v18
  v_permlane16_swap_b32 v17, v19
  buffer_store_dwordx4 v[16:19], v3, s[20:23], s36 offen offset:0 sc1
  v_permlane16_swap_b32 v20, v22
  v_permlane16_swap_b32 v21, v23
  buffer_store_dwordx4 v[20:23], v3, s[20:23], s37 offen offset:0 sc1
  v_permlane16_swap_b32 v24, v26
  v_permlane16_swap_b32 v25, v27
  buffer_store_dwordx4 v[24:27], v3, s[20:23], s36 offen offset:64 sc1
  v_permlane16_swap_b32 v28, v30
  v_permlane16_swap_b32 v29, v31
  buffer_store_dwordx4 v[28:31], v3, s[20:23], s37 offen offset:64 sc1
  s_endpgm
at_slow:
  s_mul_i32 s29, s28, 282624
  s_add_u32 s29, s29, s10
  s_add_u32 s29, s29, 4194304
  s_mov_b32 s21, 0
at_sq:
  v_mov_b32 v6, 4284592614
  v_mov_b32 v7, 0
  v_mov_b32 v160, 0
  v_mov_b32 v161, 0
  v_mov_b32 v162, 0
  v_mov_b32 v163, 0
  v_mov_b32 v164, 0
  v_mov_b32 v165, 0
  v_mov_b32 v166, 0
  v_mov_b32 v167, 0
  v_mov_b32 v168, 0
  v_mov_b32 v169, 0
  v_mov_b32 v170, 0
  v_mov_b32 v171, 0
  v_mov_b32 v172, 0
  v_mov_b32 v173, 0
  v_mov_b32 v174, 0
  v_mov_b32 v175, 0
  s_mov_b32 s20, 0
  s_mov_b32 s12, s29
at_sloop:
  buffer_load_dwordx4 v[24:27], v2, s[16:19], s12 offen offset:0 sc1
  buffer_load_dwordx4 v[28:31], v2, s[16:19], s12 offen offset:1024 sc1
  buffer_load_dwordx4 v[40:43], v2, s[16:19], s12 offen offset:2048 sc1
  buffer_load_dwordx4 v[44:47], v2, s[16:19], s12 offen offset:3072 sc1
  s_add_u32 s12, s12, 4096
  s_waitcnt vmcnt(0)
  v_mfma_f32_32x32x16_bf16 v[144:159], v[24:27], v[8:11], 0
  v_mfma_f32_32x32x16_bf16 v[144:159], v[28:31], v[12:15], v[144:159]
  s_nop 11
  v_max3_f32 v1, v144, v145, v146
  v_max3_f32 v1, v1, v147, v148
  v_max3_f32 v1, v1, v149, v150
  v_max3_f32 v1, v1, v151, v152
  v_max3_f32 v1, v1, v153, v154
  v_max3_f32 v1, v1, v155, v156
  v_max3_f32 v1, v1, v157, v158
  v_max3_f32 v1, v1, v159, v6
  v_mov_b32 v3, v1
  s_nop 1
  v_permlane32_swap_b32 v1, v3
  v_max_f32 v1, v1, v3
  v_sub_f32 v3, v6, v1
  v_exp_f32 v3, v3
  v_mov_b32 v6, v1
  v_sub_f32 v144, v144, v1
  v_sub_f32 v145, v145, v1
  v_sub_f32 v146, v146, v1
  v_sub_f32 v147, v147, v1
  v_sub_f32 v148, v148, v1
  v_sub_f32 v149, v149, v1
  v_sub_f32 v150, v150, v1
  v_sub_f32 v151, v151, v1
  v_sub_f32 v152, v152, v1
  v_sub_f32 v153, v153, v1
  v_sub_f32 v154, v154, v1
  v_sub_f32 v155, v155, v1
  v_sub_f32 v156, v156, v1
  v_sub_f32 v157, v157, v1
  v_sub_f32 v158, v158, v1
  v_sub_f32 v159, v159, v1
  v_exp_f32 v144, v144
  v_exp_f32 v145, v145
  v_exp_f32 v146, v146
  v_exp_f32 v147, v147
  v_exp_f32 v148, v148
  v_exp_f32 v149, v149
  v_exp_f32 v150, v150
  v_exp_f32 v151, v151
  v_exp_f32 v152, v152
  v_exp_f32 v153, v153
  v_exp_f32 v154, v154
  v_exp_f32 v155, v155
  v_exp_f32 v156, v156
  v_exp_f32 v157, v157
  v_exp_f32 v158, v158
  v_exp_f32 v159, v159
  v_mul_f32 v160, v160, v3
  v_mul_f32 v161, v161, v3
  v_mul_f32 v162, v162, v3
  v_mul_f32 v163, v163, v3
  v_mul_f32 v164, v164, v3
  v_mul_f32 v165, v165, v3
  v_mul_f32 v166, v166, v3
  v_mul_f32 v167, v167, v3
  v_mul_f32 v168, v168, v3
  v_mul_f32 v169, v169, v3
  v_mul_f32 v170, v170, v3
  v_mul_f32 v171, v171, v3
  v_mul_f32 v172, v172, v3
  v_mul_f32 v173, v173, v3
  v_mul_f32 v174, v174, v3
  v_mul_f32 v175, v175, v3
  v_mul_f32 v7, v7, v3
  v_cvt_pk_bf16_f32 v56, v144, v145
  v_cvt_pk_bf16_f32 v57, v146, v147
  v_cvt_pk_bf16_f32 v58, v148, v149
  v_cvt_pk_bf16_f32 v59, v150, v151
  v_cvt_pk_bf16_f32 v60, v152, v153
  v_cvt_pk_bf16_f32 v61, v154, v155
  v_cvt_pk_bf16_f32 v62, v156, v157
  v_cvt_pk_bf16_f32 v63, v158, v159
  v_add_f32 v7, v7, v144
  v_add_f32 v7, v7, v145
  v_add_f32 v7, v7, v146
  v_add_f32 v7, v7, v147
  v_add_f32 v7, v7, v148
  v_add_f32 v7, v7, v149
  v_add_f32 v7, v7, v150
  v_add_f32 v7, v7, v151
  v_add_f32 v7, v7, v152
  v_add_f32 v7, v7, v153
  v_add_f32 v7, v7, v154
  v_add_f32 v7, v7, v155
  v_add_f32 v7, v7, v156
  v_add_f32 v7, v7, v157
  v_add_f32 v7, v7, v158
  v_add_f32 v7, v7, v159
  v_mfma_f32_32x32x16_bf16 v[160:175], v[40:43], v[56:59], v[160:175]
  v_mfma_f32_32x32x16_bf16 v[160:175], v[44:47], v[60:63], v[160:175]
  s_add_u32 s20, s20, 1
  s_cmp_lg_u32 s20, 64
  s_nop 7
  s_cbranch_scc1 at_sloop
  v_mov_b32 v3, v7
  s_nop 1
  v_permlane32_swap_b32 v7, v3
  v_add_f32 v72, v7, v3
  v_mov_b32 v96, v160
  v_mov_b32 v97, v161
  v_mov_b32 v98, v162
  v_mov_b32 v99, v163
  v_mov_b32 v100, v164
  v_mov_b32 v101, v165
  v_mov_b32 v102, v166
  v_mov_b32 v103, v167
  v_mov_b32 v104, v168
  v_mov_b32 v105, v169
  v_mov_b32 v106, v170
  v_mov_b32 v107, v171
  v_mov_b32 v108, v172
  v_mov_b32 v109, v173
  v_mov_b32 v110, v174
  v_mov_b32 v111, v175
  s_cmp_lg_u32 s21, 0
  s_cbranch_scc1 at_fin
  s_mov_b32 s21, 1
  v_mov_b32 v68, v72
  v_mov_b32 v80, v160
  v_mov_b32 v81, v161
  v_mov_b32 v82, v162
  v_mov_b32 v83, v163
  v_mov_b32 v84, v164
  v_mov_b32 v85, v165
  v_mov_b32 v86, v166
  v_mov_b32 v87, v167
  v_mov_b32 v88, v168
  v_mov_b32 v89, v169
  v_mov_b32 v90, v170
  v_mov_b32 v91, v171
  v_mov_b32 v92, v172
  v_mov_b32 v93, v173
  v_mov_b32 v94, v174
  v_mov_b32 v95, v175
  v_mov_b32 v8, v16
  v_mov_b32 v9, v17
  v_mov_b32 v10, v18
  v_mov_b32 v11, v19
  v_mov_b32 v12, v20
  v_mov_b32 v13, v21
  v_mov_b32 v14, v22
  v_mov_b32 v15, v23
  s_branch at_sq
main_end:
.section .rodata,"a"
.p2align 6
.amdhsa_kernel main_kernel
  .amdhsa_next_free_vgpr 256
  .amdhsa_next_free_sgpr 96
  .amdhsa_accum_offset 256
  .amdhsa_group_segment_fixed_size 0
  .amdhsa_kernarg_size 72
  .amdhsa_user_sgpr_count 2
  .amdhsa_user_sgpr_kernarg_segment_ptr 1
  .amdhsa_system_sgpr_workgroup_id_x 1
.end_amdhsa_kernel
.text
```
